```python
import torch

def _softmax(x, axis=-1):
    return torch.softmax(x, dim=axis)
def _gelu(x):
    return torch.nn.functional.gelu(x, approximate="tanh")
def _silu(x):
    return torch.nn.functional.silu(x)
def _sigmoid(x):
    return torch.sigmoid(x)
def _layernorm(x, axis=-1, eps=1e-5):
    m = x.mean(dim=axis, keepdim=True)
    v = x.var(dim=axis, keepdim=True, unbiased=False)
    return (x - m) / torch.sqrt(v + eps)
def _scatter_add(tgt, idx, src, axis=0):
    return tgt.clone().index_add_(axis, idx, src)
def _segment_sum(src, seg, n):
    out = torch.zeros((n,) + src.shape[1:], dtype=src.dtype)
    return out.index_add_(0, seg, src)
def _pad(x, pw):
    flat = tuple(v for pair in reversed(pw) for v in pair)
    return torch.nn.functional.pad(x, flat)

kernel_name = 'sequential_preLN__linear_kernel_hedgehog__moe_arch_mod__prompt'

def setup_inputs():

    _w = (lambda a: (lambda t: t.to(torch.bfloat16) if t.is_floating_point() else t)(torch.as_tensor(a)))
    def _A_setup():
        B, S, D, H = 1, 2048, 640, 32
        Dh = D // H
        return {
            "x": _w((lambda *s: torch.randn(*s, dtype=torch.bfloat16) * 0.05)(B, S, D)),
            "wqkv": _w((lambda *s: torch.randn(*s, dtype=torch.bfloat16) * 0.2)(D, 3 * D)),
            "w_phi": _w((lambda *s: torch.randn(*s, dtype=torch.bfloat16) * 0.2)(H, Dh, Dh) * (Dh ** -0.5)),
            "wo": _w((lambda *s: torch.randn(*s, dtype=torch.bfloat16) * 0.05)(D, D)),
        }
    _A_in = _A_setup()

    def _B_setup():
        B, S, D, F, C = 1, 2048, 640, 1536, 8
        return {
            "x": _w((lambda *s: torch.randn(*s, dtype=torch.bfloat16) * 0.05)(B, S, D)),
            "w_r": _w((lambda *s: torch.randn(*s, dtype=torch.bfloat16) * 0.05)(D)),
            "w_gate": _w((lambda *s: torch.randn(*s, dtype=torch.bfloat16) * 0.05)(D, F)),
            "w_up": _w((lambda *s: torch.randn(*s, dtype=torch.bfloat16) * 0.05)(D, F)),
            "w_down": _w((lambda *s: torch.randn(*s, dtype=torch.bfloat16) * 0.05)(F, D)),
        }
    _B_in = _B_setup()

    return {
        "A_x": _A_in["x"],
        "A_wqkv": _A_in["wqkv"],
        "A_w_phi": _A_in["w_phi"],
        "A_wo": _A_in["wo"],
        "B_x": _B_in["x"],
        "B_w_r": _B_in["w_r"],
        "B_w_gate": _B_in["w_gate"],
        "B_w_up": _B_in["w_up"],
        "B_w_down": _B_in["w_down"],
    }

def reference(A_x, A_wqkv, A_w_phi, A_wo, B_x, B_w_r, B_w_gate, B_w_up, B_w_down):
    def _A_ref(x, wqkv, w_phi, wo):
        B, S, D = x.shape
        H = 32; Dh = D // H
        qkv = (lambda x, *d: x.permute(*d))((x @ wqkv).reshape(B, S, 3, H, Dh), 2, 0, 3, 1, 4)
        q, k, v = qkv[0], qkv[1], qkv[2]
        pq = torch.einsum("bhsd,hdf->bhsf", q, w_phi)
        pk = torch.einsum("bhsd,hdf->bhsf", k, w_phi)
        phi_q = torch.concatenate([_softmax(pq, axis=-1), _softmax(-pq, axis=-1)], axis=-1)
        phi_k = torch.concatenate([_softmax(pk, axis=-1), _softmax(-pk, axis=-1)], axis=-1)
        kv = torch.einsum("bhsf,bhsd->bhfd", phi_k, v)
        z  = torch.einsum("bhsf->bhf", phi_k)
        num = torch.einsum("bhqf,bhfd->bhqd", phi_q, kv)
        den = torch.einsum("bhqf,bhf->bhq", phi_q, z)[..., None] + 1e-6
        o = num / den
        return (lambda x, *d: x.permute(*d))(o, 0, 2, 1, 3).reshape(B, S, D) @ wo

    def _B_ref(x, w_r, w_gate, w_up, w_down):
        B, S, D = x.shape
        C = 8
        r = x @ w_r
        idx = torch.argsort(-r, axis=-1)[:, :C]
        idx_e = (lambda x, n, axis: torch.repeat_interleave(x, n, dim=axis))(idx.reshape(B, C, 1), D, axis=2)
        x_sel = (lambda x, i, axis: torch.take_along_dim(x, i, dim=axis))(x, idx_e, axis=1)
        g = _silu(x_sel @ w_gate)
        u = x_sel @ w_up
        y = (g * u) @ w_down
        r_sel = _sigmoid((lambda x, i, axis: torch.take_along_dim(x, i, dim=axis))(r, idx, axis=1))
        y = y * r_sel.reshape(B, C, 1)
        b_off = (torch.arange(B) * S).reshape(B, 1)
        flat_idx = (idx + b_off).reshape(B * C)
        zero = (x * 0.0).reshape(B * S, D)
        upd = _scatter_add(zero, flat_idx, y.reshape(B * C, D), axis=0)
        return x + upd.reshape(B, S, D)

    x = A_x
    h = x + _A_ref(_layernorm(x, axis=-1), A_wqkv, A_w_phi, A_wo)
    h2 = h + _B_ref(_layernorm(h, axis=-1), B_w_r, B_w_gate, B_w_up, B_w_down)
    return h2
```

```asm
; @launch grid=(256,1,1) block=(512,1,1) lds=163840
.amdgcn_target "amdgcn-amd-amdhsa--gfx950"
.text
.globl sequential_preLN__linear_kernel_hedgehog__moe_arch_mod__prompt_kernel
.p2align 8
.type sequential_preLN__linear_kernel_hedgehog__moe_arch_mod__prompt_kernel,@function
sequential_preLN__linear_kernel_hedgehog__moe_arch_mod__prompt_kernel:
    s_cmp_ge_u32 s2, 256
    s_cbranch_scc0 L_go
    s_endpgm
L_go:
    s_load_dwordx16 s[32:47], s[0:1], 0
    s_load_dwordx8 s[48:55], s[0:1], 64
    v_lshrrev_b32 v14, 6, v0
    v_and_b32 v1, 63, v0
    v_readfirstlane_b32 s5, v14
    s_lshr_b32 s57, s2, 3
    s_cmp_lg_u32 s5, 7
    s_cbranch_scc1 L_nopf
    s_getpc_b64 s[20:21]
L_pc:
    s_sub_u32 s20, s20, L_pc-sequential_preLN__linear_kernel_hedgehog__moe_arch_mod__prompt_kernel
    s_subb_u32 s21, s21, 0
    s_and_b32 s21, s21, 0xffff
    s_mov_b32 s22, L_codeend-sequential_preLN__linear_kernel_hedgehog__moe_arch_mod__prompt_kernel
    s_mov_b32 s23, 0x20000
    s_lshl_b32 s58, s57, 7
    v_lshlrev_b32 v14, 12, v1
    s_mov_b64 exec, 0xffff
    buffer_load_dword v230, v14, s[20:23], s58 offen
    s_mov_b64 exec, -1
    v_lshlrev_b32 v18, 4, v1
    v_add_u32 v18, 159744, v18
    v_mov_b32 v14, 0
    v_mov_b32 v15, 0
    v_mov_b32 v16, 0
    v_mov_b32 v17, 0
    ds_write_b128 v18, v[14:17]
L_nopf:
    s_and_b32 s3, s2, 6
    s_lshl_b32 s3, s3, 2
    s_and_b32 s58, s57, 7
    s_add_u32 s3, s3, s58
    s_and_b32 s4, s2, 1
    s_lshl_b32 s4, s4, 2
    s_lshr_b32 s58, s57, 3
    s_add_u32 s4, s4, s58
    s_mul_i32 s7, s4, 5
    s_lshl1_add_u32 s7, s3, s7
    s_mul_i32 s58, s7, 205
    s_lshr_b32 s58, s58, 11
    s_mul_i32 s58, s58, 10
    s_sub_u32 s7, s7, s58
    s_and_b32 s6, s5, 3
    s_cmp_ge_u32 s5, 4
    s_cbranch_scc1 L_E
    v_lshrrev_b32 v14, 3, v1
    v_and_b32 v15, 7, v1
    v_lshrrev_b32 v16, 1, v14
    v_xor_b32 v15, v15, v16
    v_lshlrev_b32_e64 v15, 4, v15
    v_mul_u32_u24 v14, 1280, v14
    v_add_u32 v18, v14, v15
    v_xor_b32 v15, 64, v15
    v_add_u32_e64 v19, v14, v15
    v_add_u32 v19, 9216, v19
    s_lshl2_add_u32 s67, s3, s6
    s_mul_i32 s67, s67, 20480
    s_mov_b32 s10, 2621440
    s_mov_b32 s11, 0x20000
    s_mul_i32 s63, s6, 20480
    s_add_u32 s63, s63, 61440
    s_lshl_b32 s68, s7, 7
    s_add_u32 s68, s68, s67
    s_add_u32 s69, s67, 1280
    s_waitcnt lgkmcnt(0)
    s_mov_b32 s8, s32
    s_and_b32 s9, s33, 0xffff
    s_add_u32 m0, s63, 0
    s_add_u32 s58, s68, 128
    buffer_load_dwordx4 v18, s[8:11], s68 offen lds
    buffer_load_dwordx4 v19, s[8:11], s68 offen offset:1024 lds
    s_cmp_eq_u32 s58, s69
    s_cselect_b32 s68, s67, s58
    s_add_u32 m0, s63, 2048
    s_add_u32 s58, s68, 128
    buffer_load_dwordx4 v18, s[8:11], s68 offen lds
    buffer_load_dwordx4 v19, s[8:11], s68 offen offset:1024 lds
    s_cmp_eq_u32 s58, s69
    s_cselect_b32 s68, s67, s58
    s_add_u32 m0, s63, 4096
    s_add_u32 s58, s68, 128
    buffer_load_dwordx4 v18, s[8:11], s68 offen lds
    buffer_load_dwordx4 v19, s[8:11], s68 offen offset:1024 lds
    s_cmp_eq_u32 s58, s69
    s_cselect_b32 s68, s67, s58
    s_add_u32 m0, s63, 6144
    s_add_u32 s58, s68, 128
    buffer_load_dwordx4 v18, s[8:11], s68 offen lds
    buffer_load_dwordx4 v19, s[8:11], s68 offen offset:1024 lds
    s_cmp_eq_u32 s58, s69
    s_cselect_b32 s68, s67, s58
    s_add_u32 m0, s63, 8192
    s_add_u32 s58, s68, 128
    buffer_load_dwordx4 v18, s[8:11], s68 offen lds
    buffer_load_dwordx4 v19, s[8:11], s68 offen offset:1024 lds
    s_cmp_eq_u32 s58, s69
    s_cselect_b32 s68, s67, s58
    s_mov_b32 s12, s34
    s_and_b32 s13, s35, 0xffff
    s_mov_b32 s14, 2457600
    s_mov_b32 s15, 0x20000
    s_mul_i32 s58, s6, 7
    v_add_u32 v14, s58, v1
    v_min_u32 v14, 24, v14
    v_mul_u32_u24 v15, 13108, v14
    v_lshrrev_b32_e64 v15, 16, v15
    v_mul_u32_u24 v15, 3200, v15
    v_lshl_add_u32 v14, v14, 7, v15
    s_and_b32 s59, s4, 3
    s_lshl2_add_u32 s58, s3, s59
    s_mul_i32 s58, s58, 19200
    s_lshr_b32 s59, s4, 2
    s_mul_i32 s59, s59, 640
    s_add_u32 s58, s58, s59
    s_mov_b64 exec, 0x7f
    buffer_load_dword v255, v14, s[12:15], s58 offen offset:1280
    s_mov_b64 exec, -1
    v_and_b32 v2, 15, v1
    v_lshrrev_b32 v3, 4, v1
    s_mov_b32 s31, 0xffff0000
    s_mul_i32 s62, s6, 5120
    s_mov_b32 s64, 1069066811
    s_mov_b32 s65, 1069066811
    s_mov_b32 s66, 0x3f803f80
    s_lshl_b32 s58, s6, 2
    s_add_u32 s58, s58, 159744
    v_mov_b32 v12, s58
    v_and_b32 v14, 3, v1
    v_lshlrev_b32_e64 v14, 2, v14
    v_add_u32 v13, 159744, v14
    v_lshrrev_b32 v14, 5, v1
    v_lshlrev_b32 v14, 4, v14
    v_bfe_u32 v15, v1, 2, 3
    v_add_u32_e64 v14, v14, v15
    v_mul_u32_u24 v14, 160, v14
    v_and_b32_e64 v15, 3, v1
    v_mad_u32_u24 v9, v15, 40, v14
    v_add_u32 v10, 61440, v9
    v_add_u32 v11, 122880, v9
    v_lshrrev_b32 v14, 1, v2
    v_xor_b32 v14, v14, v3
    v_lshlrev_b32_e64 v14, 4, v14
    v_lshl_add_u32 v14, v2, 7, v14
    v_add_u32 v20, s63, v14
    v_xor_b32_e64 v21, 64, v20
    s_lshl_b32 s58, s6, 4
    v_lshl_add_u32 v14, v3, 6, v2
    v_add_u32 v23, s58, v14
    v_mul_u32_u24 v14, 48, v23
    v_add_u32 v247, 143360, v14
    s_mul_i32 s58, s6, 3072
    s_add_u32 s58, s58, 143360
    v_lshl_add_u32 v246, v1, 4, s58
    v_mov_b32 v166, s66
    v_mov_b32 v167, s66
    s_mov_b32 s72, 0x3f80
    s_mov_b32 s73, 0x3f800000
    s_bitcmp1_b32 s3, 0
    s_mov_b32 s58, 0x43765210
    s_cselect_b32 s58, 0x43276510, s58
    s_mov_b32 s59, 0x00400000
    s_cselect_b32 s59, 0x00088400, s59
    s_lshl_b32 s56, s4, 2
    s_lshr_b32 s58, s58, s56
    s_and_b32 s0, s58, 7
    s_lshr_b32 s59, s59, s56
    s_and_b32 s1, s59, 15
    s_bfe_u32 s59, s3, 0x20001
    s_add_u32 s1, s1, s59
    s_and_b32 s59, s2, 7
    s_mul_i32 s70, s59, 6
    s_mul_i32 s59, s59, 5
    s_add_u32 s59, s59, 42
    s_cmp_lt_u32 s1, 6
    s_cselect_b32 s70, s70, s59
    s_add_u32 s70, s70, s1
    s_cmp_eq_u32 s1, 11
    s_cselect_b32 s70, 88, s70
    v_bfe_u32 v14, v1, 2, 2
    v_mul_u32_u24_e64 v14, 40, v14
    v_mul_u32_u24 v15, 800, v3
    v_add_u32 v14, v14, v15
    v_and_b32 v15, 3, v1
    v_cmp_eq_u32_e64 vcc, v15, v3
    v_mov_b32 v15, 3200
    s_nop 0
    v_cndmask_b32 v14, v15, v14, vcc
    v_add_u32 v22, 155648, v14
    v_bfe_u32 v248, v1, 0, 1
    v_add_u32_e64 v248, -1, v248
    v_bfe_u32 v249, v1, 1, 1
    v_add_u32_e64 v249, -1, v249
    v_bfe_u32 v250, v1, 2, 1
    v_add_u32 v250, -1, v250
    s_mov_b32 s16, s54
    s_and_b32 s17, s55, 0xffff
    s_mov_b32 s18, 7776256
    s_mov_b32 s19, 0x20000
    s_mov_b32 s20, s42
    s_and_b32 s21, s43, 0xffff
    s_mov_b32 s22, 1280
    s_mov_b32 s23, 0x20000
    v_mul_u32_u24 v245, 20, v1
    v_mov_b32 v14, 0
    v_mov_b32 v16, 0
    s_add_u32 m0, s63, 10240
    s_add_u32 s58, s68, 128
    buffer_load_dwordx4 v18, s[8:11], s68 offen lds
    buffer_load_dwordx4 v19, s[8:11], s68 offen offset:1024 lds
    s_cmp_eq_u32 s58, s69
    s_cselect_b32 s68, s67, s58
    s_waitcnt vmcnt(11)
    ds_read_b128 v[24:27], v20 offset:0
    ds_read_b128 v[28:31], v21 offset:0
    s_add_u32 m0, s63, 12288
    s_add_u32 s58, s68, 128
    buffer_load_dwordx4 v18, s[8:11], s68 offen lds
    buffer_load_dwordx4 v19, s[8:11], s68 offen offset:1024 lds
    s_cmp_eq_u32 s58, s69
    s_cselect_b32 s68, s67, s58
    s_waitcnt vmcnt(11)
    ds_read_b128 v[32:35], v20 offset:2048
    ds_read_b128 v[36:39], v21 offset:2048
    s_waitcnt lgkmcnt(2)
    v_dot2c_f32_bf16 v14, s66, v24
    v_dot2c_f32_bf16 v16, v24, v24
    v_dot2c_f32_bf16 v14, s66, v25
    v_dot2c_f32_bf16 v16, v25, v25
    v_dot2c_f32_bf16 v14, s66, v26
    v_dot2c_f32_bf16 v16, v26, v26
    v_dot2c_f32_bf16 v14, s66, v27
    v_dot2c_f32_bf16 v16, v27, v27
    v_dot2c_f32_bf16 v14, s66, v28
    v_dot2c_f32_bf16 v16, v28, v28
    v_dot2c_f32_bf16 v14, s66, v29
    v_dot2c_f32_bf16 v16, v29, v29
    v_dot2c_f32_bf16 v14, s66, v30
    v_dot2c_f32_bf16 v16, v30, v30
    v_dot2c_f32_bf16 v14, s66, v31
    v_dot2c_f32_bf16 v16, v31, v31
    s_add_u32 m0, s63, 14336
    s_add_u32 s58, s68, 128
    buffer_load_dwordx4 v18, s[8:11], s68 offen lds
    buffer_load_dwordx4 v19, s[8:11], s68 offen offset:1024 lds
    s_cmp_eq_u32 s58, s69
    s_cselect_b32 s68, s67, s58
    s_waitcnt vmcnt(11)
    ds_read_b128 v[40:43], v20 offset:4096
    ds_read_b128 v[44:47], v21 offset:4096
    s_waitcnt lgkmcnt(2)
    v_dot2c_f32_bf16 v14, s66, v32
    v_dot2c_f32_bf16 v16, v32, v32
    v_dot2c_f32_bf16 v14, s66, v33
    v_dot2c_f32_bf16 v16, v33, v33
    v_dot2c_f32_bf16 v14, s66, v34
    v_dot2c_f32_bf16 v16, v34, v34
    v_dot2c_f32_bf16 v14, s66, v35
    v_dot2c_f32_bf16 v16, v35, v35
    v_dot2c_f32_bf16 v14, s66, v36
    v_dot2c_f32_bf16 v16, v36, v36
    v_dot2c_f32_bf16 v14, s66, v37
    v_dot2c_f32_bf16 v16, v37, v37
    v_dot2c_f32_bf16 v14, s66, v38
    v_dot2c_f32_bf16 v16, v38, v38
    v_dot2c_f32_bf16 v14, s66, v39
    v_dot2c_f32_bf16 v16, v39, v39
    s_add_u32 m0, s63, 16384
    s_add_u32 s58, s68, 128
    buffer_load_dwordx4 v18, s[8:11], s68 offen lds
    buffer_load_dwordx4 v19, s[8:11], s68 offen offset:1024 lds
    s_cmp_eq_u32 s58, s69
    s_cselect_b32 s68, s67, s58
    s_waitcnt vmcnt(11)
    ds_read_b128 v[48:51], v20 offset:6144
    ds_read_b128 v[52:55], v21 offset:6144
    s_waitcnt lgkmcnt(2)
    v_dot2c_f32_bf16 v14, s66, v40
    v_dot2c_f32_bf16 v16, v40, v40
    v_dot2c_f32_bf16 v14, s66, v41
    v_dot2c_f32_bf16 v16, v41, v41
    v_dot2c_f32_bf16 v14, s66, v42
    v_dot2c_f32_bf16 v16, v42, v42
    v_dot2c_f32_bf16 v14, s66, v43
    v_dot2c_f32_bf16 v16, v43, v43
    v_dot2c_f32_bf16 v14, s66, v44
    v_dot2c_f32_bf16 v16, v44, v44
    v_dot2c_f32_bf16 v14, s66, v45
    v_dot2c_f32_bf16 v16, v45, v45
    v_dot2c_f32_bf16 v14, s66, v46
    v_dot2c_f32_bf16 v16, v46, v46
    v_dot2c_f32_bf16 v14, s66, v47
    v_dot2c_f32_bf16 v16, v47, v47
    s_add_u32 m0, s63, 18432
    s_add_u32 s58, s68, 128
    buffer_load_dwordx4 v18, s[8:11], s68 offen lds
    buffer_load_dwordx4 v19, s[8:11], s68 offen offset:1024 lds
    s_barrier
    s_waitcnt vmcnt(11)
    ds_read_b128 v[56:59], v20 offset:8192
    ds_read_b128 v[60:63], v21 offset:8192
    s_waitcnt lgkmcnt(2)
    v_dot2c_f32_bf16 v14, s66, v48
    v_dot2c_f32_bf16 v16, v48, v48
    v_dot2c_f32_bf16 v14, s66, v49
    v_dot2c_f32_bf16 v16, v49, v49
    v_dot2c_f32_bf16 v14, s66, v50
    v_dot2c_f32_bf16 v16, v50, v50
    v_dot2c_f32_bf16 v14, s66, v51
    v_dot2c_f32_bf16 v16, v51, v51
    v_dot2c_f32_bf16 v14, s66, v52
    v_dot2c_f32_bf16 v16, v52, v52
    v_dot2c_f32_bf16 v14, s66, v53
    v_dot2c_f32_bf16 v16, v53, v53
    v_dot2c_f32_bf16 v14, s66, v54
    v_dot2c_f32_bf16 v16, v54, v54
    v_dot2c_f32_bf16 v14, s66, v55
    v_dot2c_f32_bf16 v16, v55, v55
    s_waitcnt vmcnt(8)
    ds_read_b128 v[64:67], v20 offset:10240
    ds_read_b128 v[68:71], v21 offset:10240
    s_waitcnt lgkmcnt(2)
    v_dot2c_f32_bf16 v14, s66, v56
    v_dot2c_f32_bf16 v16, v56, v56
    v_dot2c_f32_bf16 v14, s66, v57
    v_dot2c_f32_bf16 v16, v57, v57
    v_dot2c_f32_bf16 v14, s66, v58
    v_dot2c_f32_bf16 v16, v58, v58
    v_dot2c_f32_bf16 v14, s66, v59
    v_dot2c_f32_bf16 v16, v59, v59
    v_dot2c_f32_bf16 v14, s66, v60
    v_dot2c_f32_bf16 v16, v60, v60
    v_dot2c_f32_bf16 v14, s66, v61
    v_dot2c_f32_bf16 v16, v61, v61
    v_dot2c_f32_bf16 v14, s66, v62
    v_dot2c_f32_bf16 v16, v62, v62
    v_dot2c_f32_bf16 v14, s66, v63
    v_dot2c_f32_bf16 v16, v63, v63
    s_branch pg_1
L_E:
    v_and_b32 v2, 15, v1
    v_lshrrev_b32 v3, 4, v1
    s_mov_b32 s31, 0xffff0000
    s_mul_i32 s62, s6, 5120
    s_mov_b32 s64, 1069066811
    s_mov_b32 s65, 1069066811
    s_mov_b32 s66, 0x3f803f80
    s_lshl_b32 s58, s6, 2
    s_add_u32 s58, s58, 159744
    v_mov_b32 v12, s58
    v_and_b32 v14, 3, v1
    v_lshlrev_b32_e64 v14, 2, v14
    v_add_u32 v13, 159744, v14
    v_add_u32_e64 v14, 0, v1
    v_mul_u32_u24 v15, 6554, v14
    v_lshrrev_b32 v15, 16, v15
    v_mul_u32_u24 v16, 10, v15
    v_sub_u32 v14, v14, v16
    v_and_b32 v16, 0x13, v15
    v_and_b32_e64 v17, 4, v15
    v_lshl_or_b32 v16, v17, 1, v16
    v_bfe_u32 v17, v15, 3, 1
    v_lshl_or_b32 v16, v17, 2, v16
    v_mul_u32_u24 v16, 3840, v16
    v_lshl_add_u32 v4, v14, 4, v16
    v_add_u32_e64 v14, 64, v1
    v_mul_u32_u24 v15, 6554, v14
    v_lshrrev_b32 v15, 16, v15
    v_mul_u32_u24 v16, 10, v15
    v_sub_u32 v14, v14, v16
    v_and_b32 v16, 0x13, v15
    v_and_b32_e64 v17, 4, v15
    v_lshl_or_b32 v16, v17, 1, v16
    v_bfe_u32 v17, v15, 3, 1
    v_lshl_or_b32 v16, v17, 2, v16
    v_mul_u32_u24 v16, 3840, v16
    v_lshl_add_u32 v5, v14, 4, v16
    v_subrev_u32 v5, 1024, v5
    v_add_u32 v14, 128, v1
    v_mul_u32_u24 v15, 6554, v14
    v_lshrrev_b32 v15, 16, v15
    v_mul_u32_u24 v16, 10, v15
    v_sub_u32 v14, v14, v16
    v_and_b32 v16, 0x13, v15
    v_and_b32_e64 v17, 4, v15
    v_lshl_or_b32 v16, v17, 1, v16
    v_bfe_u32 v17, v15, 3, 1
    v_lshl_or_b32 v16, v17, 2, v16
    v_mul_u32_u24 v16, 3840, v16
    v_lshl_add_u32 v6, v14, 4, v16
    v_subrev_u32 v6, 2048, v6
    v_add_u32 v14, 192, v1
    v_mul_u32_u24 v15, 6554, v14
    v_lshrrev_b32 v15, 16, v15
    v_mul_u32_u24 v16, 10, v15
    v_sub_u32 v14, v14, v16
    v_and_b32 v16, 0x13, v15
    v_and_b32_e64 v17, 4, v15
    v_lshl_or_b32 v16, v17, 1, v16
    v_bfe_u32 v17, v15, 3, 1
    v_lshl_or_b32 v16, v17, 2, v16
    v_mul_u32_u24 v16, 3840, v16
    v_lshl_add_u32 v7, v14, 4, v16
    v_subrev_u32 v7, 3072, v7
    v_add_u32 v14, 256, v1
    v_mul_u32_u24 v15, 6554, v14
    v_lshrrev_b32 v15, 16, v15
    v_mul_u32_u24 v16, 10, v15
    v_sub_u32 v14, v14, v16
    v_and_b32 v16, 0x13, v15
    v_and_b32_e64 v17, 4, v15
    v_lshl_or_b32 v16, v17, 1, v16
    v_bfe_u32 v17, v15, 3, 1
    v_lshl_or_b32 v16, v17, 2, v16
    v_mul_u32_u24 v16, 3840, v16
    v_lshl_add_u32 v8, v14, 4, v16
    s_waitcnt lgkmcnt(0)
    s_load_dword s28, s[54:55], 12
    s_lshl_b32 s60, s7, 1
    s_add_u32 s60, s60, s6
    s_mul_i32 s61, s4, 160
    s_add_u32 s58, s60, 0
    s_cmp_ge_u32 s58, 20
    s_cselect_b32 s59, 20, 0
    s_sub_u32 s58, s58, s59
    s_mul_i32 s58, s58, 122880
    s_add_u32 s40, s58, s61
    s_add_u32 s58, s60, 4
    s_cmp_ge_u32 s58, 20
    s_cselect_b32 s59, 20, 0
    s_sub_u32 s58, s58, s59
    s_mul_i32 s58, s58, 122880
    s_add_u32 s41, s58, s61
    s_add_u32 s58, s60, 8
    s_cmp_ge_u32 s58, 20
    s_cselect_b32 s59, 20, 0
    s_sub_u32 s58, s58, s59
    s_mul_i32 s58, s58, 122880
    s_add_u32 s32, s58, s61
    s_add_u32 s58, s60, 12
    s_cmp_ge_u32 s58, 20
    s_cselect_b32 s59, 20, 0
    s_sub_u32 s58, s58, s59
    s_mul_i32 s58, s58, 122880
    s_add_u32 s33, s58, s61
    s_add_u32 s58, s60, 16
    s_cmp_ge_u32 s58, 20
    s_cselect_b32 s59, 20, 0
    s_sub_u32 s58, s58, s59
    s_mul_i32 s58, s58, 122880
    s_add_u32 s75, s58, s61
    s_bitcmp1_b32 s3, 0
    s_mov_b32 s58, 0x43765210
    s_cselect_b32 s58, 0x43276510, s58
    s_mov_b32 s59, 0x00400000
    s_cselect_b32 s59, 0x00088400, s59
    s_lshl_b32 s56, s4, 2
    s_lshr_b32 s58, s58, s56
    s_and_b32 s0, s58, 7
    s_lshr_b32 s59, s59, s56
    s_and_b32 s1, s59, 15
    s_bfe_u32 s59, s3, 0x20001
    s_add_u32 s1, s1, s59
    s_and_b32 s59, s2, 7
    s_mul_i32 s70, s59, 6
    s_mul_i32 s59, s59, 5
    s_add_u32 s59, s59, 42
    s_cmp_lt_u32 s1, 6
    s_cselect_b32 s70, s70, s59
    s_add_u32 s70, s70, s1
    s_cmp_eq_u32 s1, 11
    s_cselect_b32 s70, 88, s70
    s_mov_b32 s12, s34
    s_and_b32 s13, s35, 0xffff
    s_mov_b32 s14, 2457600
    s_mov_b32 s15, 0x20000
    s_mov_b32 s16, s54
    s_and_b32 s17, s55, 0xffff
    s_mov_b32 s18, 7776256
    s_mov_b32 s19, 0x20000
    s_mov_b32 s20, s36
    s_and_b32 s21, s37, 0xffff
    s_mov_b32 s22, 25600
    s_mov_b32 s23, 0x20000
    v_bfe_u32 v14, v1, 2, 2
    v_mul_u32_u24_e64 v14, 40, v14
    v_mul_u32_u24 v15, 800, v3
    v_add_u32 v14, v14, v15
    v_and_b32 v15, 3, v1
    v_cmp_eq_u32_e64 vcc, v15, v3
    v_mov_b32 v15, 3200
    s_nop 0
    v_cndmask_b32 v14, v15, v14, vcc
    v_add_u32 v86, 155648, v14
    s_lshl_b32 s58, s6, 6
    v_add_u32 v14, s58, v1
    v_lshlrev_b32_e64 v84, 4, v14
    v_cmp_gt_u32 vcc, 200, v14
    v_mov_b32 v15, 0x7ff00000
    s_nop 0
    v_cndmask_b32 v84, v15, v84, vcc
    s_min_u32 s74, s0, 4
    v_lshrrev_b32 v16, 5, v1
    v_lshlrev_b32_e64 v85, 5, v16
    s_lshr_b32 s59, s6, 1
    s_lshl1_add_u32 s58, s74, s59
    s_sub_u32 s58, s58, s7
    s_cselect_b32 s59, 10, 0
    s_add_u32 s58, s58, s59
    s_lshl_b32 s58, s58, 11
    s_add_u32 s58, s58, 61440
    s_and_b32 s59, s6, 1
    s_lshl_b32 s59, s59, 2
    v_lshl_add_u32 v16, v16, 1, s59
    v_lshrrev_b32 v17, 1, v2
    v_xor_b32 v16, v16, v17
    v_lshlrev_b32_e64 v16, 4, v16
    v_lshl_add_u32 v16, v2, 7, v16
    v_and_b32_e64 v17, 1, v3
    v_mul_u32_u24 v17, 20480, v17
    v_add3_u32 v10, v16, v17, s58
    v_xor_b32 v11, 16, v10
    v_lshrrev_b32 v14, 5, v1
    v_bfe_u32 v15, v1, 2, 2
    v_lshl_add_u32 v14, v14, 3, v15
    s_lshl_b32 s58, s6, 6
    v_add_u32 v14, s58, v14
    v_and_b32 v15, 1, v3
    v_and_b32 v16, 3, v1
    v_lshl_add_u32 v15, v15, 2, v16
    v_and_b32 v16, 1, v15
    v_mul_u32_u24 v16, 40, v16
    v_mul_u32_u24 v17, 80, v14
    v_add_u32_e64 v16, v16, v17
    v_add_u32 v21, 61472, v16
    v_lshrrev_b32_e64 v17, 1, v15
    v_lshl_add_u32 v16, v17, 3, v16
    v_add_u32 v20, 61440, v16
    v_min_u32 v15, 5, v15
    v_mul_u32_u24 v14, 48, v14
    v_lshl_add_u32 v14, v15, 3, v14
    v_add_u32 v22, 143360, v14
    s_lshl_b32 s58, s6, 4
    v_lshl_add_u32 v14, v3, 6, v2
    v_add_u32 v14, s58, v14
    v_mul_u32_u24 v14, 80, v14
    v_add_u32 v23, 61440, v14
    s_mul_i32 s58, s6, 3072
    s_add_u32 s58, s58, 143360
    v_lshl_add_u32 v19, v1, 4, s58
    v_and_b32 v14, 31, v1
    v_lshrrev_b32 v15, 5, v1
    v_mad_u32_u24 v14, v15, 24, v14
    v_lshlrev_b32 v18, 4, v14
    s_lshl2_add_u32 s71, s4, s6
    s_mul_i32 s71, s71, 98304
    s_mul_i32 s59, s3, 768
    s_add_u32 s71, s71, s59
    s_add_u32 s71, s71, 65536
    s_mov_b32 s24, s42
    s_and_b32 s25, s43, 0xffff
    s_mov_b32 s26, 1280
    s_mov_b32 s27, 0x20000
    s_branch L_E1
    .p2align 12
pg_1:
    s_waitcnt vmcnt(6)
    ds_read_b128 v[72:75], v20 offset:12288
    ds_read_b128 v[76:79], v21 offset:12288
    s_waitcnt lgkmcnt(2)
    v_dot2c_f32_bf16 v14, s66, v64
    v_dot2c_f32_bf16 v16, v64, v64
    v_dot2c_f32_bf16 v14, s66, v65
    v_dot2c_f32_bf16 v16, v65, v65
    v_dot2c_f32_bf16 v14, s66, v66
    v_dot2c_f32_bf16 v16, v66, v66
    v_dot2c_f32_bf16 v14, s66, v67
    v_dot2c_f32_bf16 v16, v67, v67
    v_dot2c_f32_bf16 v14, s66, v68
    v_dot2c_f32_bf16 v16, v68, v68
    v_dot2c_f32_bf16 v14, s66, v69
    v_dot2c_f32_bf16 v16, v69, v69
    v_dot2c_f32_bf16 v14, s66, v70
    v_dot2c_f32_bf16 v16, v70, v70
    v_dot2c_f32_bf16 v14, s66, v71
    v_dot2c_f32_bf16 v16, v71, v71
    s_waitcnt vmcnt(4)
    ds_read_b128 v[80:83], v20 offset:14336
    ds_read_b128 v[84:87], v21 offset:14336
    s_waitcnt lgkmcnt(2)
    v_dot2c_f32_bf16 v14, s66, v72
    v_dot2c_f32_bf16 v16, v72, v72
    v_dot2c_f32_bf16 v14, s66, v73
    v_dot2c_f32_bf16 v16, v73, v73
    v_dot2c_f32_bf16 v14, s66, v74
    v_dot2c_f32_bf16 v16, v74, v74
    v_dot2c_f32_bf16 v14, s66, v75
    v_dot2c_f32_bf16 v16, v75, v75
    v_dot2c_f32_bf16 v14, s66, v76
    v_dot2c_f32_bf16 v16, v76, v76
    v_dot2c_f32_bf16 v14, s66, v77
    v_dot2c_f32_bf16 v16, v77, v77
    v_dot2c_f32_bf16 v14, s66, v78
    v_dot2c_f32_bf16 v16, v78, v78
    v_dot2c_f32_bf16 v14, s66, v79
    v_dot2c_f32_bf16 v16, v79, v79
    s_waitcnt vmcnt(2)
    ds_read_b128 v[88:91], v20 offset:16384
    ds_read_b128 v[92:95], v21 offset:16384
    s_waitcnt lgkmcnt(2)
    v_dot2c_f32_bf16 v14, s66, v80
    v_dot2c_f32_bf16 v16, v80, v80
    v_dot2c_f32_bf16 v14, s66, v81
    v_dot2c_f32_bf16 v16, v81, v81
    v_dot2c_f32_bf16 v14, s66, v82
    v_dot2c_f32_bf16 v16, v82, v82
    v_dot2c_f32_bf16 v14, s66, v83
    v_dot2c_f32_bf16 v16, v83, v83
    v_dot2c_f32_bf16 v14, s66, v84
    v_dot2c_f32_bf16 v16, v84, v84
    v_dot2c_f32_bf16 v14, s66, v85
    v_dot2c_f32_bf16 v16, v85, v85
    v_dot2c_f32_bf16 v14, s66, v86
    v_dot2c_f32_bf16 v16, v86, v86
    v_dot2c_f32_bf16 v14, s66, v87
    v_dot2c_f32_bf16 v16, v87, v87
    s_waitcnt vmcnt(0)
    ds_read_b128 v[96:99], v20 offset:18432
    ds_read_b128 v[100:103], v21 offset:18432
    ds_write_b32 v12, v12 offset:528
    s_waitcnt lgkmcnt(3)
    v_dot2c_f32_bf16 v14, s66, v88
    v_dot2c_f32_bf16 v16, v88, v88
    v_dot2c_f32_bf16 v14, s66, v89
    v_dot2c_f32_bf16 v16, v89, v89
    v_dot2c_f32_bf16 v14, s66, v90
    v_dot2c_f32_bf16 v16, v90, v90
    v_dot2c_f32_bf16 v14, s66, v91
    v_dot2c_f32_bf16 v16, v91, v91
    v_dot2c_f32_bf16 v14, s66, v92
    v_dot2c_f32_bf16 v16, v92, v92
    v_dot2c_f32_bf16 v14, s66, v93
    v_dot2c_f32_bf16 v16, v93, v93
    v_dot2c_f32_bf16 v14, s66, v94
    v_dot2c_f32_bf16 v16, v94, v94
    v_dot2c_f32_bf16 v14, s66, v95
    v_dot2c_f32_bf16 v16, v95, v95
    s_waitcnt lgkmcnt(1)
    v_dot2c_f32_bf16 v14, s66, v96
    v_dot2c_f32_bf16 v16, v96, v96
    v_dot2c_f32_bf16 v14, s66, v97
    v_dot2c_f32_bf16 v16, v97, v97
    v_dot2c_f32_bf16 v14, s66, v98
    v_dot2c_f32_bf16 v16, v98, v98
    v_dot2c_f32_bf16 v14, s66, v99
    v_dot2c_f32_bf16 v16, v99, v99
    v_dot2c_f32_bf16 v14, s66, v100
    v_dot2c_f32_bf16 v16, v100, v100
    v_dot2c_f32_bf16 v14, s66, v101
    v_dot2c_f32_bf16 v16, v101, v101
    v_dot2c_f32_bf16 v14, s66, v102
    v_dot2c_f32_bf16 v16, v102, v102
    v_dot2c_f32_bf16 v14, s66, v103
    v_dot2c_f32_bf16 v16, v103, v103
    s_load_dword s28, s[54:55], 12
    s_nop 1
    v_permlane32_swap_b32 v14, v16
    v_add_f32 v14, v14, v16
    v_mov_b32 v16, v14
    s_nop 1
    v_permlane16_swap_b32 v14, v16
    v_add_f32 v14, v14, v16
    v_mov_b32_e64 v16, v14
    s_nop 1
    v_permlane32_swap_b32 v14, v16
    v_mul_f32 v14, 0xbacccccd, v14
    v_mul_f32 v16, 0x3acccccd, v16
    v_fma_f32 v15, -v14, v14, v16
    v_max_f32_e64 v15, 0, v15
    v_cvt_pk_bf16_f32 v15, 0, v15
    v_add_f32 v15, 0x3727c5ac, v15
    v_cvt_pk_bf16_f32 v15, 0, v15
    v_sqrt_f32_e64 v15, v15
    v_cvt_pk_bf16_f32 v18, 0, v14
    v_cvt_pk_bf16_f32 v15, 0, v15
    v_rcp_f32_e64 v19, v15
    v_dot2_f32_bf16 v136, v24, s72, v18
    v_dot2_f32_bf16 v137, v24, s73, v18
    v_dot2_f32_bf16 v138, v25, s72, v18
    v_dot2_f32_bf16 v139, v25, s73, v18
    v_dot2_f32_bf16 v140, v26, s72, v18
    v_dot2_f32_bf16 v141, v26, s73, v18
    v_dot2_f32_bf16 v142, v27, s72, v18
    v_dot2_f32_bf16 v143, v27, s73, v18
    v_cvt_pk_bf16_f32 v136, 0, v136
    v_cvt_pk_bf16_f32 v137, 0, v137
    v_cvt_pk_bf16_f32 v138, 0, v138
    v_cvt_pk_bf16_f32 v139, 0, v139
    v_cvt_pk_bf16_f32 v140, 0, v140
    v_cvt_pk_bf16_f32 v141, 0, v141
    v_cvt_pk_bf16_f32 v142, 0, v142
    v_cvt_pk_bf16_f32 v143, 0, v143
    v_pk_mul_f32 v[136:137], v[136:137], v[18:19] op_sel:[0,1] op_sel_hi:[1,1]
    v_pk_mul_f32 v[138:139], v[138:139], v[18:19] op_sel:[0,1] op_sel_hi:[1,1]
    v_pk_mul_f32 v[140:141], v[140:141], v[18:19] op_sel:[0,1] op_sel_hi:[1,1]
    v_pk_mul_f32 v[142:143], v[142:143], v[18:19] op_sel:[0,1] op_sel_hi:[1,1]
    v_cvt_pk_bf16_f32 v24, v136, v137
    v_cvt_pk_bf16_f32 v25, v138, v139
    v_cvt_pk_bf16_f32 v26, v140, v141
    v_cvt_pk_bf16_f32 v27, v142, v143
    v_dot2_f32_bf16 v144, v28, s72, v18
    v_dot2_f32_bf16 v145, v28, s73, v18
    v_dot2_f32_bf16 v146, v29, s72, v18
    v_dot2_f32_bf16 v147, v29, s73, v18
    v_dot2_f32_bf16 v148, v30, s72, v18
    v_dot2_f32_bf16 v149, v30, s73, v18
    v_dot2_f32_bf16 v150, v31, s72, v18
    v_dot2_f32_bf16 v151, v31, s73, v18
    v_cvt_pk_bf16_f32 v144, 0, v144
    v_cvt_pk_bf16_f32 v145, 0, v145
    v_cvt_pk_bf16_f32 v146, 0, v146
    v_cvt_pk_bf16_f32 v147, 0, v147
    v_cvt_pk_bf16_f32 v148, 0, v148
    v_cvt_pk_bf16_f32 v149, 0, v149
    v_cvt_pk_bf16_f32 v150, 0, v150
    v_cvt_pk_bf16_f32 v151, 0, v151
    v_pk_mul_f32 v[144:145], v[144:145], v[18:19] op_sel:[0,1] op_sel_hi:[1,1]
    v_pk_mul_f32 v[146:147], v[146:147], v[18:19] op_sel:[0,1] op_sel_hi:[1,1]
    v_pk_mul_f32 v[148:149], v[148:149], v[18:19] op_sel:[0,1] op_sel_hi:[1,1]
    v_pk_mul_f32 v[150:151], v[150:151], v[18:19] op_sel:[0,1] op_sel_hi:[1,1]
    v_cvt_pk_bf16_f32 v28, v144, v145
    v_cvt_pk_bf16_f32 v29, v146, v147
    v_cvt_pk_bf16_f32 v30, v148, v149
    v_cvt_pk_bf16_f32 v31, v150, v151
    v_dot2_f32_bf16 v136, v32, s72, v18
    v_dot2_f32_bf16 v137, v32, s73, v18
    v_dot2_f32_bf16 v138, v33, s72, v18
    v_dot2_f32_bf16 v139, v33, s73, v18
    v_dot2_f32_bf16 v140, v34, s72, v18
    v_dot2_f32_bf16 v141, v34, s73, v18
    v_dot2_f32_bf16 v142, v35, s72, v18
    v_dot2_f32_bf16 v143, v35, s73, v18
    v_cvt_pk_bf16_f32 v136, 0, v136
    v_cvt_pk_bf16_f32 v137, 0, v137
    v_cvt_pk_bf16_f32 v138, 0, v138
    v_cvt_pk_bf16_f32 v139, 0, v139
    v_cvt_pk_bf16_f32 v140, 0, v140
    v_cvt_pk_bf16_f32 v141, 0, v141
    v_cvt_pk_bf16_f32 v142, 0, v142
    v_cvt_pk_bf16_f32 v143, 0, v143
    v_pk_mul_f32 v[136:137], v[136:137], v[18:19] op_sel:[0,1] op_sel_hi:[1,1]
    v_pk_mul_f32 v[138:139], v[138:139], v[18:19] op_sel:[0,1] op_sel_hi:[1,1]
    v_pk_mul_f32 v[140:141], v[140:141], v[18:19] op_sel:[0,1] op_sel_hi:[1,1]
    v_pk_mul_f32 v[142:143], v[142:143], v[18:19] op_sel:[0,1] op_sel_hi:[1,1]
    v_cvt_pk_bf16_f32 v32, v136, v137
    v_cvt_pk_bf16_f32 v33, v138, v139
    v_cvt_pk_bf16_f32 v34, v140, v141
    v_cvt_pk_bf16_f32 v35, v142, v143
    v_dot2_f32_bf16 v144, v36, s72, v18
    v_dot2_f32_bf16 v145, v36, s73, v18
    v_dot2_f32_bf16 v146, v37, s72, v18
    v_dot2_f32_bf16 v147, v37, s73, v18
    v_dot2_f32_bf16 v148, v38, s72, v18
    v_dot2_f32_bf16 v149, v38, s73, v18
    v_dot2_f32_bf16 v150, v39, s72, v18
    v_dot2_f32_bf16 v151, v39, s73, v18
    v_cvt_pk_bf16_f32 v144, 0, v144
    v_cvt_pk_bf16_f32 v145, 0, v145
    v_cvt_pk_bf16_f32 v146, 0, v146
    v_cvt_pk_bf16_f32 v147, 0, v147
    v_cvt_pk_bf16_f32 v148, 0, v148
    v_cvt_pk_bf16_f32 v149, 0, v149
    v_cvt_pk_bf16_f32 v150, 0, v150
    v_cvt_pk_bf16_f32 v151, 0, v151
    v_pk_mul_f32 v[144:145], v[144:145], v[18:19] op_sel:[0,1] op_sel_hi:[1,1]
    v_pk_mul_f32 v[146:147], v[146:147], v[18:19] op_sel:[0,1] op_sel_hi:[1,1]
    v_pk_mul_f32 v[148:149], v[148:149], v[18:19] op_sel:[0,1] op_sel_hi:[1,1]
    v_pk_mul_f32 v[150:151], v[150:151], v[18:19] op_sel:[0,1] op_sel_hi:[1,1]
    v_cvt_pk_bf16_f32 v36, v144, v145
    v_cvt_pk_bf16_f32 v37, v146, v147
    v_cvt_pk_bf16_f32 v38, v148, v149
    v_cvt_pk_bf16_f32 v39, v150, v151
    v_dot2_f32_bf16 v136, v40, s72, v18
    v_dot2_f32_bf16 v137, v40, s73, v18
    v_dot2_f32_bf16 v138, v41, s72, v18
    v_dot2_f32_bf16 v139, v41, s73, v18
    v_dot2_f32_bf16 v140, v42, s72, v18
    v_dot2_f32_bf16 v141, v42, s73, v18
    v_dot2_f32_bf16 v142, v43, s72, v18
    v_dot2_f32_bf16 v143, v43, s73, v18
    v_cvt_pk_bf16_f32 v136, 0, v136
    v_cvt_pk_bf16_f32 v137, 0, v137
    v_cvt_pk_bf16_f32 v138, 0, v138
    v_cvt_pk_bf16_f32 v139, 0, v139
    v_cvt_pk_bf16_f32 v140, 0, v140
    v_cvt_pk_bf16_f32 v141, 0, v141
    v_cvt_pk_bf16_f32 v142, 0, v142
    v_cvt_pk_bf16_f32 v143, 0, v143
    v_pk_mul_f32 v[136:137], v[136:137], v[18:19] op_sel:[0,1] op_sel_hi:[1,1]
    v_pk_mul_f32 v[138:139], v[138:139], v[18:19] op_sel:[0,1] op_sel_hi:[1,1]
    v_pk_mul_f32 v[140:141], v[140:141], v[18:19] op_sel:[0,1] op_sel_hi:[1,1]
    v_pk_mul_f32 v[142:143], v[142:143], v[18:19] op_sel:[0,1] op_sel_hi:[1,1]
    v_cvt_pk_bf16_f32 v40, v136, v137
    v_cvt_pk_bf16_f32 v41, v138, v139
    v_cvt_pk_bf16_f32 v42, v140, v141
    v_cvt_pk_bf16_f32 v43, v142, v143
    v_dot2_f32_bf16 v144, v44, s72, v18
    v_dot2_f32_bf16 v145, v44, s73, v18
    v_dot2_f32_bf16 v146, v45, s72, v18
    v_dot2_f32_bf16 v147, v45, s73, v18
    v_dot2_f32_bf16 v148, v46, s72, v18
    v_dot2_f32_bf16 v149, v46, s73, v18
    v_dot2_f32_bf16 v150, v47, s72, v18
    v_dot2_f32_bf16 v151, v47, s73, v18
    v_cvt_pk_bf16_f32 v144, 0, v144
    v_cvt_pk_bf16_f32 v145, 0, v145
    v_cvt_pk_bf16_f32 v146, 0, v146
    v_cvt_pk_bf16_f32 v147, 0, v147
    v_cvt_pk_bf16_f32 v148, 0, v148
    v_cvt_pk_bf16_f32 v149, 0, v149
    v_cvt_pk_bf16_f32 v150, 0, v150
    v_cvt_pk_bf16_f32 v151, 0, v151
    v_pk_mul_f32 v[144:145], v[144:145], v[18:19] op_sel:[0,1] op_sel_hi:[1,1]
    v_pk_mul_f32 v[146:147], v[146:147], v[18:19] op_sel:[0,1] op_sel_hi:[1,1]
    v_pk_mul_f32 v[148:149], v[148:149], v[18:19] op_sel:[0,1] op_sel_hi:[1,1]
    v_pk_mul_f32 v[150:151], v[150:151], v[18:19] op_sel:[0,1] op_sel_hi:[1,1]
    v_cvt_pk_bf16_f32 v44, v144, v145
    v_cvt_pk_bf16_f32 v45, v146, v147
    v_cvt_pk_bf16_f32 v46, v148, v149
    v_cvt_pk_bf16_f32 v47, v150, v151
    v_dot2_f32_bf16 v136, v48, s72, v18
    v_dot2_f32_bf16 v137, v48, s73, v18
    v_dot2_f32_bf16 v138, v49, s72, v18
    v_dot2_f32_bf16 v139, v49, s73, v18
    v_dot2_f32_bf16 v140, v50, s72, v18
    v_dot2_f32_bf16 v141, v50, s73, v18
    v_dot2_f32_bf16 v142, v51, s72, v18
    v_dot2_f32_bf16 v143, v51, s73, v18
    v_cvt_pk_bf16_f32 v136, 0, v136
    v_cvt_pk_bf16_f32 v137, 0, v137
    v_cvt_pk_bf16_f32 v138, 0, v138
    v_cvt_pk_bf16_f32 v139, 0, v139
    v_cvt_pk_bf16_f32 v140, 0, v140
    v_cvt_pk_bf16_f32 v141, 0, v141
    v_cvt_pk_bf16_f32 v142, 0, v142
    v_cvt_pk_bf16_f32 v143, 0, v143
    v_pk_mul_f32 v[136:137], v[136:137], v[18:19] op_sel:[0,1] op_sel_hi:[1,1]
    v_pk_mul_f32 v[138:139], v[138:139], v[18:19] op_sel:[0,1] op_sel_hi:[1,1]
    v_pk_mul_f32 v[140:141], v[140:141], v[18:19] op_sel:[0,1] op_sel_hi:[1,1]
    v_pk_mul_f32 v[142:143], v[142:143], v[18:19] op_sel:[0,1] op_sel_hi:[1,1]
    v_cvt_pk_bf16_f32 v48, v136, v137
    v_cvt_pk_bf16_f32 v49, v138, v139
    v_cvt_pk_bf16_f32 v50, v140, v141
    v_cvt_pk_bf16_f32 v51, v142, v143
    v_dot2_f32_bf16 v144, v52, s72, v18
    v_dot2_f32_bf16 v145, v52, s73, v18
    v_dot2_f32_bf16 v146, v53, s72, v18
    v_dot2_f32_bf16 v147, v53, s73, v18
    v_dot2_f32_bf16 v148, v54, s72, v18
    v_dot2_f32_bf16 v149, v54, s73, v18
    v_dot2_f32_bf16 v150, v55, s72, v18
    v_dot2_f32_bf16 v151, v55, s73, v18
    v_cvt_pk_bf16_f32 v144, 0, v144
    v_cvt_pk_bf16_f32 v145, 0, v145
    v_cvt_pk_bf16_f32 v146, 0, v146
    v_cvt_pk_bf16_f32 v147, 0, v147
    v_cvt_pk_bf16_f32 v148, 0, v148
    v_cvt_pk_bf16_f32 v149, 0, v149
    v_cvt_pk_bf16_f32 v150, 0, v150
    v_cvt_pk_bf16_f32 v151, 0, v151
    v_pk_mul_f32 v[144:145], v[144:145], v[18:19] op_sel:[0,1] op_sel_hi:[1,1]
    v_pk_mul_f32 v[146:147], v[146:147], v[18:19] op_sel:[0,1] op_sel_hi:[1,1]
    v_pk_mul_f32 v[148:149], v[148:149], v[18:19] op_sel:[0,1] op_sel_hi:[1,1]
    v_pk_mul_f32 v[150:151], v[150:151], v[18:19] op_sel:[0,1] op_sel_hi:[1,1]
    v_cvt_pk_bf16_f32 v52, v144, v145
    v_cvt_pk_bf16_f32 v53, v146, v147
    v_cvt_pk_bf16_f32 v54, v148, v149
    v_cvt_pk_bf16_f32 v55, v150, v151
    v_dot2_f32_bf16 v136, v56, s72, v18
    v_dot2_f32_bf16 v137, v56, s73, v18
    v_dot2_f32_bf16 v138, v57, s72, v18
    v_dot2_f32_bf16 v139, v57, s73, v18
    v_dot2_f32_bf16 v140, v58, s72, v18
    v_dot2_f32_bf16 v141, v58, s73, v18
    v_dot2_f32_bf16 v142, v59, s72, v18
    v_dot2_f32_bf16 v143, v59, s73, v18
    v_cvt_pk_bf16_f32 v136, 0, v136
    v_cvt_pk_bf16_f32 v137, 0, v137
    v_cvt_pk_bf16_f32 v138, 0, v138
    v_cvt_pk_bf16_f32 v139, 0, v139
    v_cvt_pk_bf16_f32 v140, 0, v140
    v_cvt_pk_bf16_f32 v141, 0, v141
    v_cvt_pk_bf16_f32 v142, 0, v142
    v_cvt_pk_bf16_f32 v143, 0, v143
    v_pk_mul_f32 v[136:137], v[136:137], v[18:19] op_sel:[0,1] op_sel_hi:[1,1]
    v_pk_mul_f32 v[138:139], v[138:139], v[18:19] op_sel:[0,1] op_sel_hi:[1,1]
    v_pk_mul_f32 v[140:141], v[140:141], v[18:19] op_sel:[0,1] op_sel_hi:[1,1]
    v_pk_mul_f32 v[142:143], v[142:143], v[18:19] op_sel:[0,1] op_sel_hi:[1,1]
    v_cvt_pk_bf16_f32 v56, v136, v137
    v_cvt_pk_bf16_f32 v57, v138, v139
    v_cvt_pk_bf16_f32 v58, v140, v141
    v_cvt_pk_bf16_f32 v59, v142, v143
    v_dot2_f32_bf16 v144, v60, s72, v18
    v_dot2_f32_bf16 v145, v60, s73, v18
    v_dot2_f32_bf16 v146, v61, s72, v18
    v_dot2_f32_bf16 v147, v61, s73, v18
    v_dot2_f32_bf16 v148, v62, s72, v18
    v_dot2_f32_bf16 v149, v62, s73, v18
    v_dot2_f32_bf16 v150, v63, s72, v18
    v_dot2_f32_bf16 v151, v63, s73, v18
    v_cvt_pk_bf16_f32 v144, 0, v144
    v_cvt_pk_bf16_f32 v145, 0, v145
    v_cvt_pk_bf16_f32 v146, 0, v146
    v_cvt_pk_bf16_f32 v147, 0, v147
    v_cvt_pk_bf16_f32 v148, 0, v148
    v_cvt_pk_bf16_f32 v149, 0, v149
    v_cvt_pk_bf16_f32 v150, 0, v150
    v_cvt_pk_bf16_f32 v151, 0, v151
    v_pk_mul_f32 v[144:145], v[144:145], v[18:19] op_sel:[0,1] op_sel_hi:[1,1]
    v_pk_mul_f32 v[146:147], v[146:147], v[18:19] op_sel:[0,1] op_sel_hi:[1,1]
    v_pk_mul_f32 v[148:149], v[148:149], v[18:19] op_sel:[0,1] op_sel_hi:[1,1]
    v_pk_mul_f32 v[150:151], v[150:151], v[18:19] op_sel:[0,1] op_sel_hi:[1,1]
    v_cvt_pk_bf16_f32 v60, v144, v145
    v_cvt_pk_bf16_f32 v61, v146, v147
    v_cvt_pk_bf16_f32 v62, v148, v149
    v_cvt_pk_bf16_f32 v63, v150, v151
    v_dot2_f32_bf16 v136, v64, s72, v18
    v_dot2_f32_bf16 v137, v64, s73, v18
    v_dot2_f32_bf16 v138, v65, s72, v18
    v_dot2_f32_bf16 v139, v65, s73, v18
    v_dot2_f32_bf16 v140, v66, s72, v18
    v_dot2_f32_bf16 v141, v66, s73, v18
    v_dot2_f32_bf16 v142, v67, s72, v18
    v_dot2_f32_bf16 v143, v67, s73, v18
    v_cvt_pk_bf16_f32 v136, 0, v136
    v_cvt_pk_bf16_f32 v137, 0, v137
    v_cvt_pk_bf16_f32 v138, 0, v138
    v_cvt_pk_bf16_f32 v139, 0, v139
    v_cvt_pk_bf16_f32 v140, 0, v140
    v_cvt_pk_bf16_f32 v141, 0, v141
    v_cvt_pk_bf16_f32 v142, 0, v142
    v_cvt_pk_bf16_f32 v143, 0, v143
    v_pk_mul_f32 v[136:137], v[136:137], v[18:19] op_sel:[0,1] op_sel_hi:[1,1]
    v_pk_mul_f32 v[138:139], v[138:139], v[18:19] op_sel:[0,1] op_sel_hi:[1,1]
    v_pk_mul_f32 v[140:141], v[140:141], v[18:19] op_sel:[0,1] op_sel_hi:[1,1]
    v_pk_mul_f32 v[142:143], v[142:143], v[18:19] op_sel:[0,1] op_sel_hi:[1,1]
    v_cvt_pk_bf16_f32 v64, v136, v137
    v_cvt_pk_bf16_f32 v65, v138, v139
    v_cvt_pk_bf16_f32 v66, v140, v141
    v_cvt_pk_bf16_f32 v67, v142, v143
    v_dot2_f32_bf16 v144, v68, s72, v18
    v_dot2_f32_bf16 v145, v68, s73, v18
    v_dot2_f32_bf16 v146, v69, s72, v18
    v_dot2_f32_bf16 v147, v69, s73, v18
    v_dot2_f32_bf16 v148, v70, s72, v18
    v_dot2_f32_bf16 v149, v70, s73, v18
    v_dot2_f32_bf16 v150, v71, s72, v18
    v_dot2_f32_bf16 v151, v71, s73, v18
    v_cvt_pk_bf16_f32 v144, 0, v144
    v_cvt_pk_bf16_f32 v145, 0, v145
    v_cvt_pk_bf16_f32 v146, 0, v146
    v_cvt_pk_bf16_f32 v147, 0, v147
    v_cvt_pk_bf16_f32 v148, 0, v148
    v_cvt_pk_bf16_f32 v149, 0, v149
    v_cvt_pk_bf16_f32 v150, 0, v150
    v_cvt_pk_bf16_f32 v151, 0, v151
    v_pk_mul_f32 v[144:145], v[144:145], v[18:19] op_sel:[0,1] op_sel_hi:[1,1]
    v_pk_mul_f32 v[146:147], v[146:147], v[18:19] op_sel:[0,1] op_sel_hi:[1,1]
    v_pk_mul_f32 v[148:149], v[148:149], v[18:19] op_sel:[0,1] op_sel_hi:[1,1]
    v_pk_mul_f32 v[150:151], v[150:151], v[18:19] op_sel:[0,1] op_sel_hi:[1,1]
    v_cvt_pk_bf16_f32 v68, v144, v145
    v_cvt_pk_bf16_f32 v69, v146, v147
    v_cvt_pk_bf16_f32 v70, v148, v149
    v_cvt_pk_bf16_f32 v71, v150, v151
    v_dot2_f32_bf16 v136, v72, s72, v18
    v_dot2_f32_bf16 v137, v72, s73, v18
    v_dot2_f32_bf16 v138, v73, s72, v18
    v_dot2_f32_bf16 v139, v73, s73, v18
    v_dot2_f32_bf16 v140, v74, s72, v18
    v_dot2_f32_bf16 v141, v74, s73, v18
    v_dot2_f32_bf16 v142, v75, s72, v18
    v_dot2_f32_bf16 v143, v75, s73, v18
    v_cvt_pk_bf16_f32 v136, 0, v136
    v_cvt_pk_bf16_f32 v137, 0, v137
    v_cvt_pk_bf16_f32 v138, 0, v138
    v_cvt_pk_bf16_f32 v139, 0, v139
    v_cvt_pk_bf16_f32 v140, 0, v140
    v_cvt_pk_bf16_f32 v141, 0, v141
    v_cvt_pk_bf16_f32 v142, 0, v142
    v_cvt_pk_bf16_f32 v143, 0, v143
    v_pk_mul_f32 v[136:137], v[136:137], v[18:19] op_sel:[0,1] op_sel_hi:[1,1]
    v_pk_mul_f32 v[138:139], v[138:139], v[18:19] op_sel:[0,1] op_sel_hi:[1,1]
    v_pk_mul_f32 v[140:141], v[140:141], v[18:19] op_sel:[0,1] op_sel_hi:[1,1]
    v_pk_mul_f32 v[142:143], v[142:143], v[18:19] op_sel:[0,1] op_sel_hi:[1,1]
    v_cvt_pk_bf16_f32 v72, v136, v137
    v_cvt_pk_bf16_f32 v73, v138, v139
    v_cvt_pk_bf16_f32 v74, v140, v141
    v_cvt_pk_bf16_f32 v75, v142, v143
    v_dot2_f32_bf16 v144, v76, s72, v18
    v_dot2_f32_bf16 v145, v76, s73, v18
    v_dot2_f32_bf16 v146, v77, s72, v18
    v_dot2_f32_bf16 v147, v77, s73, v18
    v_dot2_f32_bf16 v148, v78, s72, v18
    v_dot2_f32_bf16 v149, v78, s73, v18
    v_dot2_f32_bf16 v150, v79, s72, v18
    v_dot2_f32_bf16 v151, v79, s73, v18
    v_cvt_pk_bf16_f32 v144, 0, v144
    v_cvt_pk_bf16_f32 v145, 0, v145
    v_cvt_pk_bf16_f32 v146, 0, v146
    v_cvt_pk_bf16_f32 v147, 0, v147
    v_cvt_pk_bf16_f32 v148, 0, v148
    v_cvt_pk_bf16_f32 v149, 0, v149
    v_cvt_pk_bf16_f32 v150, 0, v150
    v_cvt_pk_bf16_f32 v151, 0, v151
    v_pk_mul_f32 v[144:145], v[144:145], v[18:19] op_sel:[0,1] op_sel_hi:[1,1]
    v_pk_mul_f32 v[146:147], v[146:147], v[18:19] op_sel:[0,1] op_sel_hi:[1,1]
    v_pk_mul_f32 v[148:149], v[148:149], v[18:19] op_sel:[0,1] op_sel_hi:[1,1]
    v_pk_mul_f32 v[150:151], v[150:151], v[18:19] op_sel:[0,1] op_sel_hi:[1,1]
    v_cvt_pk_bf16_f32 v76, v144, v145
    v_cvt_pk_bf16_f32 v77, v146, v147
    v_cvt_pk_bf16_f32 v78, v148, v149
    v_cvt_pk_bf16_f32 v79, v150, v151
    v_dot2_f32_bf16 v136, v80, s72, v18
    v_dot2_f32_bf16 v137, v80, s73, v18
    v_dot2_f32_bf16 v138, v81, s72, v18
    v_dot2_f32_bf16 v139, v81, s73, v18
    v_dot2_f32_bf16 v140, v82, s72, v18
    v_dot2_f32_bf16 v141, v82, s73, v18
    v_dot2_f32_bf16 v142, v83, s72, v18
    v_dot2_f32_bf16 v143, v83, s73, v18
    v_cvt_pk_bf16_f32 v136, 0, v136
    v_cvt_pk_bf16_f32 v137, 0, v137
    v_cvt_pk_bf16_f32 v138, 0, v138
    v_cvt_pk_bf16_f32 v139, 0, v139
    v_cvt_pk_bf16_f32 v140, 0, v140
    v_cvt_pk_bf16_f32 v141, 0, v141
    v_cvt_pk_bf16_f32 v142, 0, v142
    v_cvt_pk_bf16_f32 v143, 0, v143
    v_pk_mul_f32 v[136:137], v[136:137], v[18:19] op_sel:[0,1] op_sel_hi:[1,1]
    v_pk_mul_f32 v[138:139], v[138:139], v[18:19] op_sel:[0,1] op_sel_hi:[1,1]
    v_pk_mul_f32 v[140:141], v[140:141], v[18:19] op_sel:[0,1] op_sel_hi:[1,1]
    v_pk_mul_f32 v[142:143], v[142:143], v[18:19] op_sel:[0,1] op_sel_hi:[1,1]
    v_cvt_pk_bf16_f32 v80, v136, v137
    v_cvt_pk_bf16_f32 v81, v138, v139
    v_cvt_pk_bf16_f32 v82, v140, v141
    v_cvt_pk_bf16_f32 v83, v142, v143
    v_dot2_f32_bf16 v144, v84, s72, v18
    v_dot2_f32_bf16 v145, v84, s73, v18
    v_dot2_f32_bf16 v146, v85, s72, v18
    v_dot2_f32_bf16 v147, v85, s73, v18
    v_dot2_f32_bf16 v148, v86, s72, v18
    v_dot2_f32_bf16 v149, v86, s73, v18
    v_dot2_f32_bf16 v150, v87, s72, v18
    v_dot2_f32_bf16 v151, v87, s73, v18
    v_cvt_pk_bf16_f32 v144, 0, v144
    v_cvt_pk_bf16_f32 v145, 0, v145
    v_cvt_pk_bf16_f32 v146, 0, v146
    v_cvt_pk_bf16_f32 v147, 0, v147
    v_cvt_pk_bf16_f32 v148, 0, v148
    v_cvt_pk_bf16_f32 v149, 0, v149
    v_cvt_pk_bf16_f32 v150, 0, v150
    v_cvt_pk_bf16_f32 v151, 0, v151
    v_pk_mul_f32 v[144:145], v[144:145], v[18:19] op_sel:[0,1] op_sel_hi:[1,1]
    v_pk_mul_f32 v[146:147], v[146:147], v[18:19] op_sel:[0,1] op_sel_hi:[1,1]
    v_pk_mul_f32 v[148:149], v[148:149], v[18:19] op_sel:[0,1] op_sel_hi:[1,1]
    v_pk_mul_f32 v[150:151], v[150:151], v[18:19] op_sel:[0,1] op_sel_hi:[1,1]
    v_cvt_pk_bf16_f32 v84, v144, v145
    v_cvt_pk_bf16_f32 v85, v146, v147
    v_cvt_pk_bf16_f32 v86, v148, v149
    v_cvt_pk_bf16_f32 v87, v150, v151
    v_dot2_f32_bf16 v136, v88, s72, v18
    v_dot2_f32_bf16 v137, v88, s73, v18
    v_dot2_f32_bf16 v138, v89, s72, v18
    v_dot2_f32_bf16 v139, v89, s73, v18
    v_dot2_f32_bf16 v140, v90, s72, v18
    v_dot2_f32_bf16 v141, v90, s73, v18
    v_dot2_f32_bf16 v142, v91, s72, v18
    v_dot2_f32_bf16 v143, v91, s73, v18
    v_cvt_pk_bf16_f32 v136, 0, v136
    v_cvt_pk_bf16_f32 v137, 0, v137
    v_cvt_pk_bf16_f32 v138, 0, v138
    v_cvt_pk_bf16_f32 v139, 0, v139
    v_cvt_pk_bf16_f32 v140, 0, v140
    v_cvt_pk_bf16_f32 v141, 0, v141
    v_cvt_pk_bf16_f32 v142, 0, v142
    v_cvt_pk_bf16_f32 v143, 0, v143
    v_pk_mul_f32 v[136:137], v[136:137], v[18:19] op_sel:[0,1] op_sel_hi:[1,1]
    v_pk_mul_f32 v[138:139], v[138:139], v[18:19] op_sel:[0,1] op_sel_hi:[1,1]
    v_pk_mul_f32 v[140:141], v[140:141], v[18:19] op_sel:[0,1] op_sel_hi:[1,1]
    v_pk_mul_f32 v[142:143], v[142:143], v[18:19] op_sel:[0,1] op_sel_hi:[1,1]
    v_cvt_pk_bf16_f32 v88, v136, v137
    v_cvt_pk_bf16_f32 v89, v138, v139
    v_cvt_pk_bf16_f32 v90, v140, v141
    v_cvt_pk_bf16_f32 v91, v142, v143
    v_dot2_f32_bf16 v144, v92, s72, v18
    v_dot2_f32_bf16 v145, v92, s73, v18
    v_dot2_f32_bf16 v146, v93, s72, v18
    v_dot2_f32_bf16 v147, v93, s73, v18
    v_dot2_f32_bf16 v148, v94, s72, v18
    v_dot2_f32_bf16 v149, v94, s73, v18
    v_dot2_f32_bf16 v150, v95, s72, v18
    v_dot2_f32_bf16 v151, v95, s73, v18
    v_cvt_pk_bf16_f32 v144, 0, v144
    v_cvt_pk_bf16_f32 v145, 0, v145
    v_cvt_pk_bf16_f32 v146, 0, v146
    v_cvt_pk_bf16_f32 v147, 0, v147
    v_cvt_pk_bf16_f32 v148, 0, v148
    v_cvt_pk_bf16_f32 v149, 0, v149
    v_cvt_pk_bf16_f32 v150, 0, v150
    v_cvt_pk_bf16_f32 v151, 0, v151
    v_pk_mul_f32 v[144:145], v[144:145], v[18:19] op_sel:[0,1] op_sel_hi:[1,1]
    v_pk_mul_f32 v[146:147], v[146:147], v[18:19] op_sel:[0,1] op_sel_hi:[1,1]
    v_pk_mul_f32 v[148:149], v[148:149], v[18:19] op_sel:[0,1] op_sel_hi:[1,1]
    v_pk_mul_f32 v[150:151], v[150:151], v[18:19] op_sel:[0,1] op_sel_hi:[1,1]
    v_cvt_pk_bf16_f32 v92, v144, v145
    v_cvt_pk_bf16_f32 v93, v146, v147
    v_cvt_pk_bf16_f32 v94, v148, v149
    v_cvt_pk_bf16_f32 v95, v150, v151
    ds_read_b32 v14, v13 offset:16
    v_dot2_f32_bf16 v136, v96, s72, v18
    v_dot2_f32_bf16 v137, v96, s73, v18
    v_dot2_f32_bf16 v138, v97, s72, v18
    v_dot2_f32_bf16 v139, v97, s73, v18
    v_dot2_f32_bf16 v140, v98, s72, v18
    v_dot2_f32_bf16 v141, v98, s73, v18
    v_dot2_f32_bf16 v142, v99, s72, v18
    v_dot2_f32_bf16 v143, v99, s73, v18
    v_cvt_pk_bf16_f32 v136, 0, v136
    v_cvt_pk_bf16_f32 v137, 0, v137
    v_cvt_pk_bf16_f32 v138, 0, v138
    v_cvt_pk_bf16_f32 v139, 0, v139
    v_cvt_pk_bf16_f32 v140, 0, v140
    v_cvt_pk_bf16_f32 v141, 0, v141
    v_cvt_pk_bf16_f32 v142, 0, v142
    v_cvt_pk_bf16_f32 v143, 0, v143
    v_pk_mul_f32 v[136:137], v[136:137], v[18:19] op_sel:[0,1] op_sel_hi:[1,1]
    v_pk_mul_f32 v[138:139], v[138:139], v[18:19] op_sel:[0,1] op_sel_hi:[1,1]
    v_pk_mul_f32 v[140:141], v[140:141], v[18:19] op_sel:[0,1] op_sel_hi:[1,1]
    v_pk_mul_f32 v[142:143], v[142:143], v[18:19] op_sel:[0,1] op_sel_hi:[1,1]
    v_cvt_pk_bf16_f32 v96, v136, v137
    v_cvt_pk_bf16_f32 v97, v138, v139
    v_cvt_pk_bf16_f32 v98, v140, v141
    v_cvt_pk_bf16_f32 v99, v142, v143
    s_waitcnt lgkmcnt(0)
    v_cmp_eq_u32 vcc, 0, v14
    s_cbranch_vccnz fs_2
fr_3:
    ds_read_b64_tr_b16 v[104:105], v9 offset:0
    ds_read_b64_tr_b16 v[106:107], v9 offset:1280
    ds_read_b64_tr_b16 v[108:109], v9 offset:8
    ds_read_b64_tr_b16 v[110:111], v9 offset:1288
    ds_read_b64_tr_b16 v[112:113], v9 offset:16
    ds_read_b64_tr_b16 v[114:115], v9 offset:1296
    ds_read_b64_tr_b16 v[116:117], v9 offset:24
    ds_read_b64_tr_b16 v[118:119], v9 offset:1304
    ds_read_b64_tr_b16 v[120:121], v9 offset:32
    ds_read_b64_tr_b16 v[122:123], v9 offset:1312
    ds_read_b64_tr_b16 v[124:125], v9 offset:5120
    ds_read_b64_tr_b16 v[126:127], v9 offset:6400
    s_nop 0
    v_dot2_f32_bf16 v144, v100, s72, v18
    v_dot2_f32_bf16 v145, v100, s73, v18
    v_dot2_f32_bf16 v146, v101, s72, v18
    v_dot2_f32_bf16 v147, v101, s73, v18
    v_dot2_f32_bf16 v148, v102, s72, v18
    v_dot2_f32_bf16 v149, v102, s73, v18
    v_dot2_f32_bf16 v150, v103, s72, v18
    v_dot2_f32_bf16 v151, v103, s73, v18
    v_cvt_pk_bf16_f32 v144, 0, v144
    v_cvt_pk_bf16_f32 v145, 0, v145
    v_cvt_pk_bf16_f32 v146, 0, v146
    v_cvt_pk_bf16_f32 v147, 0, v147
    v_cvt_pk_bf16_f32 v148, 0, v148
    v_cvt_pk_bf16_f32 v149, 0, v149
    v_cvt_pk_bf16_f32 v150, 0, v150
    v_cvt_pk_bf16_f32 v151, 0, v151
    v_pk_mul_f32 v[144:145], v[144:145], v[18:19] op_sel:[0,1] op_sel_hi:[1,1]
    v_pk_mul_f32 v[146:147], v[146:147], v[18:19] op_sel:[0,1] op_sel_hi:[1,1]
    v_pk_mul_f32 v[148:149], v[148:149], v[18:19] op_sel:[0,1] op_sel_hi:[1,1]
    v_pk_mul_f32 v[150:151], v[150:151], v[18:19] op_sel:[0,1] op_sel_hi:[1,1]
    v_cvt_pk_bf16_f32 v100, v144, v145
    v_cvt_pk_bf16_f32 v101, v146, v147
    v_cvt_pk_bf16_f32 v102, v148, v149
    v_cvt_pk_bf16_f32 v103, v150, v151
    ds_read_b64_tr_b16 v[128:129], v9 offset:5128
    ds_read_b64_tr_b16 v[130:131], v9 offset:6408
    s_waitcnt lgkmcnt(6)
    v_mfma_f32_16x16x32_bf16 v[136:139], v[104:107], v[24:27], 0
    ds_read_b64_tr_b16 v[132:133], v9 offset:5136
    ds_read_b64_tr_b16 v[134:135], v9 offset:6416
    v_mfma_f32_16x16x32_bf16 v[140:143], v[108:111], v[24:27], 0
    ds_read_b64_tr_b16 v[104:105], v9 offset:5144
    ds_read_b64_tr_b16 v[106:107], v9 offset:6424
    v_mfma_f32_16x16x32_bf16 v[144:147], v[112:115], v[24:27], 0
    ds_read_b64_tr_b16 v[108:109], v9 offset:5152
    ds_read_b64_tr_b16 v[110:111], v9 offset:6432
    v_mfma_f32_16x16x32_bf16 v[148:151], v[116:119], v[24:27], 0
    ds_read_b64_tr_b16 v[112:113], v9 offset:10240
    ds_read_b64_tr_b16 v[114:115], v9 offset:11520
    s_waitcnt lgkmcnt(6)
    v_mfma_f32_16x16x32_bf16 v[152:155], v[120:123], v[24:27], 0
    ds_read_b64_tr_b16 v[116:117], v9 offset:10248
    ds_read_b64_tr_b16 v[118:119], v9 offset:11528
    v_mfma_f32_16x16x32_bf16 v[136:139], v[124:127], v[28:31], v[136:139]
    ds_read_b64_tr_b16 v[120:121], v9 offset:10256
    ds_read_b64_tr_b16 v[122:123], v9 offset:11536
    v_mfma_f32_16x16x32_bf16 v[140:143], v[128:131], v[28:31], v[140:143]
    ds_read_b64_tr_b16 v[124:125], v9 offset:10264
    ds_read_b64_tr_b16 v[126:127], v9 offset:11544
    v_mfma_f32_16x16x32_bf16 v[144:147], v[132:135], v[28:31], v[144:147]
    ds_read_b64_tr_b16 v[128:129], v9 offset:10272
    ds_read_b64_tr_b16 v[130:131], v9 offset:11552
    s_waitcnt lgkmcnt(6)
    v_mfma_f32_16x16x32_bf16 v[148:151], v[104:107], v[28:31], v[148:151]
    ds_read_b64_tr_b16 v[132:133], v9 offset:15360
    ds_read_b64_tr_b16 v[134:135], v9 offset:16640
    v_mfma_f32_16x16x32_bf16 v[152:155], v[108:111], v[28:31], v[152:155]
    ds_read_b64_tr_b16 v[104:105], v9 offset:15368
    ds_read_b64_tr_b16 v[106:107], v9 offset:16648
    v_mfma_f32_16x16x32_bf16 v[136:139], v[112:115], v[32:35], v[136:139]
    ds_read_b64_tr_b16 v[108:109], v9 offset:15376
    ds_read_b64_tr_b16 v[110:111], v9 offset:16656
    v_mfma_f32_16x16x32_bf16 v[140:143], v[116:119], v[32:35], v[140:143]
    ds_read_b64_tr_b16 v[112:113], v9 offset:15384
    ds_read_b64_tr_b16 v[114:115], v9 offset:16664
    s_waitcnt lgkmcnt(6)
    v_mfma_f32_16x16x32_bf16 v[144:147], v[120:123], v[32:35], v[144:147]
    ds_read_b64_tr_b16 v[116:117], v9 offset:15392
    ds_read_b64_tr_b16 v[118:119], v9 offset:16672
    v_mfma_f32_16x16x32_bf16 v[148:151], v[124:127], v[32:35], v[148:151]
    ds_read_b64_tr_b16 v[120:121], v9 offset:20480
    ds_read_b64_tr_b16 v[122:123], v9 offset:21760
    v_mfma_f32_16x16x32_bf16 v[152:155], v[128:131], v[32:35], v[152:155]
    ds_read_b64_tr_b16 v[124:125], v9 offset:20488
    ds_read_b64_tr_b16 v[126:127], v9 offset:21768
    v_mfma_f32_16x16x32_bf16 v[136:139], v[132:135], v[36:39], v[136:139]
    ds_read_b64_tr_b16 v[128:129], v9 offset:20496
    ds_read_b64_tr_b16 v[130:131], v9 offset:21776
    s_waitcnt lgkmcnt(6)
    v_mfma_f32_16x16x32_bf16 v[140:143], v[104:107], v[36:39], v[140:143]
    ds_write_b32 v12, v12 offset:256
    ds_read_b64_tr_b16 v[132:133], v9 offset:20504
    ds_read_b64_tr_b16 v[134:135], v9 offset:21784
    v_mfma_f32_16x16x32_bf16 v[144:147], v[108:111], v[36:39], v[144:147]
    ds_read_b64_tr_b16 v[104:105], v9 offset:20512
    ds_read_b64_tr_b16 v[106:107], v9 offset:21792
    v_mfma_f32_16x16x32_bf16 v[148:151], v[112:115], v[36:39], v[148:151]
    ds_read_b64_tr_b16 v[108:109], v9 offset:25600
    ds_read_b64_tr_b16 v[110:111], v9 offset:26880
    v_mfma_f32_16x16x32_bf16 v[152:155], v[116:119], v[36:39], v[152:155]
    ds_read_b64_tr_b16 v[112:113], v9 offset:25608
    ds_read_b64_tr_b16 v[114:115], v9 offset:26888
    s_waitcnt lgkmcnt(6)
    v_mfma_f32_16x16x32_bf16 v[136:139], v[120:123], v[40:43], v[136:139]
    ds_read_b64_tr_b16 v[116:117], v9 offset:25616
    ds_read_b64_tr_b16 v[118:119], v9 offset:26896
    v_mfma_f32_16x16x32_bf16 v[140:143], v[124:127], v[40:43], v[140:143]
    ds_read_b64_tr_b16 v[120:121], v9 offset:25624
    ds_read_b64_tr_b16 v[122:123], v9 offset:26904
    v_mfma_f32_16x16x32_bf16 v[144:147], v[128:131], v[40:43], v[144:147]
    ds_read_b64_tr_b16 v[124:125], v9 offset:25632
    ds_read_b64_tr_b16 v[126:127], v9 offset:26912
    v_mfma_f32_16x16x32_bf16 v[148:151], v[132:135], v[40:43], v[148:151]
    ds_read_b64_tr_b16 v[128:129], v9 offset:30720
    ds_read_b64_tr_b16 v[130:131], v9 offset:32000
    s_waitcnt lgkmcnt(6)
    v_mfma_f32_16x16x32_bf16 v[152:155], v[104:107], v[40:43], v[152:155]
    ds_read_b64_tr_b16 v[132:133], v9 offset:30728
    ds_read_b64_tr_b16 v[134:135], v9 offset:32008
    v_mfma_f32_16x16x32_bf16 v[136:139], v[108:111], v[44:47], v[136:139]
    ds_read_b64_tr_b16 v[104:105], v9 offset:30736
    ds_read_b64_tr_b16 v[106:107], v9 offset:32016
    v_mfma_f32_16x16x32_bf16 v[140:143], v[112:115], v[44:47], v[140:143]
    ds_read_b64_tr_b16 v[108:109], v9 offset:30744
    ds_read_b64_tr_b16 v[110:111], v9 offset:32024
    v_mfma_f32_16x16x32_bf16 v[144:147], v[116:119], v[44:47], v[144:147]
    ds_read_b64_tr_b16 v[112:113], v9 offset:30752
    ds_read_b64_tr_b16 v[114:115], v9 offset:32032
    s_waitcnt lgkmcnt(6)
    v_mfma_f32_16x16x32_bf16 v[148:151], v[120:123], v[44:47], v[148:151]
    ds_read_b32 v14, v13 offset:32
    ds_read_b64_tr_b16 v[116:117], v9 offset:35840
    ds_read_b64_tr_b16 v[118:119], v9 offset:37120
    v_mfma_f32_16x16x32_bf16 v[152:155], v[124:127], v[44:47], v[152:155]
    ds_read_b64_tr_b16 v[120:121], v9 offset:35848
    ds_read_b64_tr_b16 v[122:123], v9 offset:37128
    v_mfma_f32_16x16x32_bf16 v[136:139], v[128:131], v[48:51], v[136:139]
    ds_read_b64_tr_b16 v[124:125], v9 offset:35856
    ds_read_b64_tr_b16 v[126:127], v9 offset:37136
    v_mfma_f32_16x16x32_bf16 v[140:143], v[132:135], v[48:51], v[140:143]
    ds_read_b64_tr_b16 v[128:129], v9 offset:35864
    ds_read_b64_tr_b16 v[130:131], v9 offset:37144
    s_waitcnt lgkmcnt(6)
    v_cmp_eq_u32 vcc, 0, v14
    v_mfma_f32_16x16x32_bf16 v[144:147], v[104:107], v[48:51], v[144:147]
    ds_read_b64_tr_b16 v[132:133], v9 offset:35872
    ds_read_b64_tr_b16 v[134:135], v9 offset:37152
    v_mfma_f32_16x16x32_bf16 v[148:151], v[108:111], v[48:51], v[148:151]
    s_cbranch_vccnz fs_4
fr_5:
    ds_read_b64_tr_b16 v[104:105], v9 offset:40960
    ds_read_b64_tr_b16 v[106:107], v9 offset:42240
    v_mfma_f32_16x16x32_bf16 v[152:155], v[112:115], v[48:51], v[152:155]
    ds_read_b64_tr_b16 v[108:109], v9 offset:40968
    ds_read_b64_tr_b16 v[110:111], v9 offset:42248
    v_mfma_f32_16x16x32_bf16 v[136:139], v[116:119], v[52:55], v[136:139]
    ds_read_b64_tr_b16 v[112:113], v9 offset:40976
    ds_read_b64_tr_b16 v[114:115], v9 offset:42256
    s_waitcnt lgkmcnt(6)
    v_mfma_f32_16x16x32_bf16 v[140:143], v[120:123], v[52:55], v[140:143]
    ds_write_b32 v12, v12 offset:272
    ds_read_b64_tr_b16 v[116:117], v9 offset:40984
    ds_read_b64_tr_b16 v[118:119], v9 offset:42264
    v_mfma_f32_16x16x32_bf16 v[144:147], v[124:127], v[52:55], v[144:147]
    ds_read_b64_tr_b16 v[120:121], v9 offset:40992
    ds_read_b64_tr_b16 v[122:123], v9 offset:42272
    v_mfma_f32_16x16x32_bf16 v[148:151], v[128:131], v[52:55], v[148:151]
    ds_read_b64_tr_b16 v[124:125], v9 offset:46080
    ds_read_b64_tr_b16 v[126:127], v9 offset:47360
    v_mfma_f32_16x16x32_bf16 v[152:155], v[132:135], v[52:55], v[152:155]
    ds_read_b64_tr_b16 v[128:129], v9 offset:46088
    ds_read_b64_tr_b16 v[130:131], v9 offset:47368
    s_waitcnt lgkmcnt(6)
    v_mfma_f32_16x16x32_bf16 v[136:139], v[104:107], v[56:59], v[136:139]
    ds_read_b64_tr_b16 v[132:133], v9 offset:46096
    ds_read_b64_tr_b16 v[134:135], v9 offset:47376
    v_mfma_f32_16x16x32_bf16 v[140:143], v[108:111], v[56:59], v[140:143]
    ds_read_b64_tr_b16 v[104:105], v9 offset:46104
    ds_read_b64_tr_b16 v[106:107], v9 offset:47384
    v_mfma_f32_16x16x32_bf16 v[144:147], v[112:115], v[56:59], v[144:147]
    ds_read_b64_tr_b16 v[108:109], v9 offset:46112
    ds_read_b64_tr_b16 v[110:111], v9 offset:47392
    v_mfma_f32_16x16x32_bf16 v[148:151], v[116:119], v[56:59], v[148:151]
    ds_read_b64_tr_b16 v[112:113], v9 offset:51200
    ds_read_b64_tr_b16 v[114:115], v9 offset:52480
    s_waitcnt lgkmcnt(6)
    v_mfma_f32_16x16x32_bf16 v[152:155], v[120:123], v[56:59], v[152:155]
    ds_read_b64_tr_b16 v[116:117], v9 offset:51208
    ds_read_b64_tr_b16 v[118:119], v9 offset:52488
    v_mfma_f32_16x16x32_bf16 v[136:139], v[124:127], v[60:63], v[136:139]
    ds_read_b64_tr_b16 v[120:121], v9 offset:51216
    ds_read_b64_tr_b16 v[122:123], v9 offset:52496
    v_mfma_f32_16x16x32_bf16 v[140:143], v[128:131], v[60:63], v[140:143]
    ds_read_b64_tr_b16 v[124:125], v9 offset:51224
    ds_read_b64_tr_b16 v[126:127], v9 offset:52504
    v_mfma_f32_16x16x32_bf16 v[144:147], v[132:135], v[60:63], v[144:147]
    ds_read_b64_tr_b16 v[128:129], v9 offset:51232
    ds_read_b64_tr_b16 v[130:131], v9 offset:52512
    s_waitcnt lgkmcnt(6)
    v_mfma_f32_16x16x32_bf16 v[148:151], v[104:107], v[60:63], v[148:151]
    ds_read_b32 v14, v13 offset:48
    ds_read_b64_tr_b16 v[132:133], v9 offset:56320
    ds_read_b64_tr_b16 v[134:135], v9 offset:57600
    v_mfma_f32_16x16x32_bf16 v[152:155], v[108:111], v[60:63], v[152:155]
    ds_read_b64_tr_b16 v[104:105], v9 offset:56328
    ds_read_b64_tr_b16 v[106:107], v9 offset:57608
    v_mfma_f32_16x16x32_bf16 v[136:139], v[112:115], v[64:67], v[136:139]
    ds_read_b64_tr_b16 v[108:109], v9 offset:56336
    ds_read_b64_tr_b16 v[110:111], v9 offset:57616
    v_mfma_f32_16x16x32_bf16 v[140:143], v[116:119], v[64:67], v[140:143]
    ds_read_b64_tr_b16 v[112:113], v9 offset:56344
    ds_read_b64_tr_b16 v[114:115], v9 offset:57624
    s_waitcnt lgkmcnt(6)
    v_cmp_eq_u32 vcc, 0, v14
    v_mfma_f32_16x16x32_bf16 v[144:147], v[120:123], v[64:67], v[144:147]
    ds_read_b64_tr_b16 v[116:117], v9 offset:56352
    ds_read_b64_tr_b16 v[118:119], v9 offset:57632
    v_mfma_f32_16x16x32_bf16 v[148:151], v[124:127], v[64:67], v[148:151]
    s_cbranch_vccnz fs_6
fr_7:
    ds_read_b64_tr_b16 v[120:121], v10 offset:0
    ds_read_b64_tr_b16 v[122:123], v10 offset:1280
    v_mfma_f32_16x16x32_bf16 v[152:155], v[128:131], v[64:67], v[152:155]
    ds_read_b64_tr_b16 v[124:125], v10 offset:8
    ds_read_b64_tr_b16 v[126:127], v10 offset:1288
    v_mfma_f32_16x16x32_bf16 v[136:139], v[132:135], v[68:71], v[136:139]
    ds_read_b64_tr_b16 v[128:129], v10 offset:16
    ds_read_b64_tr_b16 v[130:131], v10 offset:1296
    s_waitcnt lgkmcnt(6)
    v_mfma_f32_16x16x32_bf16 v[140:143], v[104:107], v[68:71], v[140:143]
    ds_write_b32 v12, v12 offset:288
    ds_read_b64_tr_b16 v[132:133], v10 offset:24
    ds_read_b64_tr_b16 v[134:135], v10 offset:1304
    v_mfma_f32_16x16x32_bf16 v[144:147], v[108:111], v[68:71], v[144:147]
    ds_read_b64_tr_b16 v[104:105], v10 offset:32
    ds_read_b64_tr_b16 v[106:107], v10 offset:1312
    v_mfma_f32_16x16x32_bf16 v[148:151], v[112:115], v[68:71], v[148:151]
    ds_read_b64_tr_b16 v[108:109], v10 offset:5120
    ds_read_b64_tr_b16 v[110:111], v10 offset:6400
    v_mfma_f32_16x16x32_bf16 v[152:155], v[116:119], v[68:71], v[152:155]
    ds_read_b64_tr_b16 v[112:113], v10 offset:5128
    ds_read_b64_tr_b16 v[114:115], v10 offset:6408
    s_waitcnt lgkmcnt(6)
    v_mfma_f32_16x16x32_bf16 v[136:139], v[120:123], v[72:75], v[136:139]
    ds_read_b64_tr_b16 v[116:117], v10 offset:5136
    ds_read_b64_tr_b16 v[118:119], v10 offset:6416
    v_mfma_f32_16x16x32_bf16 v[140:143], v[124:127], v[72:75], v[140:143]
    ds_read_b64_tr_b16 v[120:121], v10 offset:5144
    ds_read_b64_tr_b16 v[122:123], v10 offset:6424
    v_mfma_f32_16x16x32_bf16 v[144:147], v[128:131], v[72:75], v[144:147]
    ds_read_b64_tr_b16 v[124:125], v10 offset:5152
    ds_read_b64_tr_b16 v[126:127], v10 offset:6432
    v_mfma_f32_16x16x32_bf16 v[148:151], v[132:135], v[72:75], v[148:151]
    ds_read_b64_tr_b16 v[128:129], v10 offset:10240
    ds_read_b64_tr_b16 v[130:131], v10 offset:11520
    s_waitcnt lgkmcnt(6)
    v_mfma_f32_16x16x32_bf16 v[152:155], v[104:107], v[72:75], v[152:155]
    ds_read_b64_tr_b16 v[132:133], v10 offset:10248
    ds_read_b64_tr_b16 v[134:135], v10 offset:11528
    v_mfma_f32_16x16x32_bf16 v[136:139], v[108:111], v[76:79], v[136:139]
    ds_read_b64_tr_b16 v[104:105], v10 offset:10256
    ds_read_b64_tr_b16 v[106:107], v10 offset:11536
    v_mfma_f32_16x16x32_bf16 v[140:143], v[112:115], v[76:79], v[140:143]
    ds_read_b64_tr_b16 v[108:109], v10 offset:10264
    ds_read_b64_tr_b16 v[110:111], v10 offset:11544
    v_mfma_f32_16x16x32_bf16 v[144:147], v[116:119], v[76:79], v[144:147]
    ds_read_b64_tr_b16 v[112:113], v10 offset:10272
    ds_read_b64_tr_b16 v[114:115], v10 offset:11552
    s_waitcnt lgkmcnt(6)
    v_mfma_f32_16x16x32_bf16 v[148:151], v[120:123], v[76:79], v[148:151]
    ds_read_b32 v14, v13 offset:64
    ds_read_b64_tr_b16 v[116:117], v10 offset:15360
    ds_read_b64_tr_b16 v[118:119], v10 offset:16640
    v_mfma_f32_16x16x32_bf16 v[152:155], v[124:127], v[76:79], v[152:155]
    ds_read_b64_tr_b16 v[120:121], v10 offset:15368
    ds_read_b64_tr_b16 v[122:123], v10 offset:16648
    v_mfma_f32_16x16x32_bf16 v[136:139], v[128:131], v[80:83], v[136:139]
    ds_read_b64_tr_b16 v[124:125], v10 offset:15376
    ds_read_b64_tr_b16 v[126:127], v10 offset:16656
    v_mfma_f32_16x16x32_bf16 v[140:143], v[132:135], v[80:83], v[140:143]
    ds_read_b64_tr_b16 v[128:129], v10 offset:15384
    ds_read_b64_tr_b16 v[130:131], v10 offset:16664
    s_waitcnt lgkmcnt(6)
    v_cmp_eq_u32 vcc, 0, v14
    v_mfma_f32_16x16x32_bf16 v[144:147], v[104:107], v[80:83], v[144:147]
    ds_read_b64_tr_b16 v[132:133], v10 offset:15392
    ds_read_b64_tr_b16 v[134:135], v10 offset:16672
    v_mfma_f32_16x16x32_bf16 v[148:151], v[108:111], v[80:83], v[148:151]
    s_cbranch_vccnz fs_8
fr_9:
    ds_read_b64_tr_b16 v[104:105], v10 offset:20480
    ds_read_b64_tr_b16 v[106:107], v10 offset:21760
    v_mfma_f32_16x16x32_bf16 v[152:155], v[112:115], v[80:83], v[152:155]
    ds_read_b64_tr_b16 v[108:109], v10 offset:20488
    ds_read_b64_tr_b16 v[110:111], v10 offset:21768
    v_mfma_f32_16x16x32_bf16 v[136:139], v[116:119], v[84:87], v[136:139]
    ds_read_b64_tr_b16 v[112:113], v10 offset:20496
    ds_read_b64_tr_b16 v[114:115], v10 offset:21776
    s_waitcnt lgkmcnt(6)
    v_mfma_f32_16x16x32_bf16 v[140:143], v[120:123], v[84:87], v[140:143]
    ds_read_b64_tr_b16 v[116:117], v10 offset:20504
    ds_read_b64_tr_b16 v[118:119], v10 offset:21784
    v_mfma_f32_16x16x32_bf16 v[144:147], v[124:127], v[84:87], v[144:147]
    ds_read_b64_tr_b16 v[120:121], v10 offset:20512
    ds_read_b64_tr_b16 v[122:123], v10 offset:21792
    v_mfma_f32_16x16x32_bf16 v[148:151], v[128:131], v[84:87], v[148:151]
    ds_read_b64_tr_b16 v[124:125], v10 offset:25600
    ds_read_b64_tr_b16 v[126:127], v10 offset:26880
    v_mfma_f32_16x16x32_bf16 v[152:155], v[132:135], v[84:87], v[152:155]
    ds_read_b64_tr_b16 v[128:129], v10 offset:25608
    ds_read_b64_tr_b16 v[130:131], v10 offset:26888
    s_waitcnt lgkmcnt(6)
    v_mfma_f32_16x16x32_bf16 v[136:139], v[104:107], v[88:91], v[136:139]
    ds_read_b64_tr_b16 v[132:133], v10 offset:25616
    ds_read_b64_tr_b16 v[134:135], v10 offset:26896
    v_mfma_f32_16x16x32_bf16 v[140:143], v[108:111], v[88:91], v[140:143]
    ds_read_b64_tr_b16 v[104:105], v10 offset:25624
    ds_read_b64_tr_b16 v[106:107], v10 offset:26904
    v_mfma_f32_16x16x32_bf16 v[144:147], v[112:115], v[88:91], v[144:147]
    ds_read_b64_tr_b16 v[108:109], v10 offset:25632
    ds_read_b64_tr_b16 v[110:111], v10 offset:26912
    v_mfma_f32_16x16x32_bf16 v[148:151], v[116:119], v[88:91], v[148:151]
    ds_read_b64_tr_b16 v[112:113], v10 offset:30720
    ds_read_b64_tr_b16 v[114:115], v10 offset:32000
    s_waitcnt lgkmcnt(6)
    v_mfma_f32_16x16x32_bf16 v[152:155], v[120:123], v[88:91], v[152:155]
    ds_read_b64_tr_b16 v[116:117], v10 offset:30728
    ds_read_b64_tr_b16 v[118:119], v10 offset:32008
    v_mfma_f32_16x16x32_bf16 v[136:139], v[124:127], v[92:95], v[136:139]
    ds_read_b64_tr_b16 v[120:121], v10 offset:30736
    ds_read_b64_tr_b16 v[122:123], v10 offset:32016
    v_mfma_f32_16x16x32_bf16 v[140:143], v[128:131], v[92:95], v[140:143]
    ds_read_b64_tr_b16 v[124:125], v10 offset:30744
    ds_read_b64_tr_b16 v[126:127], v10 offset:32024
    v_mfma_f32_16x16x32_bf16 v[144:147], v[132:135], v[92:95], v[144:147]
    ds_read_b64_tr_b16 v[128:129], v10 offset:30752
    ds_read_b64_tr_b16 v[130:131], v10 offset:32032
    s_waitcnt lgkmcnt(6)
    v_mfma_f32_16x16x32_bf16 v[148:151], v[104:107], v[92:95], v[148:151]
    ds_read_b32 v14, v13 offset:80
    ds_read_b64_tr_b16 v[132:133], v10 offset:35840
    ds_read_b64_tr_b16 v[134:135], v10 offset:37120
    v_mfma_f32_16x16x32_bf16 v[152:155], v[108:111], v[92:95], v[152:155]
    ds_read_b64_tr_b16 v[104:105], v10 offset:35848
    ds_read_b64_tr_b16 v[106:107], v10 offset:37128
    v_mfma_f32_16x16x32_bf16 v[136:139], v[112:115], v[96:99], v[136:139]
    ds_read_b64_tr_b16 v[108:109], v10 offset:35856
    ds_read_b64_tr_b16 v[110:111], v10 offset:37136
    v_mfma_f32_16x16x32_bf16 v[140:143], v[116:119], v[96:99], v[140:143]
    ds_read_b64_tr_b16 v[112:113], v10 offset:35864
    ds_read_b64_tr_b16 v[114:115], v10 offset:37144
    s_waitcnt lgkmcnt(6)
    v_cmp_eq_u32 vcc, 0, v14
    v_mfma_f32_16x16x32_bf16 v[144:147], v[120:123], v[96:99], v[144:147]
    ds_read_b64_tr_b16 v[116:117], v10 offset:35872
    ds_read_b64_tr_b16 v[118:119], v10 offset:37152
    v_mfma_f32_16x16x32_bf16 v[148:151], v[124:127], v[96:99], v[148:151]
    s_cbranch_vccnz fs_10
fr_11:
    ds_read_b64_tr_b16 v[120:121], v10 offset:40960
    ds_read_b64_tr_b16 v[122:123], v10 offset:42240
    v_mfma_f32_16x16x32_bf16 v[152:155], v[128:131], v[96:99], v[152:155]
    ds_read_b64_tr_b16 v[124:125], v10 offset:40968
    ds_read_b64_tr_b16 v[126:127], v10 offset:42248
    v_mfma_f32_16x16x32_bf16 v[136:139], v[132:135], v[100:103], v[136:139]
    ds_read_b64_tr_b16 v[128:129], v10 offset:40976
    ds_read_b64_tr_b16 v[130:131], v10 offset:42256
    s_waitcnt lgkmcnt(6)
    v_mfma_f32_16x16x32_bf16 v[140:143], v[104:107], v[100:103], v[140:143]
    ds_read_b64_tr_b16 v[132:133], v10 offset:40984
    ds_read_b64_tr_b16 v[134:135], v10 offset:42264
    v_mfma_f32_16x16x32_bf16 v[144:147], v[108:111], v[100:103], v[144:147]
    ds_read_b64_tr_b16 v[104:105], v10 offset:40992
    ds_read_b64_tr_b16 v[106:107], v10 offset:42272
    v_mfma_f32_16x16x32_bf16 v[148:151], v[112:115], v[100:103], v[148:151]
    ds_read_b64_tr_b16 v[108:109], v10 offset:46080
    ds_read_b64_tr_b16 v[110:111], v10 offset:47360
    v_mfma_f32_16x16x32_bf16 v[152:155], v[116:119], v[100:103], v[152:155]
    v_cvt_pk_bf16_f32 v156, v136, v137
    v_cvt_pk_bf16_f32 v157, v138, v139
    v_cvt_pk_bf16_f32 v158, v140, v141
    v_cvt_pk_bf16_f32 v159, v142, v143
    ds_write_b128 v246, v[156:159] offset:0
    ds_read_b64_tr_b16 v[112:113], v10 offset:46088
    ds_read_b64_tr_b16 v[114:115], v10 offset:47368
    s_waitcnt lgkmcnt(7)
    v_mfma_f32_16x16x32_bf16 v[168:171], v[120:123], v[24:27], 0
    ds_read_b64_tr_b16 v[116:117], v10 offset:46096
    ds_read_b64_tr_b16 v[118:119], v10 offset:47376
    v_mfma_f32_16x16x32_bf16 v[172:175], v[124:127], v[24:27], 0
    v_cvt_pk_bf16_f32 v160, v144, v145
    v_cvt_pk_bf16_f32 v161, v146, v147
    v_cvt_pk_bf16_f32 v162, v148, v149
    v_cvt_pk_bf16_f32 v163, v150, v151
    ds_write_b128 v246, v[160:163] offset:1024
    ds_read_b64_tr_b16 v[120:121], v10 offset:46104
    ds_read_b64_tr_b16 v[122:123], v10 offset:47384
    v_mfma_f32_16x16x32_bf16 v[176:179], v[128:131], v[24:27], 0
    v_cvt_pk_bf16_f32 v164, v152, v153
    v_cvt_pk_bf16_f32 v165, v154, v155
    ds_write_b64 v246, v[164:165] offset:2048
    ds_write_b32 v12, v12 offset:560
    s_waitcnt lgkmcnt(13)
    ds_read_b64_tr_b16 v[124:125], v10 offset:46112
    ds_read_b64_tr_b16 v[126:127], v10 offset:47392
    v_mfma_f32_16x16x32_bf16 v[180:183], v[132:135], v[24:27], 0
    s_waitcnt lgkmcnt(13)
    ds_read_b64_tr_b16 v[128:129], v10 offset:51200
    ds_read_b64_tr_b16 v[130:131], v10 offset:52480
    s_waitcnt lgkmcnt(9)
    v_mfma_f32_16x16x32_bf16 v[184:187], v[104:107], v[24:27], 0
    ds_read_b64_tr_b16 v[132:133], v10 offset:51208
    ds_read_b64_tr_b16 v[134:135], v10 offset:52488
    v_mfma_f32_16x16x32_bf16 v[168:171], v[108:111], v[28:31], v[168:171]
    ds_read_b64_tr_b16 v[104:105], v10 offset:51216
    ds_read_b64_tr_b16 v[106:107], v10 offset:52496
    v_mfma_f32_16x16x32_bf16 v[172:175], v[112:115], v[28:31], v[172:175]
    ds_read_b64_tr_b16 v[108:109], v10 offset:51224
    ds_read_b64_tr_b16 v[110:111], v10 offset:52504
    v_mfma_f32_16x16x32_bf16 v[176:179], v[116:119], v[28:31], v[176:179]
    s_waitcnt lgkmcnt(13)
    ds_read_b64_tr_b16 v[112:113], v10 offset:51232
    ds_read_b64_tr_b16 v[114:115], v10 offset:52512
    s_waitcnt lgkmcnt(6)
    v_mfma_f32_16x16x32_bf16 v[180:183], v[120:123], v[28:31], v[180:183]
    ds_read_b32 v14, v13 offset:96
    ds_read_b64_tr_b16 v[116:117], v10 offset:56320
    ds_read_b64_tr_b16 v[118:119], v10 offset:57600
    v_mfma_f32_16x16x32_bf16 v[184:187], v[124:127], v[28:31], v[184:187]
    ds_read_b64_tr_b16 v[120:121], v10 offset:56328
    ds_read_b64_tr_b16 v[122:123], v10 offset:57608
    v_mfma_f32_16x16x32_bf16 v[168:171], v[128:131], v[32:35], v[168:171]
    ds_read_b64_tr_b16 v[124:125], v10 offset:56336
    ds_read_b64_tr_b16 v[126:127], v10 offset:57616
    v_mfma_f32_16x16x32_bf16 v[172:175], v[132:135], v[32:35], v[172:175]
    ds_read_b64_tr_b16 v[128:129], v10 offset:56344
    ds_read_b64_tr_b16 v[130:131], v10 offset:57624
    s_waitcnt lgkmcnt(6)
    v_cmp_eq_u32 vcc, 0, v14
    v_mfma_f32_16x16x32_bf16 v[176:179], v[104:107], v[32:35], v[176:179]
    ds_read_b64_tr_b16 v[132:133], v10 offset:56352
    ds_read_b64_tr_b16 v[134:135], v10 offset:57632
    v_mfma_f32_16x16x32_bf16 v[180:183], v[108:111], v[32:35], v[180:183]
    s_cbranch_vccnz fs_12
fr_13:
    ds_read_b64_tr_b16 v[104:105], v11 offset:0
    ds_read_b64_tr_b16 v[106:107], v11 offset:1280
    v_mfma_f32_16x16x32_bf16 v[184:187], v[112:115], v[32:35], v[184:187]
    ds_read_b64_tr_b16 v[108:109], v11 offset:8
    ds_read_b64_tr_b16 v[110:111], v11 offset:1288
    v_mfma_f32_16x16x32_bf16 v[168:171], v[116:119], v[36:39], v[168:171]
    ds_read_b64_tr_b16 v[112:113], v11 offset:16
    ds_read_b64_tr_b16 v[114:115], v11 offset:1296
    s_waitcnt lgkmcnt(6)
    v_mfma_f32_16x16x32_bf16 v[172:175], v[120:123], v[36:39], v[172:175]
    ds_write_b32 v12, v12 offset:336
    ds_read_b64_tr_b16 v[116:117], v11 offset:24
    ds_read_b64_tr_b16 v[118:119], v11 offset:1304
    v_mfma_f32_16x16x32_bf16 v[176:179], v[124:127], v[36:39], v[176:179]
    ds_read_b64_tr_b16 v[120:121], v11 offset:32
    ds_read_b64_tr_b16 v[122:123], v11 offset:1312
    v_mfma_f32_16x16x32_bf16 v[180:183], v[128:131], v[36:39], v[180:183]
    ds_read_b64_tr_b16 v[124:125], v11 offset:5120
    ds_read_b64_tr_b16 v[126:127], v11 offset:6400
    v_mfma_f32_16x16x32_bf16 v[184:187], v[132:135], v[36:39], v[184:187]
    ds_read_b64_tr_b16 v[128:129], v11 offset:5128
    ds_read_b64_tr_b16 v[130:131], v11 offset:6408
    s_waitcnt lgkmcnt(6)
    v_mfma_f32_16x16x32_bf16 v[168:171], v[104:107], v[40:43], v[168:171]
    ds_read_b64_tr_b16 v[132:133], v11 offset:5136
    ds_read_b64_tr_b16 v[134:135], v11 offset:6416
    v_mfma_f32_16x16x32_bf16 v[172:175], v[108:111], v[40:43], v[172:175]
    ds_read_b64_tr_b16 v[104:105], v11 offset:5144
    ds_read_b64_tr_b16 v[106:107], v11 offset:6424
    v_mfma_f32_16x16x32_bf16 v[176:179], v[112:115], v[40:43], v[176:179]
    ds_read_b64_tr_b16 v[108:109], v11 offset:5152
    ds_read_b64_tr_b16 v[110:111], v11 offset:6432
    v_mfma_f32_16x16x32_bf16 v[180:183], v[116:119], v[40:43], v[180:183]
    ds_read_b64_tr_b16 v[112:113], v11 offset:10240
    ds_read_b64_tr_b16 v[114:115], v11 offset:11520
    s_waitcnt lgkmcnt(6)
    v_mfma_f32_16x16x32_bf16 v[184:187], v[120:123], v[40:43], v[184:187]
    ds_read_b64_tr_b16 v[116:117], v11 offset:10248
    ds_read_b64_tr_b16 v[118:119], v11 offset:11528
    v_mfma_f32_16x16x32_bf16 v[168:171], v[124:127], v[44:47], v[168:171]
    ds_read_b64_tr_b16 v[120:121], v11 offset:10256
    ds_read_b64_tr_b16 v[122:123], v11 offset:11536
    v_mfma_f32_16x16x32_bf16 v[172:175], v[128:131], v[44:47], v[172:175]
    ds_read_b64_tr_b16 v[124:125], v11 offset:10264
    ds_read_b64_tr_b16 v[126:127], v11 offset:11544
    v_mfma_f32_16x16x32_bf16 v[176:179], v[132:135], v[44:47], v[176:179]
    ds_read_b64_tr_b16 v[128:129], v11 offset:10272
    ds_read_b64_tr_b16 v[130:131], v11 offset:11552
    s_waitcnt lgkmcnt(6)
    v_mfma_f32_16x16x32_bf16 v[180:183], v[104:107], v[44:47], v[180:183]
    ds_read_b32 v14, v13 offset:112
    ds_read_b64_tr_b16 v[132:133], v11 offset:15360
    ds_read_b64_tr_b16 v[134:135], v11 offset:16640
    v_mfma_f32_16x16x32_bf16 v[184:187], v[108:111], v[44:47], v[184:187]
    ds_read_b64_tr_b16 v[104:105], v11 offset:15368
    ds_read_b64_tr_b16 v[106:107], v11 offset:16648
    v_mfma_f32_16x16x32_bf16 v[168:171], v[112:115], v[48:51], v[168:171]
    ds_read_b64_tr_b16 v[108:109], v11 offset:15376
    ds_read_b64_tr_b16 v[110:111], v11 offset:16656
    v_mfma_f32_16x16x32_bf16 v[172:175], v[116:119], v[48:51], v[172:175]
    ds_read_b64_tr_b16 v[112:113], v11 offset:15384
    ds_read_b64_tr_b16 v[114:115], v11 offset:16664
    s_waitcnt lgkmcnt(6)
    v_cmp_eq_u32 vcc, 0, v14
    v_mfma_f32_16x16x32_bf16 v[176:179], v[120:123], v[48:51], v[176:179]
    ds_read_b64_tr_b16 v[116:117], v11 offset:15392
    ds_read_b64_tr_b16 v[118:119], v11 offset:16672
    v_mfma_f32_16x16x32_bf16 v[180:183], v[124:127], v[48:51], v[180:183]
    s_cbranch_vccnz fs_14
fr_15:
    ds_read_b64_tr_b16 v[120:121], v9 offset:0
    ds_read_b64_tr_b16 v[122:123], v9 offset:1280
    v_mfma_f32_16x16x32_bf16 v[184:187], v[128:131], v[48:51], v[184:187]
    ds_read_b64_tr_b16 v[124:125], v9 offset:8
    ds_read_b64_tr_b16 v[126:127], v9 offset:1288
    v_mfma_f32_16x16x32_bf16 v[168:171], v[132:135], v[52:55], v[168:171]
    ds_read_b64_tr_b16 v[128:129], v9 offset:16
    ds_read_b64_tr_b16 v[130:131], v9 offset:1296
    s_waitcnt lgkmcnt(6)
    v_mfma_f32_16x16x32_bf16 v[172:175], v[104:107], v[52:55], v[172:175]
    ds_write_b32 v12, v12 offset:352
    ds_read_b64_tr_b16 v[132:133], v9 offset:24
    ds_read_b64_tr_b16 v[134:135], v9 offset:1304
    v_mfma_f32_16x16x32_bf16 v[176:179], v[108:111], v[52:55], v[176:179]
    ds_read_b64_tr_b16 v[104:105], v9 offset:32
    ds_read_b64_tr_b16 v[106:107], v9 offset:1312
    v_mfma_f32_16x16x32_bf16 v[180:183], v[112:115], v[52:55], v[180:183]
    ds_read_b64_tr_b16 v[108:109], v9 offset:5120
    ds_read_b64_tr_b16 v[110:111], v9 offset:6400
    v_mfma_f32_16x16x32_bf16 v[184:187], v[116:119], v[52:55], v[184:187]
    ds_read_b64_tr_b16 v[112:113], v9 offset:5128
    ds_read_b64_tr_b16 v[114:115], v9 offset:6408
    s_waitcnt lgkmcnt(6)
    v_mfma_f32_16x16x32_bf16 v[168:171], v[120:123], v[56:59], v[168:171]
    ds_read_b64_tr_b16 v[116:117], v9 offset:5136
    ds_read_b64_tr_b16 v[118:119], v9 offset:6416
    v_mfma_f32_16x16x32_bf16 v[172:175], v[124:127], v[56:59], v[172:175]
    ds_read_b64_tr_b16 v[120:121], v9 offset:5144
    ds_read_b64_tr_b16 v[122:123], v9 offset:6424
    v_mfma_f32_16x16x32_bf16 v[176:179], v[128:131], v[56:59], v[176:179]
    ds_read_b64_tr_b16 v[124:125], v9 offset:5152
    ds_read_b64_tr_b16 v[126:127], v9 offset:6432
    v_mfma_f32_16x16x32_bf16 v[180:183], v[132:135], v[56:59], v[180:183]
    ds_read_b64_tr_b16 v[128:129], v9 offset:10240
    ds_read_b64_tr_b16 v[130:131], v9 offset:11520
    s_waitcnt lgkmcnt(6)
    v_mfma_f32_16x16x32_bf16 v[184:187], v[104:107], v[56:59], v[184:187]
    ds_read_b64_tr_b16 v[132:133], v9 offset:10248
    ds_read_b64_tr_b16 v[134:135], v9 offset:11528
    v_mfma_f32_16x16x32_bf16 v[168:171], v[108:111], v[60:63], v[168:171]
    ds_read_b64_tr_b16 v[104:105], v9 offset:10256
    ds_read_b64_tr_b16 v[106:107], v9 offset:11536
    v_mfma_f32_16x16x32_bf16 v[172:175], v[112:115], v[60:63], v[172:175]
    ds_read_b64_tr_b16 v[108:109], v9 offset:10264
    ds_read_b64_tr_b16 v[110:111], v9 offset:11544
    v_mfma_f32_16x16x32_bf16 v[176:179], v[116:119], v[60:63], v[176:179]
    ds_read_b64_tr_b16 v[112:113], v9 offset:10272
    ds_read_b64_tr_b16 v[114:115], v9 offset:11552
    s_waitcnt lgkmcnt(6)
    v_mfma_f32_16x16x32_bf16 v[180:183], v[120:123], v[60:63], v[180:183]
    ds_read_b32 v14, v13 offset:128
    ds_read_b64_tr_b16 v[116:117], v9 offset:15360
    ds_read_b64_tr_b16 v[118:119], v9 offset:16640
    v_mfma_f32_16x16x32_bf16 v[184:187], v[124:127], v[60:63], v[184:187]
    ds_read_b64_tr_b16 v[120:121], v9 offset:15368
    ds_read_b64_tr_b16 v[122:123], v9 offset:16648
    v_mfma_f32_16x16x32_bf16 v[168:171], v[128:131], v[64:67], v[168:171]
    ds_read_b64_tr_b16 v[124:125], v9 offset:15376
    ds_read_b64_tr_b16 v[126:127], v9 offset:16656
    v_mfma_f32_16x16x32_bf16 v[172:175], v[132:135], v[64:67], v[172:175]
    ds_read_b64_tr_b16 v[128:129], v9 offset:15384
    ds_read_b64_tr_b16 v[130:131], v9 offset:16664
    s_waitcnt lgkmcnt(6)
    v_cmp_eq_u32 vcc, 0, v14
    v_mfma_f32_16x16x32_bf16 v[176:179], v[104:107], v[64:67], v[176:179]
    ds_read_b64_tr_b16 v[132:133], v9 offset:15392
    ds_read_b64_tr_b16 v[134:135], v9 offset:16672
    v_mfma_f32_16x16x32_bf16 v[180:183], v[108:111], v[64:67], v[180:183]
    s_cbranch_vccnz fs_16
fr_17:
    ds_read_b64_tr_b16 v[104:105], v9 offset:20480
    ds_read_b64_tr_b16 v[106:107], v9 offset:21760
    v_mfma_f32_16x16x32_bf16 v[184:187], v[112:115], v[64:67], v[184:187]
    ds_read_b64_tr_b16 v[108:109], v9 offset:20488
    ds_read_b64_tr_b16 v[110:111], v9 offset:21768
    v_mfma_f32_16x16x32_bf16 v[168:171], v[116:119], v[68:71], v[168:171]
    ds_read_b64_tr_b16 v[112:113], v9 offset:20496
    ds_read_b64_tr_b16 v[114:115], v9 offset:21776
    s_waitcnt lgkmcnt(6)
    v_mfma_f32_16x16x32_bf16 v[172:175], v[120:123], v[68:71], v[172:175]
    ds_read_b64_tr_b16 v[116:117], v9 offset:20504
    ds_read_b64_tr_b16 v[118:119], v9 offset:21784
    v_mfma_f32_16x16x32_bf16 v[176:179], v[124:127], v[68:71], v[176:179]
    ds_read_b64_tr_b16 v[120:121], v9 offset:20512
    ds_read_b64_tr_b16 v[122:123], v9 offset:21792
    v_mfma_f32_16x16x32_bf16 v[180:183], v[128:131], v[68:71], v[180:183]
    ds_read_b64_tr_b16 v[124:125], v9 offset:25600
    ds_read_b64_tr_b16 v[126:127], v9 offset:26880
    v_mfma_f32_16x16x32_bf16 v[184:187], v[132:135], v[68:71], v[184:187]
    ds_read_b64_tr_b16 v[128:129], v9 offset:25608
    ds_read_b64_tr_b16 v[130:131], v9 offset:26888
    s_waitcnt lgkmcnt(6)
    v_mfma_f32_16x16x32_bf16 v[168:171], v[104:107], v[72:75], v[168:171]
    ds_read_b64_tr_b16 v[132:133], v9 offset:25616
    ds_read_b64_tr_b16 v[134:135], v9 offset:26896
    v_mfma_f32_16x16x32_bf16 v[172:175], v[108:111], v[72:75], v[172:175]
    ds_read_b64_tr_b16 v[104:105], v9 offset:25624
    ds_read_b64_tr_b16 v[106:107], v9 offset:26904
    v_mfma_f32_16x16x32_bf16 v[176:179], v[112:115], v[72:75], v[176:179]
    ds_read_b64_tr_b16 v[108:109], v9 offset:25632
    ds_read_b64_tr_b16 v[110:111], v9 offset:26912
    v_mfma_f32_16x16x32_bf16 v[180:183], v[116:119], v[72:75], v[180:183]
    ds_read_b64_tr_b16 v[112:113], v9 offset:30720
    ds_read_b64_tr_b16 v[114:115], v9 offset:32000
    s_waitcnt lgkmcnt(6)
    v_mfma_f32_16x16x32_bf16 v[184:187], v[120:123], v[72:75], v[184:187]
    ds_read_b64_tr_b16 v[116:117], v9 offset:30728
    ds_read_b64_tr_b16 v[118:119], v9 offset:32008
    v_mfma_f32_16x16x32_bf16 v[168:171], v[124:127], v[76:79], v[168:171]
    ds_read_b64_tr_b16 v[120:121], v9 offset:30736
    ds_read_b64_tr_b16 v[122:123], v9 offset:32016
    v_mfma_f32_16x16x32_bf16 v[172:175], v[128:131], v[76:79], v[172:175]
    ds_read_b64_tr_b16 v[124:125], v9 offset:30744
    ds_read_b64_tr_b16 v[126:127], v9 offset:32024
    v_mfma_f32_16x16x32_bf16 v[176:179], v[132:135], v[76:79], v[176:179]
    ds_read_b64_tr_b16 v[128:129], v9 offset:30752
    ds_read_b64_tr_b16 v[130:131], v9 offset:32032
    s_waitcnt lgkmcnt(6)
    v_mfma_f32_16x16x32_bf16 v[180:183], v[104:107], v[76:79], v[180:183]
    ds_read_b32 v14, v13 offset:144
    ds_read_b64_tr_b16 v[132:133], v9 offset:35840
    ds_read_b64_tr_b16 v[134:135], v9 offset:37120
    v_mfma_f32_16x16x32_bf16 v[184:187], v[108:111], v[76:79], v[184:187]
    ds_read_b64_tr_b16 v[104:105], v9 offset:35848
    ds_read_b64_tr_b16 v[106:107], v9 offset:37128
    v_mfma_f32_16x16x32_bf16 v[168:171], v[112:115], v[80:83], v[168:171]
    ds_read_b64_tr_b16 v[108:109], v9 offset:35856
    ds_read_b64_tr_b16 v[110:111], v9 offset:37136
    v_mfma_f32_16x16x32_bf16 v[172:175], v[116:119], v[80:83], v[172:175]
    ds_read_b64_tr_b16 v[112:113], v9 offset:35864
    ds_read_b64_tr_b16 v[114:115], v9 offset:37144
    s_waitcnt lgkmcnt(6)
    v_cmp_eq_u32 vcc, 0, v14
    v_mfma_f32_16x16x32_bf16 v[176:179], v[120:123], v[80:83], v[176:179]
    ds_read_b64_tr_b16 v[116:117], v9 offset:35872
    ds_read_b64_tr_b16 v[118:119], v9 offset:37152
    v_mfma_f32_16x16x32_bf16 v[180:183], v[124:127], v[80:83], v[180:183]
    s_cbranch_vccnz fs_18
fr_19:
    ds_read_b64_tr_b16 v[120:121], v9 offset:40960
    ds_read_b64_tr_b16 v[122:123], v9 offset:42240
    v_mfma_f32_16x16x32_bf16 v[184:187], v[128:131], v[80:83], v[184:187]
    ds_read_b64_tr_b16 v[124:125], v9 offset:40968
    ds_read_b64_tr_b16 v[126:127], v9 offset:42248
    v_mfma_f32_16x16x32_bf16 v[168:171], v[132:135], v[84:87], v[168:171]
    ds_read_b64_tr_b16 v[128:129], v9 offset:40976
    ds_read_b64_tr_b16 v[130:131], v9 offset:42256
    s_waitcnt lgkmcnt(6)
    v_mfma_f32_16x16x32_bf16 v[172:175], v[104:107], v[84:87], v[172:175]
    ds_read_b64_tr_b16 v[132:133], v9 offset:40984
    ds_read_b64_tr_b16 v[134:135], v9 offset:42264
    v_mfma_f32_16x16x32_bf16 v[176:179], v[108:111], v[84:87], v[176:179]
    ds_read_b64_tr_b16 v[104:105], v9 offset:40992
    ds_read_b64_tr_b16 v[106:107], v9 offset:42272
    v_mfma_f32_16x16x32_bf16 v[180:183], v[112:115], v[84:87], v[180:183]
    ds_read_b64_tr_b16 v[108:109], v9 offset:46080
    ds_read_b64_tr_b16 v[110:111], v9 offset:47360
    v_mfma_f32_16x16x32_bf16 v[184:187], v[116:119], v[84:87], v[184:187]
    ds_read_b64_tr_b16 v[112:113], v9 offset:46088
    ds_read_b64_tr_b16 v[114:115], v9 offset:47368
    s_waitcnt lgkmcnt(6)
    v_mfma_f32_16x16x32_bf16 v[168:171], v[120:123], v[88:91], v[168:171]
    ds_read_b64_tr_b16 v[116:117], v9 offset:46096
    ds_read_b64_tr_b16 v[118:119], v9 offset:47376
    v_mfma_f32_16x16x32_bf16 v[172:175], v[124:127], v[88:91], v[172:175]
    ds_read_b64_tr_b16 v[120:121], v9 offset:46104
    ds_read_b64_tr_b16 v[122:123], v9 offset:47384
    v_mfma_f32_16x16x32_bf16 v[176:179], v[128:131], v[88:91], v[176:179]
    ds_read_b64_tr_b16 v[124:125], v9 offset:46112
    ds_read_b64_tr_b16 v[126:127], v9 offset:47392
    v_mfma_f32_16x16x32_bf16 v[180:183], v[132:135], v[88:91], v[180:183]
    ds_read_b64_tr_b16 v[128:129], v9 offset:51200
    ds_read_b64_tr_b16 v[130:131], v9 offset:52480
    s_waitcnt lgkmcnt(6)
    v_mfma_f32_16x16x32_bf16 v[184:187], v[104:107], v[88:91], v[184:187]
    ds_read_b64_tr_b16 v[132:133], v9 offset:51208
    ds_read_b64_tr_b16 v[134:135], v9 offset:52488
    v_mfma_f32_16x16x32_bf16 v[168:171], v[108:111], v[92:95], v[168:171]
    ds_read_b64_tr_b16 v[104:105], v9 offset:51216
    ds_read_b64_tr_b16 v[106:107], v9 offset:52496
    v_mfma_f32_16x16x32_bf16 v[172:175], v[112:115], v[92:95], v[172:175]
    ds_read_b64_tr_b16 v[108:109], v9 offset:51224
    ds_read_b64_tr_b16 v[110:111], v9 offset:52504
    v_mfma_f32_16x16x32_bf16 v[176:179], v[116:119], v[92:95], v[176:179]
    ds_read_b64_tr_b16 v[112:113], v9 offset:51232
    ds_read_b64_tr_b16 v[114:115], v9 offset:52512
    s_waitcnt lgkmcnt(6)
    v_mfma_f32_16x16x32_bf16 v[180:183], v[120:123], v[92:95], v[180:183]
    ds_read_b64_tr_b16 v[116:117], v9 offset:56320
    ds_read_b64_tr_b16 v[118:119], v9 offset:57600
    v_mfma_f32_16x16x32_bf16 v[184:187], v[124:127], v[92:95], v[184:187]
    ds_read_b64_tr_b16 v[120:121], v9 offset:56328
    ds_read_b64_tr_b16 v[122:123], v9 offset:57608
    v_mfma_f32_16x16x32_bf16 v[168:171], v[128:131], v[96:99], v[168:171]
    ds_read_b64_tr_b16 v[124:125], v9 offset:56336
    ds_read_b64_tr_b16 v[126:127], v9 offset:57616
    v_mfma_f32_16x16x32_bf16 v[172:175], v[132:135], v[96:99], v[172:175]
    ds_read_b64_tr_b16 v[128:129], v9 offset:56344
    ds_read_b64_tr_b16 v[130:131], v9 offset:57624
    s_waitcnt lgkmcnt(6)
    v_mfma_f32_16x16x32_bf16 v[176:179], v[104:107], v[96:99], v[176:179]
    ds_read_b64_tr_b16 v[132:133], v9 offset:56352
    ds_read_b64_tr_b16 v[134:135], v9 offset:57632
    v_mfma_f32_16x16x32_bf16 v[180:183], v[108:111], v[96:99], v[180:183]
    v_mfma_f32_16x16x32_bf16 v[184:187], v[112:115], v[96:99], v[184:187]
    v_mfma_f32_16x16x32_bf16 v[168:171], v[116:119], v[100:103], v[168:171]
    s_waitcnt lgkmcnt(0)
    v_mfma_f32_16x16x32_bf16 v[172:175], v[120:123], v[100:103], v[172:175]
    v_mfma_f32_16x16x32_bf16 v[176:179], v[124:127], v[100:103], v[176:179]
    v_mfma_f32_16x16x32_bf16 v[180:183], v[128:131], v[100:103], v[180:183]
    v_mfma_f32_16x16x32_bf16 v[184:187], v[132:135], v[100:103], v[184:187]
    s_nop 2
    v_cvt_pk_bf16_f32 v156, v168, v169
    v_cvt_pk_bf16_f32 v157, v170, v171
    v_cvt_pk_bf16_f32 v158, v172, v173
    v_cvt_pk_bf16_f32 v159, v174, v175
    ds_write_b128 v247, v[156:159] offset:0
    v_cvt_pk_bf16_f32 v160, v176, v177
    v_cvt_pk_bf16_f32 v161, v178, v179
    v_cvt_pk_bf16_f32 v162, v180, v181
    v_cvt_pk_bf16_f32 v163, v182, v183
    ds_write_b128 v247, v[160:163] offset:16
    v_cvt_pk_bf16_f32 v164, v184, v185
    v_cvt_pk_bf16_f32 v165, v186, v187
    ds_write_b128 v247, v[164:167] offset:32
    s_waitcnt lgkmcnt(0)
    s_barrier
    buffer_load_dwordx4 v[240:243], v245, s[20:23], 0 offen
    buffer_load_dword v244, v245, s[20:23], 0 offen offset:16
    s_mul_i32 s28, s28, 0x9e3779b5
    s_add_u32 s28, s28, 0x7f4a7c15
    v_bfe_u32 v14, v1, 2, 2
    v_xor_b32 v15, v14, v3
    v_lshlrev_b32 v15, 6, v15
    v_and_b32_e64 v16, 3, v1
    v_lshl_add_u32 v15, v16, 4, v15
    v_mul_u32_u24 v17, 1280, v3
    v_add_u32 v253, v15, v17
    s_mul_i32 s29, s6, 25600
    s_lshl_b32 s58, s0, 8
    s_add_u32 s29, s29, s58
    s_mov_b32 s24, s38
    s_and_b32 s25, s39, 0xffff
    s_mov_b32 s26, 819200
    s_mov_b32 s27, 0x20000
    v_lshrrev_b32 v16, 5, v1
    v_and_b32 v17, 31, v1
    s_add_u32 s58, s62, 122880
    v_lshl_add_u32 v14, v17, 4, s58
    v_lshl_add_u32 v252, v16, 11, v14
    v_lshl_add_u32 v245, v16, 3, v14
    v_lshrrev_b32 v15, 2, v17
    v_lshlrev_b32 v15, 2, v15
    s_mov_b32 s58, 0x55443120
    v_lshrrev_b32 v15, v15, s58
    v_and_b32 v15, 7, v15
    v_and_b32 v17, 3, v17
    v_lshl_add_u32 v17, v15, 2, v17
    v_mad_u32_u24 v17, v16, 24, v17
    v_lshlrev_b32 v251, 4, v17
    s_lshl2_add_u32 s71, s4, s6
    s_mul_i32 s71, s71, 3072
    s_add_u32 s71, s71, 3211264
    v_lshlrev_b32_e64 v14, 12, v3
    v_lshl_add_u32 v14, v23, 4, v14
    v_add_u32 v23, 122880, v14
    s_mul_i32 s72, s3, 98304
    s_mul_i32 s58, s6, 3072
    s_add_u32 s72, s72, s58
    s_add_u32 s72, s72, 3309568
    s_mul_i32 s69, s4, 12288
    s_add_u32 s69, s69, s72
    v_lshlrev_b32 v4, 4, v1
    s_lshl_b32 s58, s6, 11
    s_add_u32 s58, s58, 40960
    v_add_u32_e64 v6, s58, v4
    v_add_u32 v7, 40960, v6
    s_lshl_b32 s58, s6, 9
    s_add_u32 s58, s58, 49152
    v_lshl_add_u32 v8, v1, 3, s58
    v_add_u32 v5, 40960, v8
    v_cmp_le_u32 s[74:75], 32, v1
    v_mov_b32 v238, 0
    v_mov_b32 v239, 0
    v_mov_b32 v166, 0
    v_mov_b32 v167, 0
    ds_read_b64_tr_b16 v[188:189], v22 offset:0
    ds_read_b64_tr_b16 v[190:191], v22 offset:160
    ds_read_b64_tr_b16 v[192:193], v22 offset:320
    ds_read_b64_tr_b16 v[194:195], v22 offset:480
    ds_read_b64_tr_b16 v[196:197], v22 offset:640
    ds_read_b64_tr_b16 v[198:199], v22 offset:8
    ds_read_b64_tr_b16 v[200:201], v22 offset:168
    ds_read_b64_tr_b16 v[202:203], v22 offset:328
    ds_read_b64_tr_b16 v[204:205], v22 offset:488
    ds_read_b64_tr_b16 v[206:207], v22 offset:648
    s_waitcnt lgkmcnt(5)
    ds_read_b64_tr_b16 v[208:209], v22 offset:16
    ds_read_b64_tr_b16 v[210:211], v22 offset:176
    ds_read_b64_tr_b16 v[212:213], v22 offset:336
    ds_read_b64_tr_b16 v[214:215], v22 offset:496
    ds_read_b64_tr_b16 v[216:217], v22 offset:656
    ds_read_b64_tr_b16 v[218:219], v22 offset:24
    ds_read_b64_tr_b16 v[220:221], v22 offset:184
    ds_read_b64_tr_b16 v[222:223], v22 offset:344
    ds_read_b64_tr_b16 v[224:225], v22 offset:504
    ds_read_b64_tr_b16 v[226:227], v22 offset:664
    s_waitcnt lgkmcnt(5)
    ds_read_b64_tr_b16 v[228:229], v22 offset:32
    ds_read_b64_tr_b16 v[230:231], v22 offset:192
    ds_read_b64_tr_b16 v[232:233], v22 offset:352
    ds_read_b64_tr_b16 v[234:235], v22 offset:512
    ds_read_b64_tr_b16 v[236:237], v22 offset:672
    s_waitcnt lgkmcnt(0)
    ds_read_b64_tr_b16 v[104:105], v10 offset:20480
    ds_read_b64_tr_b16 v[106:107], v10 offset:21760
    ds_read_b64_tr_b16 v[108:109], v10 offset:20488
    ds_read_b64_tr_b16 v[110:111], v10 offset:21768
    ds_read_b64_tr_b16 v[112:113], v10 offset:20496
    ds_read_b64_tr_b16 v[114:115], v10 offset:21776
    ds_read_b64_tr_b16 v[116:117], v10 offset:20504
    ds_read_b64_tr_b16 v[118:119], v10 offset:21784
    ds_read_b64_tr_b16 v[120:121], v10 offset:20512
    ds_read_b64_tr_b16 v[122:123], v10 offset:21792
    ds_read_b64_tr_b16 v[124:125], v10 offset:25600
    ds_read_b64_tr_b16 v[126:127], v10 offset:26880
    ds_read_b64_tr_b16 v[128:129], v10 offset:25608
    ds_read_b64_tr_b16 v[130:131], v10 offset:26888
    s_waitcnt lgkmcnt(6)
    v_mfma_f32_16x16x32_bf16 v[136:139], v[104:107], v[24:27], 0
    ds_read_b64_tr_b16 v[132:133], v10 offset:25616
    ds_read_b64_tr_b16 v[134:135], v10 offset:26896
    v_mfma_f32_16x16x32_bf16 v[140:143], v[108:111], v[24:27], 0
    ds_read_b64_tr_b16 v[104:105], v10 offset:25624
    ds_read_b64_tr_b16 v[106:107], v10 offset:26904
    v_mfma_f32_16x16x32_bf16 v[144:147], v[112:115], v[24:27], 0
    ds_read_b64_tr_b16 v[108:109], v10 offset:25632
    ds_read_b64_tr_b16 v[110:111], v10 offset:26912
    v_mfma_f32_16x16x32_bf16 v[148:151], v[116:119], v[24:27], 0
    ds_read_b64_tr_b16 v[112:113], v10 offset:30720
    ds_read_b64_tr_b16 v[114:115], v10 offset:32000
    s_waitcnt lgkmcnt(6)
    v_mfma_f32_16x16x32_bf16 v[152:155], v[120:123], v[24:27], 0
    ds_read_b64_tr_b16 v[116:117], v10 offset:30728
    ds_read_b64_tr_b16 v[118:119], v10 offset:32008
    v_mfma_f32_16x16x32_bf16 v[136:139], v[124:127], v[28:31], v[136:139]
    ds_read_b64_tr_b16 v[120:121], v10 offset:30736
    ds_read_b64_tr_b16 v[122:123], v10 offset:32016
    v_mfma_f32_16x16x32_bf16 v[140:143], v[128:131], v[28:31], v[140:143]
    ds_read_b64_tr_b16 v[124:125], v10 offset:30744
    ds_read_b64_tr_b16 v[126:127], v10 offset:32024
    v_mfma_f32_16x16x32_bf16 v[144:147], v[132:135], v[28:31], v[144:147]
    ds_read_b64_tr_b16 v[128:129], v10 offset:30752
    ds_read_b64_tr_b16 v[130:131], v10 offset:32032
    s_waitcnt lgkmcnt(6)
    v_mfma_f32_16x16x32_bf16 v[148:151], v[104:107], v[28:31], v[148:151]
    ds_read_b64_tr_b16 v[132:133], v10 offset:35840
    ds_read_b64_tr_b16 v[134:135], v10 offset:37120
    v_mfma_f32_16x16x32_bf16 v[152:155], v[108:111], v[28:31], v[152:155]
    ds_read_b64_tr_b16 v[104:105], v10 offset:35848
    ds_read_b64_tr_b16 v[106:107], v10 offset:37128
    v_mfma_f32_16x16x32_bf16 v[136:139], v[112:115], v[32:35], v[136:139]
    ds_read_b64_tr_b16 v[108:109], v10 offset:35856
    ds_read_b64_tr_b16 v[110:111], v10 offset:37136
    v_mfma_f32_16x16x32_bf16 v[140:143], v[116:119], v[32:35], v[140:143]
    ds_read_b64_tr_b16 v[112:113], v10 offset:35864
    ds_read_b64_tr_b16 v[114:115], v10 offset:37144
    s_waitcnt lgkmcnt(6)
    v_mfma_f32_16x16x32_bf16 v[144:147], v[120:123], v[32:35], v[144:147]
    ds_read_b64_tr_b16 v[116:117], v10 offset:35872
    ds_read_b64_tr_b16 v[118:119], v10 offset:37152
    v_mfma_f32_16x16x32_bf16 v[148:151], v[124:127], v[32:35], v[148:151]
    ds_read_b64_tr_b16 v[120:121], v10 offset:40960
    ds_read_b64_tr_b16 v[122:123], v10 offset:42240
    v_mfma_f32_16x16x32_bf16 v[152:155], v[128:131], v[32:35], v[152:155]
    ds_read_b64_tr_b16 v[124:125], v10 offset:40968
    ds_read_b64_tr_b16 v[126:127], v10 offset:42248
    v_mfma_f32_16x16x32_bf16 v[136:139], v[132:135], v[36:39], v[136:139]
    ds_read_b64_tr_b16 v[128:129], v10 offset:40976
    ds_read_b64_tr_b16 v[130:131], v10 offset:42256
    s_waitcnt lgkmcnt(6)
    v_mfma_f32_16x16x32_bf16 v[140:143], v[104:107], v[36:39], v[140:143]
    ds_read_b64_tr_b16 v[132:133], v10 offset:40984
    ds_read_b64_tr_b16 v[134:135], v10 offset:42264
    v_mfma_f32_16x16x32_bf16 v[144:147], v[108:111], v[36:39], v[144:147]
    ds_read_b64_tr_b16 v[104:105], v10 offset:40992
    ds_read_b64_tr_b16 v[106:107], v10 offset:42272
    v_mfma_f32_16x16x32_bf16 v[148:151], v[112:115], v[36:39], v[148:151]
    ds_read_b64_tr_b16 v[108:109], v10 offset:46080
    ds_read_b64_tr_b16 v[110:111], v10 offset:47360
    v_mfma_f32_16x16x32_bf16 v[152:155], v[116:119], v[36:39], v[152:155]
    ds_read_b64_tr_b16 v[112:113], v10 offset:46088
    ds_read_b64_tr_b16 v[114:115], v10 offset:47368
    s_waitcnt lgkmcnt(6)
    v_mfma_f32_16x16x32_bf16 v[136:139], v[120:123], v[40:43], v[136:139]
    ds_read_b64_tr_b16 v[116:117], v10 offset:46096
    ds_read_b64_tr_b16 v[118:119], v10 offset:47376
    v_mfma_f32_16x16x32_bf16 v[140:143], v[124:127], v[40:43], v[140:143]
    ds_read_b64_tr_b16 v[120:121], v10 offset:46104
    ds_read_b64_tr_b16 v[122:123], v10 offset:47384
    v_mfma_f32_16x16x32_bf16 v[144:147], v[128:131], v[40:43], v[144:147]
    ds_read_b64_tr_b16 v[124:125], v10 offset:46112
    ds_read_b64_tr_b16 v[126:127], v10 offset:47392
    v_mfma_f32_16x16x32_bf16 v[148:151], v[132:135], v[40:43], v[148:151]
    ds_read_b64_tr_b16 v[128:129], v10 offset:51200
    ds_read_b64_tr_b16 v[130:131], v10 offset:52480
    s_waitcnt lgkmcnt(6)
    v_mfma_f32_16x16x32_bf16 v[152:155], v[104:107], v[40:43], v[152:155]
    ds_read_b64_tr_b16 v[132:133], v10 offset:51208
    ds_read_b64_tr_b16 v[134:135], v10 offset:52488
    v_mfma_f32_16x16x32_bf16 v[136:139], v[108:111], v[44:47], v[136:139]
    ds_read_b64_tr_b16 v[104:105], v10 offset:51216
    ds_read_b64_tr_b16 v[106:107], v10 offset:52496
    v_mfma_f32_16x16x32_bf16 v[140:143], v[112:115], v[44:47], v[140:143]
    ds_read_b64_tr_b16 v[108:109], v10 offset:51224
    ds_read_b64_tr_b16 v[110:111], v10 offset:52504
    v_mfma_f32_16x16x32_bf16 v[144:147], v[116:119], v[44:47], v[144:147]
    ds_read_b64_tr_b16 v[112:113], v10 offset:51232
    ds_read_b64_tr_b16 v[114:115], v10 offset:52512
    s_waitcnt lgkmcnt(6)
    v_mfma_f32_16x16x32_bf16 v[148:151], v[120:123], v[44:47], v[148:151]
    ds_read_b32 v14, v13 offset:192
    ds_read_b64_tr_b16 v[116:117], v10 offset:56320
    ds_read_b64_tr_b16 v[118:119], v10 offset:57600
    v_mfma_f32_16x16x32_bf16 v[152:155], v[124:127], v[44:47], v[152:155]
    ds_read_b64_tr_b16 v[120:121], v10 offset:56328
    ds_read_b64_tr_b16 v[122:123], v10 offset:57608
    v_mfma_f32_16x16x32_bf16 v[136:139], v[128:131], v[48:51], v[136:139]
    ds_read_b64_tr_b16 v[124:125], v10 offset:56336
    ds_read_b64_tr_b16 v[126:127], v10 offset:57616
    v_mfma_f32_16x16x32_bf16 v[140:143], v[132:135], v[48:51], v[140:143]
    ds_read_b64_tr_b16 v[128:129], v10 offset:56344
    ds_read_b64_tr_b16 v[130:131], v10 offset:57624
    s_waitcnt lgkmcnt(6)
    v_cmp_eq_u32 vcc, 0, v14
    v_mfma_f32_16x16x32_bf16 v[144:147], v[104:107], v[48:51], v[144:147]
    ds_read_b64_tr_b16 v[132:133], v10 offset:56352
    ds_read_b64_tr_b16 v[134:135], v10 offset:57632
    v_mfma_f32_16x16x32_bf16 v[148:151], v[108:111], v[48:51], v[148:151]
    s_cbranch_vccnz fs_20
fr_21:
    ds_read_b64_tr_b16 v[104:105], v11 offset:0
    ds_read_b64_tr_b16 v[106:107], v11 offset:1280
    v_mfma_f32_16x16x32_bf16 v[152:155], v[112:115], v[48:51], v[152:155]
    ds_read_b64_tr_b16 v[108:109], v11 offset:8
    ds_read_b64_tr_b16 v[110:111], v11 offset:1288
    v_mfma_f32_16x16x32_bf16 v[136:139], v[116:119], v[52:55], v[136:139]
    ds_read_b64_tr_b16 v[112:113], v11 offset:16
    ds_read_b64_tr_b16 v[114:115], v11 offset:1296
    s_waitcnt lgkmcnt(6)
    v_mfma_f32_16x16x32_bf16 v[140:143], v[120:123], v[52:55], v[140:143]
    ds_write_b32 v12, v12 offset:432
    ds_read_b64_tr_b16 v[116:117], v11 offset:24
    ds_read_b64_tr_b16 v[118:119], v11 offset:1304
    v_mfma_f32_16x16x32_bf16 v[144:147], v[124:127], v[52:55], v[144:147]
    ds_read_b64_tr_b16 v[120:121], v11 offset:32
    ds_read_b64_tr_b16 v[122:123], v11 offset:1312
    v_mfma_f32_16x16x32_bf16 v[148:151], v[128:131], v[52:55], v[148:151]
    ds_read_b64_tr_b16 v[124:125], v11 offset:5120
    ds_read_b64_tr_b16 v[126:127], v11 offset:6400
    v_mfma_f32_16x16x32_bf16 v[152:155], v[132:135], v[52:55], v[152:155]
    ds_read_b64_tr_b16 v[128:129], v11 offset:5128
    ds_read_b64_tr_b16 v[130:131], v11 offset:6408
    s_waitcnt lgkmcnt(6)
    v_mfma_f32_16x16x32_bf16 v[136:139], v[104:107], v[56:59], v[136:139]
    ds_read_b64_tr_b16 v[132:133], v11 offset:5136
    ds_read_b64_tr_b16 v[134:135], v11 offset:6416
    v_mfma_f32_16x16x32_bf16 v[140:143], v[108:111], v[56:59], v[140:143]
    ds_read_b64_tr_b16 v[104:105], v11 offset:5144
    ds_read_b64_tr_b16 v[106:107], v11 offset:6424
    v_mfma_f32_16x16x32_bf16 v[144:147], v[112:115], v[56:59], v[144:147]
    ds_read_b64_tr_b16 v[108:109], v11 offset:5152
    ds_read_b64_tr_b16 v[110:111], v11 offset:6432
    v_mfma_f32_16x16x32_bf16 v[148:151], v[116:119], v[56:59], v[148:151]
    ds_read_b64_tr_b16 v[112:113], v11 offset:10240
    ds_read_b64_tr_b16 v[114:115], v11 offset:11520
    s_waitcnt lgkmcnt(6)
    v_mfma_f32_16x16x32_bf16 v[152:155], v[120:123], v[56:59], v[152:155]
    ds_read_b64_tr_b16 v[116:117], v11 offset:10248
    ds_read_b64_tr_b16 v[118:119], v11 offset:11528
    v_mfma_f32_16x16x32_bf16 v[136:139], v[124:127], v[60:63], v[136:139]
    ds_read_b64_tr_b16 v[120:121], v11 offset:10256
    ds_read_b64_tr_b16 v[122:123], v11 offset:11536
    v_mfma_f32_16x16x32_bf16 v[140:143], v[128:131], v[60:63], v[140:143]
    ds_read_b64_tr_b16 v[124:125], v11 offset:10264
    ds_read_b64_tr_b16 v[126:127], v11 offset:11544
    v_mfma_f32_16x16x32_bf16 v[144:147], v[132:135], v[60:63], v[144:147]
    ds_read_b64_tr_b16 v[128:129], v11 offset:10272
    ds_read_b64_tr_b16 v[130:131], v11 offset:11552
    s_waitcnt lgkmcnt(6)
    v_mfma_f32_16x16x32_bf16 v[148:151], v[104:107], v[60:63], v[148:151]
    ds_read_b32 v14, v13 offset:208
    ds_read_b64_tr_b16 v[132:133], v11 offset:15360
    ds_read_b64_tr_b16 v[134:135], v11 offset:16640
    v_mfma_f32_16x16x32_bf16 v[152:155], v[108:111], v[60:63], v[152:155]
    ds_read_b64_tr_b16 v[104:105], v11 offset:15368
    ds_read_b64_tr_b16 v[106:107], v11 offset:16648
    v_mfma_f32_16x16x32_bf16 v[136:139], v[112:115], v[64:67], v[136:139]
    ds_read_b64_tr_b16 v[108:109], v11 offset:15376
    ds_read_b64_tr_b16 v[110:111], v11 offset:16656
    v_mfma_f32_16x16x32_bf16 v[140:143], v[116:119], v[64:67], v[140:143]
    ds_read_b64_tr_b16 v[112:113], v11 offset:15384
    ds_read_b64_tr_b16 v[114:115], v11 offset:16664
    s_waitcnt lgkmcnt(6)
    v_cmp_eq_u32 vcc, 0, v14
    v_mfma_f32_16x16x32_bf16 v[144:147], v[120:123], v[64:67], v[144:147]
    ds_read_b64_tr_b16 v[116:117], v11 offset:15392
    ds_read_b64_tr_b16 v[118:119], v11 offset:16672
    v_mfma_f32_16x16x32_bf16 v[148:151], v[124:127], v[64:67], v[148:151]
    s_cbranch_vccnz fs_22
fr_23:
    ds_read_b64_tr_b16 v[120:121], v9 offset:0
    ds_read_b64_tr_b16 v[122:123], v9 offset:1280
    v_mfma_f32_16x16x32_bf16 v[152:155], v[128:131], v[64:67], v[152:155]
    ds_read_b64_tr_b16 v[124:125], v9 offset:8
    ds_read_b64_tr_b16 v[126:127], v9 offset:1288
    v_mfma_f32_16x16x32_bf16 v[136:139], v[132:135], v[68:71], v[136:139]
    ds_read_b64_tr_b16 v[128:129], v9 offset:16
    ds_read_b64_tr_b16 v[130:131], v9 offset:1296
    s_waitcnt lgkmcnt(6)
    v_mfma_f32_16x16x32_bf16 v[140:143], v[104:107], v[68:71], v[140:143]
    ds_write_b32 v12, v12 offset:448
    ds_read_b64_tr_b16 v[132:133], v9 offset:24
    ds_read_b64_tr_b16 v[134:135], v9 offset:1304
    v_mfma_f32_16x16x32_bf16 v[144:147], v[108:111], v[68:71], v[144:147]
    ds_read_b64_tr_b16 v[104:105], v9 offset:32
    ds_read_b64_tr_b16 v[106:107], v9 offset:1312
    v_mfma_f32_16x16x32_bf16 v[148:151], v[112:115], v[68:71], v[148:151]
    s_branch pg_24
    .p2align 12
pg_24:
    ds_read_b64_tr_b16 v[108:109], v9 offset:5120
    ds_read_b64_tr_b16 v[110:111], v9 offset:6400
    v_mfma_f32_16x16x32_bf16 v[152:155], v[116:119], v[68:71], v[152:155]
    ds_read_b64_tr_b16 v[112:113], v9 offset:5128
    ds_read_b64_tr_b16 v[114:115], v9 offset:6408
    s_waitcnt lgkmcnt(6)
    v_mfma_f32_16x16x32_bf16 v[136:139], v[120:123], v[72:75], v[136:139]
    ds_read_b64_tr_b16 v[116:117], v9 offset:5136
    ds_read_b64_tr_b16 v[118:119], v9 offset:6416
    v_mfma_f32_16x16x32_bf16 v[140:143], v[124:127], v[72:75], v[140:143]
    ds_read_b64_tr_b16 v[120:121], v9 offset:5144
    ds_read_b64_tr_b16 v[122:123], v9 offset:6424
    v_mfma_f32_16x16x32_bf16 v[144:147], v[128:131], v[72:75], v[144:147]
    ds_read_b64_tr_b16 v[124:125], v9 offset:5152
    ds_read_b64_tr_b16 v[126:127], v9 offset:6432
    v_mfma_f32_16x16x32_bf16 v[148:151], v[132:135], v[72:75], v[148:151]
    ds_read_b64_tr_b16 v[128:129], v9 offset:10240
    ds_read_b64_tr_b16 v[130:131], v9 offset:11520
    s_waitcnt lgkmcnt(6)
    v_mfma_f32_16x16x32_bf16 v[152:155], v[104:107], v[72:75], v[152:155]
    ds_read_b64_tr_b16 v[132:133], v9 offset:10248
    ds_read_b64_tr_b16 v[134:135], v9 offset:11528
    v_mfma_f32_16x16x32_bf16 v[136:139], v[108:111], v[76:79], v[136:139]
    ds_read_b64_tr_b16 v[104:105], v9 offset:10256
    ds_read_b64_tr_b16 v[106:107], v9 offset:11536
    v_mfma_f32_16x16x32_bf16 v[140:143], v[112:115], v[76:79], v[140:143]
    ds_read_b64_tr_b16 v[108:109], v9 offset:10264
    ds_read_b64_tr_b16 v[110:111], v9 offset:11544
    v_mfma_f32_16x16x32_bf16 v[144:147], v[116:119], v[76:79], v[144:147]
    ds_read_b64_tr_b16 v[112:113], v9 offset:10272
    ds_read_b64_tr_b16 v[114:115], v9 offset:11552
    s_waitcnt lgkmcnt(6)
    v_mfma_f32_16x16x32_bf16 v[148:151], v[120:123], v[76:79], v[148:151]
    ds_read_b32 v14, v13 offset:224
    ds_read_b64_tr_b16 v[116:117], v9 offset:15360
    ds_read_b64_tr_b16 v[118:119], v9 offset:16640
    v_mfma_f32_16x16x32_bf16 v[152:155], v[124:127], v[76:79], v[152:155]
    ds_read_b64_tr_b16 v[120:121], v9 offset:15368
    ds_read_b64_tr_b16 v[122:123], v9 offset:16648
    v_mfma_f32_16x16x32_bf16 v[136:139], v[128:131], v[80:83], v[136:139]
    ds_read_b64_tr_b16 v[124:125], v9 offset:15376
    ds_read_b64_tr_b16 v[126:127], v9 offset:16656
    v_mfma_f32_16x16x32_bf16 v[140:143], v[132:135], v[80:83], v[140:143]
    ds_read_b64_tr_b16 v[128:129], v9 offset:15384
    ds_read_b64_tr_b16 v[130:131], v9 offset:16664
    s_waitcnt lgkmcnt(6)
    v_cmp_eq_u32 vcc, 0, v14
    v_mfma_f32_16x16x32_bf16 v[144:147], v[104:107], v[80:83], v[144:147]
    ds_read_b64_tr_b16 v[132:133], v9 offset:15392
    ds_read_b64_tr_b16 v[134:135], v9 offset:16672
    v_mfma_f32_16x16x32_bf16 v[148:151], v[108:111], v[80:83], v[148:151]
    s_cbranch_vccnz fs_25
fr_26:
    ds_read_b64_tr_b16 v[104:105], v9 offset:20480
    ds_read_b64_tr_b16 v[106:107], v9 offset:21760
    v_mfma_f32_16x16x32_bf16 v[152:155], v[112:115], v[80:83], v[152:155]
    ds_read_b64_tr_b16 v[108:109], v9 offset:20488
    ds_read_b64_tr_b16 v[110:111], v9 offset:21768
    v_mfma_f32_16x16x32_bf16 v[136:139], v[116:119], v[84:87], v[136:139]
    ds_read_b64_tr_b16 v[112:113], v9 offset:20496
    ds_read_b64_tr_b16 v[114:115], v9 offset:21776
    s_waitcnt lgkmcnt(6)
    v_mfma_f32_16x16x32_bf16 v[140:143], v[120:123], v[84:87], v[140:143]
    ds_write_b32 v12, v12 offset:464
    ds_read_b64_tr_b16 v[116:117], v9 offset:20504
    ds_read_b64_tr_b16 v[118:119], v9 offset:21784
    v_mfma_f32_16x16x32_bf16 v[144:147], v[124:127], v[84:87], v[144:147]
    ds_read_b64_tr_b16 v[120:121], v9 offset:20512
    ds_read_b64_tr_b16 v[122:123], v9 offset:21792
    v_mfma_f32_16x16x32_bf16 v[148:151], v[128:131], v[84:87], v[148:151]
    ds_read_b64_tr_b16 v[124:125], v9 offset:25600
    ds_read_b64_tr_b16 v[126:127], v9 offset:26880
    v_mfma_f32_16x16x32_bf16 v[152:155], v[132:135], v[84:87], v[152:155]
    ds_read_b64_tr_b16 v[128:129], v9 offset:25608
    ds_read_b64_tr_b16 v[130:131], v9 offset:26888
    s_waitcnt lgkmcnt(6)
    v_mfma_f32_16x16x32_bf16 v[136:139], v[104:107], v[88:91], v[136:139]
    ds_read_b64_tr_b16 v[132:133], v9 offset:25616
    ds_read_b64_tr_b16 v[134:135], v9 offset:26896
    v_mfma_f32_16x16x32_bf16 v[140:143], v[108:111], v[88:91], v[140:143]
    ds_read_b64_tr_b16 v[104:105], v9 offset:25624
    ds_read_b64_tr_b16 v[106:107], v9 offset:26904
    v_mfma_f32_16x16x32_bf16 v[144:147], v[112:115], v[88:91], v[144:147]
    ds_read_b64_tr_b16 v[108:109], v9 offset:25632
    ds_read_b64_tr_b16 v[110:111], v9 offset:26912
    v_mfma_f32_16x16x32_bf16 v[148:151], v[116:119], v[88:91], v[148:151]
    ds_read_b64_tr_b16 v[112:113], v9 offset:30720
    ds_read_b64_tr_b16 v[114:115], v9 offset:32000
    s_waitcnt lgkmcnt(6)
    v_mfma_f32_16x16x32_bf16 v[152:155], v[120:123], v[88:91], v[152:155]
    ds_read_b64_tr_b16 v[116:117], v9 offset:30728
    ds_read_b64_tr_b16 v[118:119], v9 offset:32008
    v_mfma_f32_16x16x32_bf16 v[136:139], v[124:127], v[92:95], v[136:139]
    ds_read_b64_tr_b16 v[120:121], v9 offset:30736
    ds_read_b64_tr_b16 v[122:123], v9 offset:32016
    v_mfma_f32_16x16x32_bf16 v[140:143], v[128:131], v[92:95], v[140:143]
    ds_read_b64_tr_b16 v[124:125], v9 offset:30744
    ds_read_b64_tr_b16 v[126:127], v9 offset:32024
    v_mfma_f32_16x16x32_bf16 v[144:147], v[132:135], v[92:95], v[144:147]
    ds_read_b64_tr_b16 v[128:129], v9 offset:30752
    ds_read_b64_tr_b16 v[130:131], v9 offset:32032
    s_waitcnt lgkmcnt(6)
    v_mfma_f32_16x16x32_bf16 v[148:151], v[104:107], v[92:95], v[148:151]
    ds_read_b64_tr_b16 v[132:133], v9 offset:35840
    ds_read_b64_tr_b16 v[134:135], v9 offset:37120
    v_mfma_f32_16x16x32_bf16 v[152:155], v[108:111], v[92:95], v[152:155]
    ds_read_b64_tr_b16 v[104:105], v9 offset:35848
    ds_read_b64_tr_b16 v[106:107], v9 offset:37128
    v_mfma_f32_16x16x32_bf16 v[136:139], v[112:115], v[96:99], v[136:139]
    ds_read_b64_tr_b16 v[108:109], v9 offset:35856
    ds_read_b64_tr_b16 v[110:111], v9 offset:37136
    v_mfma_f32_16x16x32_bf16 v[140:143], v[116:119], v[96:99], v[140:143]
    ds_read_b64_tr_b16 v[112:113], v9 offset:35864
    ds_read_b64_tr_b16 v[114:115], v9 offset:37144
    s_waitcnt lgkmcnt(6)
    v_mfma_f32_16x16x32_bf16 v[144:147], v[120:123], v[96:99], v[144:147]
    ds_read_b64_tr_b16 v[116:117], v9 offset:35872
    ds_read_b64_tr_b16 v[118:119], v9 offset:37152
    v_mfma_f32_16x16x32_bf16 v[148:151], v[124:127], v[96:99], v[148:151]
    v_mfma_f32_16x16x32_bf16 v[152:155], v[128:131], v[96:99], v[152:155]
    v_mfma_f32_16x16x32_bf16 v[136:139], v[132:135], v[100:103], v[136:139]
    s_waitcnt lgkmcnt(0)
    v_mfma_f32_16x16x32_bf16 v[140:143], v[104:107], v[100:103], v[140:143]
    v_mfma_f32_16x16x32_bf16 v[144:147], v[108:111], v[100:103], v[144:147]
    v_mfma_f32_16x16x32_bf16 v[148:151], v[112:115], v[100:103], v[148:151]
    v_mfma_f32_16x16x32_bf16 v[152:155], v[116:119], v[100:103], v[152:155]
    ds_read_b32 v20, v13 offset:448
    s_nop 1
    s_nop 0
    v_cvt_pk_bf16_f32 v156, v136, v137
    v_cvt_pk_bf16_f32 v157, v138, v139
    v_cvt_pk_bf16_f32 v158, v140, v141
    v_cvt_pk_bf16_f32 v159, v142, v143
    v_cvt_pk_bf16_f32 v160, v144, v145
    v_cvt_pk_bf16_f32 v161, v146, v147
    v_cvt_pk_bf16_f32 v162, v148, v149
    v_cvt_pk_bf16_f32 v163, v150, v151
    v_cvt_pk_bf16_f32 v164, v152, v153
    v_cvt_pk_bf16_f32 v165, v154, v155
    v_mfma_f32_16x16x32_bf16 v[168:171], v[188:191], v[156:159], 0
    v_mfma_f32_16x16x32_bf16 v[168:171], v[192:195], v[160:163], v[168:171]
    v_mfma_f32_16x16x32_bf16 v[168:171], v[196:199], v[164:167], v[168:171]
    v_mfma_f32_16x16x32_bf16 v[172:175], v[198:201], v[156:159], 0
    v_mfma_f32_16x16x32_bf16 v[172:175], v[202:205], v[160:163], v[172:175]
    v_mfma_f32_16x16x32_bf16 v[172:175], v[206:209], v[164:167], v[172:175]
    v_mfma_f32_16x16x32_bf16 v[176:179], v[208:211], v[156:159], 0
    v_mfma_f32_16x16x32_bf16 v[176:179], v[212:215], v[160:163], v[176:179]
    v_mfma_f32_16x16x32_bf16 v[176:179], v[216:219], v[164:167], v[176:179]
    v_mfma_f32_16x16x32_bf16 v[180:183], v[218:221], v[156:159], 0
    s_nop 0
    s_nop 0
    v_cvt_pk_bf16_f32 v168, 0, v168
    v_cvt_pk_bf16_f32 v169, 0, v169
    v_mfma_f32_16x16x32_bf16 v[180:183], v[222:225], v[160:163], v[180:183]
    v_cvt_pk_bf16_f32 v170, 0, v170
    v_cvt_pk_bf16_f32 v171, 0, v171
    v_mfma_f32_16x16x32_bf16 v[180:183], v[226:229], v[164:167], v[180:183]
    v_cvt_pk_bf16_f32 v172, 0, v172
    v_cvt_pk_bf16_f32 v173, 0, v173
    v_mfma_f32_16x16x32_bf16 v[184:187], v[228:231], v[156:159], 0
    v_cvt_pk_bf16_f32 v174, 0, v174
    v_cvt_pk_bf16_f32 v175, 0, v175
    v_mfma_f32_16x16x32_bf16 v[184:187], v[232:235], v[160:163], v[184:187]
    v_cvt_pk_bf16_f32 v176, 0, v176
    v_cvt_pk_bf16_f32 v177, 0, v177
    v_mfma_f32_16x16x32_bf16 v[184:187], v[236:239], v[164:167], v[184:187]
    v_cvt_pk_bf16_f32 v178, 0, v178
    v_cvt_pk_bf16_f32 v179, 0, v179
    v_max3_f32 v14, v168, v169, v170
    v_min3_f32 v15, v168, v169, v170
    v_max3_f32 v14, v14, v171, v172
    v_min3_f32 v15, v15, v171, v172
    v_max3_f32 v14, v14, v173, v174
    v_min3_f32 v15, v15, v173, v174
    v_max3_f32 v14, v14, v175, v176
    v_min3_f32 v15, v15, v175, v176
    v_max3_f32 v14, v14, v177, v178
    v_min3_f32 v15, v15, v177, v178
    v_cvt_pk_bf16_f32 v180, 0, v180
    v_cvt_pk_bf16_f32 v181, 0, v181
    v_cvt_pk_bf16_f32 v182, 0, v182
    v_cvt_pk_bf16_f32 v183, 0, v183
    v_cvt_pk_bf16_f32 v184, 0, v184
    v_cvt_pk_bf16_f32 v185, 0, v185
    v_cvt_pk_bf16_f32 v186, 0, v186
    v_cvt_pk_bf16_f32 v187, 0, v187
    v_max3_f32 v14, v14, v179, v180
    v_min3_f32 v15, v15, v179, v180
    v_max3_f32 v14, v14, v181, v182
    v_min3_f32 v15, v15, v181, v182
    v_max3_f32 v14, v14, v183, v184
    v_min3_f32 v15, v15, v183, v184
    v_max3_f32 v14, v14, v185, v186
    v_min3_f32 v15, v15, v185, v186
    v_max_f32 v14, v14, v187
    v_min_f32 v15, v15, v187
    v_mul_f32 v14, s64, v14
    v_mul_f32 v16, s64, v15
    v_pk_fma_f32 v[104:105], v[168:169], s[64:65], v[14:15] op_sel_hi:[1,0,0] neg_lo:[0,0,1] neg_hi:[0,0,1]
    v_pk_fma_f32 v[106:107], v[170:171], s[64:65], v[14:15] op_sel_hi:[1,0,0] neg_lo:[0,0,1] neg_hi:[0,0,1]
    v_pk_fma_f32 v[108:109], v[172:173], s[64:65], v[14:15] op_sel_hi:[1,0,0] neg_lo:[0,0,1] neg_hi:[0,0,1]
    v_pk_fma_f32 v[110:111], v[174:175], s[64:65], v[14:15] op_sel_hi:[1,0,0] neg_lo:[0,0,1] neg_hi:[0,0,1]
    v_pk_fma_f32 v[112:113], v[176:177], s[64:65], v[14:15] op_sel_hi:[1,0,0] neg_lo:[0,0,1] neg_hi:[0,0,1]
    v_pk_fma_f32 v[114:115], v[178:179], s[64:65], v[14:15] op_sel_hi:[1,0,0] neg_lo:[0,0,1] neg_hi:[0,0,1]
    v_pk_fma_f32 v[116:117], v[180:181], s[64:65], v[14:15] op_sel_hi:[1,0,0] neg_lo:[0,0,1] neg_hi:[0,0,1]
    v_pk_fma_f32 v[118:119], v[182:183], s[64:65], v[14:15] op_sel_hi:[1,0,0] neg_lo:[0,0,1] neg_hi:[0,0,1]
    v_pk_fma_f32 v[120:121], v[184:185], s[64:65], v[14:15] op_sel_hi:[1,0,0] neg_lo:[0,0,1] neg_hi:[0,0,1]
    v_pk_fma_f32 v[122:123], v[186:187], s[64:65], v[14:15] op_sel_hi:[1,0,0] neg_lo:[0,0,1] neg_hi:[0,0,1]
    v_pk_fma_f32 v[124:125], v[168:169], s[64:65], v[16:17] op_sel_hi:[1,0,0] neg_lo:[1,0,0] neg_hi:[1,0,0]
    v_pk_fma_f32 v[126:127], v[170:171], s[64:65], v[16:17] op_sel_hi:[1,0,0] neg_lo:[1,0,0] neg_hi:[1,0,0]
    v_pk_fma_f32 v[128:129], v[172:173], s[64:65], v[16:17] op_sel_hi:[1,0,0] neg_lo:[1,0,0] neg_hi:[1,0,0]
    v_pk_fma_f32 v[130:131], v[174:175], s[64:65], v[16:17] op_sel_hi:[1,0,0] neg_lo:[1,0,0] neg_hi:[1,0,0]
    v_pk_fma_f32 v[132:133], v[176:177], s[64:65], v[16:17] op_sel_hi:[1,0,0] neg_lo:[1,0,0] neg_hi:[1,0,0]
    v_pk_fma_f32 v[134:135], v[178:179], s[64:65], v[16:17] op_sel_hi:[1,0,0] neg_lo:[1,0,0] neg_hi:[1,0,0]
    v_pk_fma_f32 v[136:137], v[180:181], s[64:65], v[16:17] op_sel_hi:[1,0,0] neg_lo:[1,0,0] neg_hi:[1,0,0]
    v_pk_fma_f32 v[138:139], v[182:183], s[64:65], v[16:17] op_sel_hi:[1,0,0] neg_lo:[1,0,0] neg_hi:[1,0,0]
    v_pk_fma_f32 v[140:141], v[184:185], s[64:65], v[16:17] op_sel_hi:[1,0,0] neg_lo:[1,0,0] neg_hi:[1,0,0]
    v_pk_fma_f32 v[142:143], v[186:187], s[64:65], v[16:17] op_sel_hi:[1,0,0] neg_lo:[1,0,0] neg_hi:[1,0,0]
    v_exp_f32 v104, v104
    v_exp_f32 v105, v105
    v_exp_f32 v106, v106
    v_exp_f32 v107, v107
    v_exp_f32 v108, v108
    v_exp_f32 v109, v109
    v_exp_f32 v110, v110
    v_exp_f32 v111, v111
    v_exp_f32 v112, v112
    v_exp_f32 v113, v113
    v_exp_f32 v114, v114
    v_exp_f32 v115, v115
    v_exp_f32 v116, v116
    v_exp_f32 v117, v117
    v_exp_f32 v118, v118
    v_exp_f32 v119, v119
    v_exp_f32 v120, v120
    v_exp_f32 v121, v121
    v_exp_f32 v122, v122
    v_exp_f32 v123, v123
    v_pk_add_f32 v[14:15], v[104:105], v[106:107]
    v_pk_add_f32 v[14:15], v[14:15], v[108:109]
    v_pk_add_f32 v[14:15], v[14:15], v[110:111]
    v_pk_add_f32 v[14:15], v[14:15], v[112:113]
    v_pk_add_f32 v[14:15], v[14:15], v[114:115]
    v_pk_add_f32 v[14:15], v[14:15], v[116:117]
    v_pk_add_f32 v[14:15], v[14:15], v[118:119]
    v_pk_add_f32 v[14:15], v[14:15], v[120:121]
    v_pk_add_f32 v[14:15], v[14:15], v[122:123]
    v_add_f32 v14, v14, v15
    v_rcp_f32_e64 v14, v14
    s_nop 0
    v_pk_mul_f32 v[104:105], v[104:105], v[14:15] op_sel_hi:[1,0]
    v_pk_mul_f32 v[106:107], v[106:107], v[14:15] op_sel_hi:[1,0]
    v_pk_mul_f32 v[108:109], v[108:109], v[14:15] op_sel_hi:[1,0]
    v_pk_mul_f32 v[110:111], v[110:111], v[14:15] op_sel_hi:[1,0]
    v_pk_mul_f32 v[112:113], v[112:113], v[14:15] op_sel_hi:[1,0]
    v_pk_mul_f32 v[114:115], v[114:115], v[14:15] op_sel_hi:[1,0]
    v_pk_mul_f32 v[116:117], v[116:117], v[14:15] op_sel_hi:[1,0]
    v_pk_mul_f32 v[118:119], v[118:119], v[14:15] op_sel_hi:[1,0]
    v_pk_mul_f32 v[120:121], v[120:121], v[14:15] op_sel_hi:[1,0]
    v_pk_mul_f32 v[122:123], v[122:123], v[14:15] op_sel_hi:[1,0]
    v_exp_f32 v124, v124
    v_exp_f32 v125, v125
    v_exp_f32 v126, v126
    v_exp_f32 v127, v127
    v_exp_f32 v128, v128
    v_exp_f32 v129, v129
    v_exp_f32 v130, v130
    v_exp_f32 v131, v131
    v_exp_f32 v132, v132
    v_exp_f32 v133, v133
    v_exp_f32 v134, v134
    v_exp_f32 v135, v135
    v_exp_f32 v136, v136
    v_exp_f32 v137, v137
    v_exp_f32 v138, v138
    v_exp_f32 v139, v139
    v_exp_f32 v140, v140
    v_exp_f32 v141, v141
    v_exp_f32 v142, v142
    v_exp_f32 v143, v143
    v_pk_add_f32 v[16:17], v[124:125], v[126:127]
    v_pk_add_f32 v[16:17], v[16:17], v[128:129]
    v_pk_add_f32 v[16:17], v[16:17], v[130:131]
    v_pk_add_f32 v[16:17], v[16:17], v[132:133]
    v_pk_add_f32 v[16:17], v[16:17], v[134:135]
    v_pk_add_f32 v[16:17], v[16:17], v[136:137]
    v_pk_add_f32 v[16:17], v[16:17], v[138:139]
    v_pk_add_f32 v[16:17], v[16:17], v[140:141]
    v_pk_add_f32 v[16:17], v[16:17], v[142:143]
    v_add_f32 v16, v16, v17
    v_rcp_f32_e64 v16, v16
    s_nop 0
    v_pk_mul_f32 v[124:125], v[124:125], v[16:17] op_sel_hi:[1,0]
    v_pk_mul_f32 v[126:127], v[126:127], v[16:17] op_sel_hi:[1,0]
    v_pk_mul_f32 v[128:129], v[128:129], v[16:17] op_sel_hi:[1,0]
    v_pk_mul_f32 v[130:131], v[130:131], v[16:17] op_sel_hi:[1,0]
    v_pk_mul_f32 v[132:133], v[132:133], v[16:17] op_sel_hi:[1,0]
    v_pk_mul_f32 v[134:135], v[134:135], v[16:17] op_sel_hi:[1,0]
    v_pk_mul_f32 v[136:137], v[136:137], v[16:17] op_sel_hi:[1,0]
    v_pk_mul_f32 v[138:139], v[138:139], v[16:17] op_sel_hi:[1,0]
    v_pk_mul_f32 v[140:141], v[140:141], v[16:17] op_sel_hi:[1,0]
    v_pk_mul_f32 v[142:143], v[142:143], v[16:17] op_sel_hi:[1,0]
    v_mov_b32 v34, 0
    v_mov_b32 v35, 0
    v_mov_b32 v46, 0
    v_mov_b32 v47, 0
    v_mov_b32 v98, 0
    v_mov_b32 v99, 0
    s_waitcnt lgkmcnt(0)
    v_cmp_eq_u32_e64 vcc, 0, v20
    s_cbranch_vccnz fs_27
fr_28:
    v_cvt_pk_bf16_f32 v168, v104, v105
    v_cvt_pk_bf16_f32 v169, v106, v107
    v_cvt_pk_bf16_f32 v170, v108, v109
    v_cvt_pk_bf16_f32 v171, v110, v111
    ds_write_b128 v23, v[168:171] offset:0
    v_cvt_pk_bf16_f32 v172, v112, v113
    v_cvt_pk_bf16_f32 v173, v114, v115
    v_cvt_pk_bf16_f32 v174, v116, v117
    v_cvt_pk_bf16_f32 v175, v118, v119
    ds_write_b128 v23, v[172:175] offset:1024
    v_cvt_pk_bf16_f32 v176, v124, v125
    v_cvt_pk_bf16_f32 v177, v126, v127
    v_cvt_pk_bf16_f32 v178, v128, v129
    v_cvt_pk_bf16_f32 v179, v130, v131
    ds_write_b128 v23, v[176:179] offset:2048
    v_cvt_pk_bf16_f32 v180, v132, v133
    v_cvt_pk_bf16_f32 v181, v134, v135
    v_cvt_pk_bf16_f32 v182, v136, v137
    v_cvt_pk_bf16_f32 v183, v138, v139
    ds_write_b128 v23, v[180:183] offset:3072
    v_cvt_pk_bf16_f32 v184, v120, v121
    v_cvt_pk_bf16_f32 v185, v122, v123
    v_cvt_pk_bf16_f32 v186, v140, v141
    v_cvt_pk_bf16_f32 v187, v142, v143
    ds_write_b128 v23, v[184:187] offset:4096
    ds_write_b32 v12, v12 offset:576
    buffer_load_dwordx4 v[48:51], v251, s[16:19], s71 offen offset:0 sc1
    buffer_load_dwordx4 v[52:55], v251, s[16:19], s71 offen offset:768 sc1
    buffer_load_dwordx4 v[56:59], v251, s[16:19], s71 offen offset:1536 sc1
    buffer_load_dwordx4 v[60:63], v251, s[16:19], s71 offen offset:2304 sc1
    s_mov_b32 s57, 524288
fw_29:
    ds_read_b32 v15, v13 offset:576
    s_waitcnt lgkmcnt(0)
    v_cmp_eq_u32 vcc, 0, v15
    s_cbranch_vccz fwe_30
    s_sub_u32 s57, s57, 1
    s_cbranch_scc0 fw_29
fwe_30:
    ds_read_b128 v[24:27], v252 offset:0
    ds_read_b128 v[28:31], v252 offset:1024
    ds_read_b64 v[32:33], v245 offset:4096
    ds_read_b128 v[36:39], v252 offset:512
    ds_read_b128 v[40:43], v252 offset:1536
    ds_read_b64 v[44:45], v245 offset:4608
    v_mov_b32 v107, s28
    s_mov_b32 s57, 65536
ga_31:
    s_waitcnt vmcnt(0)
    v_xor_b32 v15, s28, v48
    v_bitop3_b32 v15, v15, v55, v107 bitop3:0xf6
    v_bitop3_b32 v15, v15, v56, v107 bitop3:0xf6
    v_bitop3_b32 v15, v15, v63, v107 bitop3:0xf6
    v_cmp_ne_u32 vcc, 0, v15
    s_cbranch_vccnz gr_32
gae_33:
    v_lshl_or_b32 v96, v54, 16, v49
    v_lshl_or_b32 v97, v62, 16, v57
    s_waitcnt lgkmcnt(0)
    v_mfma_f32_32x32x16_bf16 v[64:79], v[50:53], v[24:27], 0
    v_mfma_f32_32x32x16_bf16 v[64:79], v[58:61], v[28:31], v[64:79]
    v_mfma_f32_32x32x16_bf16 v[64:79], v[96:99], v[32:35], v[64:79]
    v_mfma_f32_32x32x16_bf16 v[80:95], v[50:53], v[36:39], 0
    v_mfma_f32_32x32x16_bf16 v[80:95], v[58:61], v[40:43], v[80:95]
    v_mfma_f32_32x32x16_bf16 v[80:95], v[96:99], v[44:47], v[80:95]
    s_nop 8
    v_cvt_pk_bf16_f32 v76, 0, v76
    v_add_f32 v76, 0x358637bd, v76
    v_cvt_pk_bf16_f32 v76, 0, v76
    v_rcp_f32_e64 v76, v76
    v_cvt_pk_bf16_f32 v64, 0, v64
    v_cvt_pk_bf16_f32 v65, 0, v65
    v_cvt_pk_bf16_f32 v66, 0, v66
    v_cvt_pk_bf16_f32 v67, 0, v67
    v_cvt_pk_bf16_f32 v68, 0, v68
    v_cvt_pk_bf16_f32 v69, 0, v69
    v_cvt_pk_bf16_f32 v70, 0, v70
    v_cvt_pk_bf16_f32 v71, 0, v71
    v_mul_f32 v64, v76, v64
    v_mul_f32 v65, v76, v65
    v_mul_f32 v66, v76, v66
    v_mul_f32 v67, v76, v67
    v_mul_f32 v68, v76, v68
    v_mul_f32 v69, v76, v69
    v_mul_f32 v70, v76, v70
    v_mul_f32 v71, v76, v71
    v_cvt_pk_bf16_f32 v100, v64, v65
    v_cvt_pk_bf16_f32 v101, v66, v67
    v_cvt_pk_bf16_f32 v102, v68, v69
    v_cvt_pk_bf16_f32 v103, v70, v71
    buffer_store_dwordx4 v[100:103], v4, s[16:19], s69 offen offset:0 sc1
    v_cvt_pk_bf16_f32 v92, 0, v92
    v_add_f32 v92, 0x358637bd, v92
    v_cvt_pk_bf16_f32 v92, 0, v92
    v_rcp_f32_e64 v92, v92
    v_cvt_pk_bf16_f32 v80, 0, v80
    v_cvt_pk_bf16_f32 v81, 0, v81
    v_cvt_pk_bf16_f32 v82, 0, v82
    v_cvt_pk_bf16_f32 v83, 0, v83
    v_cvt_pk_bf16_f32 v84, 0, v84
    v_cvt_pk_bf16_f32 v85, 0, v85
    v_cvt_pk_bf16_f32 v86, 0, v86
    v_cvt_pk_bf16_f32 v87, 0, v87
    v_pk_mul_f32 v[80:81], v[80:81], v[92:93] op_sel_hi:[1,0]
    v_pk_mul_f32 v[82:83], v[82:83], v[92:93] op_sel_hi:[1,0]
    v_pk_mul_f32 v[84:85], v[84:85], v[92:93] op_sel_hi:[1,0]
    v_pk_mul_f32 v[86:87], v[86:87], v[92:93] op_sel_hi:[1,0]
    v_cvt_pk_bf16_f32 v108, v80, v81
    v_cvt_pk_bf16_f32 v109, v82, v83
    v_cvt_pk_bf16_f32 v110, v84, v85
    v_cvt_pk_bf16_f32 v111, v86, v87
    buffer_store_dwordx4 v[108:111], v4, s[16:19], s69 offen offset:1024 sc1
    v_cndmask_b32 v72, v72, v88, s[74:75]
    v_cndmask_b32 v73, v73, v89, s[74:75]
    v_cndmask_b32 v74, v74, v90, s[74:75]
    v_cndmask_b32 v75, v75, v91, s[74:75]
    v_cndmask_b32 v76, v76, v92, s[74:75]
    v_cvt_pk_bf16_f32 v72, 0, v72
    v_cvt_pk_bf16_f32 v73, 0, v73
    v_cvt_pk_bf16_f32 v74, 0, v74
    v_cvt_pk_bf16_f32 v75, 0, v75
    v_pk_mul_f32 v[72:73], v[72:73], v[76:77] op_sel_hi:[1,0]
    v_pk_mul_f32 v[74:75], v[74:75], v[76:77] op_sel_hi:[1,0]
    v_cvt_pk_bf16_f32 v104, v72, v73
    v_cvt_pk_bf16_f32 v105, v74, v75
    v_add3_u32 v106, s28, v100, v101
    v_add3_u32 v106, v106, v102, v103
    v_add3_u32 v106, v106, v108, v109
    v_add3_u32 v106, v106, v110, v111
    v_add3_u32 v106, v106, v104, v105
    buffer_store_dwordx4 v[104:107], v4, s[16:19], s69 offen offset:2048 sc1
    s_cmp_ge_u32 s0, 5
    s_cbranch_scc1 L_G_aux
    s_mov_b32 s57, 524288
fw_34:
    ds_read_b32 v15, v13 offset:592
    s_waitcnt lgkmcnt(0)
    v_cmp_eq_u32 vcc, 0, v15
    s_cbranch_vccz fwe_35
    s_sub_u32 s57, s57, 1
    s_cbranch_scc0 fw_34
fwe_35:
    ds_write_b128 v6, v[100:103] offset:0
    ds_write_b128 v6, v[108:111] offset:1024
    ds_write_b64 v8, v[104:105] offset:0
    ds_write_b32 v12, v12 offset:640
    s_add_u32 m0, s62, 0
    s_and_b32 s30, s3, 7
    s_add_u32 s30, s30, 5
    s_cmp_ge_u32 s30, 8
    s_addc_u32 s30, s30, s4
    s_and_b32 s30, s30, 7
    s_mul_i32 s30, s30, 102400
    s_add_u32 s30, s30, s29
    buffer_load_dwordx4 v253, s[24:27], s30 offen lds
    s_add_u32 m0, s62, 1024
    s_add_u32 s30, s30, 5120
    buffer_load_dwordx4 v253, s[24:27], s30 offen lds
    s_add_u32 m0, s62, 2048
    s_add_u32 s30, s30, 5120
    buffer_load_dwordx4 v253, s[24:27], s30 offen lds
    s_add_u32 m0, s62, 3072
    s_add_u32 s30, s30, 5120
    buffer_load_dwordx4 v253, s[24:27], s30 offen lds
    s_add_u32 m0, s62, 4096
    s_add_u32 s30, s30, 5120
    buffer_load_dwordx4 v253, s[24:27], s30 offen lds
    s_add_u32 m0, s62, 20480
    s_and_b32 s30, s3, 7
    s_add_u32 s30, s30, 6
    s_cmp_ge_u32 s30, 8
    s_addc_u32 s30, s30, s4
    s_and_b32 s30, s30, 7
    s_mul_i32 s30, s30, 102400
    s_add_u32 s30, s30, s29
    buffer_load_dwordx4 v253, s[24:27], s30 offen lds
    s_add_u32 m0, s62, 21504
    s_add_u32 s30, s30, 5120
    buffer_load_dwordx4 v253, s[24:27], s30 offen lds
    s_add_u32 m0, s62, 22528
    s_add_u32 s30, s30, 5120
    buffer_load_dwordx4 v253, s[24:27], s30 offen lds
    s_add_u32 m0, s62, 23552
    s_add_u32 s30, s30, 5120
    buffer_load_dwordx4 v253, s[24:27], s30 offen lds
    s_add_u32 m0, s62, 24576
    s_add_u32 s30, s30, 5120
    buffer_load_dwordx4 v253, s[24:27], s30 offen lds
    s_mov_b32 s57, 524288
fw_36:
    ds_read_b32 v15, v13 offset:640
    s_waitcnt lgkmcnt(0)
    v_cmp_eq_u32 vcc, 0, v15
    s_cbranch_vccz fwe_37
    s_sub_u32 s57, s57, 1
    s_cbranch_scc0 fw_36
fwe_37:
    s_add_u32 m0, s62, 122880
    s_and_b32 s30, s3, 7
    s_add_u32 s30, s30, 7
    s_cmp_ge_u32 s30, 8
    s_addc_u32 s30, s30, s4
    s_and_b32 s30, s30, 7
    s_mul_i32 s30, s30, 102400
    s_add_u32 s30, s30, s29
    buffer_load_dwordx4 v253, s[24:27], s30 offen lds
    s_add_u32 m0, s62, 123904
    s_add_u32 s30, s30, 5120
    buffer_load_dwordx4 v253, s[24:27], s30 offen lds
    s_add_u32 m0, s62, 124928
    s_add_u32 s30, s30, 5120
    buffer_load_dwordx4 v253, s[24:27], s30 offen lds
    s_add_u32 m0, s62, 125952
    s_add_u32 s30, s30, 5120
    buffer_load_dwordx4 v253, s[24:27], s30 offen lds
    s_add_u32 m0, s62, 126976
    s_add_u32 s30, s30, 5120
    buffer_load_dwordx4 v253, s[24:27], s30 offen lds
    s_and_b32 s58, s3, 7
    s_add_u32 s58, s58, 1
    s_cmp_ge_u32 s58, 8
    s_addc_u32 s58, s58, s4
    s_and_b32 s58, s58, 7
    s_mul_i32 s58, s58, 12288
    s_add_u32 s36, s58, s72
    s_and_b32 s58, s3, 7
    s_add_u32 s58, s58, 2
    s_cmp_ge_u32 s58, 8
    s_addc_u32 s58, s58, s4
    s_and_b32 s58, s58, 7
    s_mul_i32 s58, s58, 12288
    s_add_u32 s37, s58, s72
    s_and_b32 s58, s3, 7
    s_add_u32 s58, s58, 3
    s_cmp_ge_u32 s58, 8
    s_addc_u32 s58, s58, s4
    s_and_b32 s58, s58, 7
    s_mul_i32 s58, s58, 12288
    s_add_u32 s38, s58, s72
    s_and_b32 s58, s3, 7
    s_add_u32 s58, s58, 4
    s_cmp_ge_u32 s58, 8
    s_addc_u32 s58, s58, s4
    s_and_b32 s58, s58, 7
    s_mul_i32 s58, s58, 12288
    s_add_u32 s39, s58, s72
    s_and_b32 s58, s3, 7
    s_add_u32 s58, s58, 5
    s_cmp_ge_u32 s58, 8
    s_addc_u32 s58, s58, s4
    s_and_b32 s58, s58, 7
    s_mul_i32 s58, s58, 12288
    s_add_u32 s40, s58, s72
    s_and_b32 s58, s3, 7
    s_add_u32 s58, s58, 6
    s_cmp_ge_u32 s58, 8
    s_addc_u32 s58, s58, s4
    s_and_b32 s58, s58, 7
    s_mul_i32 s58, s58, 12288
    s_add_u32 s41, s58, s72
    s_and_b32 s58, s3, 7
    s_add_u32 s58, s58, 7
    s_cmp_ge_u32 s58, 8
    s_addc_u32 s58, s58, s4
    s_and_b32 s58, s58, 7
    s_mul_i32 s58, s58, 12288
    s_add_u32 s42, s58, s72
    s_branch pg_38
    .p2align 12
pg_38:
    s_waitcnt vmcnt(15)
    s_lshl_b32 s43, s6, 11
    s_add_u32 m0, s43, 51200
    buffer_load_dwordx4 v[160:163], v4, s[16:19], s36 offen offset:2048 sc1
    buffer_load_dwordx4 v4, s[16:19], s36 offen sc1 lds
    buffer_load_dwordx4 v4, s[16:19], s36 offen offset:1024 sc1 lds
    s_add_u32 m0, s43, 61440
    buffer_load_dwordx4 v[172:175], v4, s[16:19], s37 offen offset:2048 sc1
    buffer_load_dwordx4 v4, s[16:19], s37 offen sc1 lds
    buffer_load_dwordx4 v4, s[16:19], s37 offen offset:1024 sc1 lds
    s_add_u32 m0, s43, 71680
    buffer_load_dwordx4 v[184:187], v4, s[16:19], s38 offen offset:2048 sc1
    buffer_load_dwordx4 v4, s[16:19], s38 offen sc1 lds
    buffer_load_dwordx4 v4, s[16:19], s38 offen offset:1024 sc1 lds
    s_waitcnt vmcnt(9)
    ds_write_b32 v12, v12 offset:768
    v_mov_b32 v125, 0
    v_dot2c_f32_bf16 v125, s66, v240
    v_dot2c_f32_bf16 v125, s66, v241
    v_dot2c_f32_bf16 v125, s66, v242
    v_dot2c_f32_bf16 v125, s66, v243
    v_dot2c_f32_bf16 v125, s66, v244
    s_nop 2
    v_add_f32_dpp v125, v125, v125 row_ror:1 row_mask:0xf bank_mask:0xf
    s_nop 1
    v_add_f32_dpp v125, v125, v125 row_ror:2 row_mask:0xf bank_mask:0xf
    s_nop 1
    v_add_f32_dpp v125, v125, v125 row_ror:4 row_mask:0xf bank_mask:0xf
    s_nop 1
    v_add_f32_dpp v125, v125, v125 row_ror:8 row_mask:0xf bank_mask:0xf
    v_mov_b32 v18, v125
    s_nop 1
    v_permlane16_swap_b32 v125, v18
    v_add_f32 v125, v125, v18
    v_mov_b32 v18, v125
    s_nop 1
    v_permlane32_swap_b32 v125, v18
    v_add_f32 v125, v125, v18
    s_mov_b32 s57, 65536
ga_39:
    s_waitcnt vmcnt(6)
    ds_read_b128 v[152:155], v6 offset:10240
    ds_read_b128 v[156:159], v6 offset:11264
    ds_write_b64 v8, v[160:161] offset:10240
    v_add3_u32 v17, s28, v160, v161
    s_waitcnt lgkmcnt(2)
    v_add3_u32 v17, v17, v152, v153
    v_add3_u32 v17, v17, v154, v155
    s_waitcnt lgkmcnt(1)
    v_add3_u32 v17, v17, v156, v157
    v_add3_u32 v17, v17, v158, v159
    v_cmp_ne_u32 vcc, v17, v162
    s_cbranch_vccnz gr_40
gae_41:
    ds_write_b32 v12, v12 offset:656
    s_add_u32 m0, s43, 81920
    buffer_load_dwordx4 v[196:199], v4, s[16:19], s39 offen offset:2048 sc1
    buffer_load_dwordx4 v4, s[16:19], s39 offen sc1 lds
    buffer_load_dwordx4 v4, s[16:19], s39 offen offset:1024 sc1 lds
    s_mov_b32 s57, 65536
ga_42:
    s_waitcnt vmcnt(6)
    ds_read_b128 v[164:167], v6 offset:20480
    ds_read_b128 v[168:171], v6 offset:21504
    ds_write_b64 v8, v[172:173] offset:20480
    v_add3_u32 v17, s28, v172, v173
    s_waitcnt lgkmcnt(2)
    v_add3_u32 v17, v17, v164, v165
    v_add3_u32 v17, v17, v166, v167
    s_waitcnt lgkmcnt(1)
    v_add3_u32 v17, v17, v168, v169
    v_add3_u32 v17, v17, v170, v171
    v_cmp_ne_u32 vcc, v17, v174
    s_cbranch_vccnz gr_43
gae_44:
    ds_write_b32 v12, v12 offset:672
    s_add_u32 m0, s43, 92160
    buffer_load_dwordx4 v[208:211], v4, s[16:19], s40 offen offset:2048 sc1
    buffer_load_dwordx4 v4, s[16:19], s40 offen sc1 lds
    buffer_load_dwordx4 v4, s[16:19], s40 offen offset:1024 sc1 lds
    s_mov_b32 s57, 65536
ga_45:
    s_waitcnt vmcnt(6)
    ds_read_b128 v[176:179], v6 offset:30720
    ds_read_b128 v[180:183], v6 offset:31744
    ds_write_b64 v8, v[184:185] offset:30720
    v_add3_u32 v17, s28, v184, v185
    s_waitcnt lgkmcnt(2)
    v_add3_u32 v17, v17, v176, v177
    v_add3_u32 v17, v17, v178, v179
    s_waitcnt lgkmcnt(1)
    v_add3_u32 v17, v17, v180, v181
    v_add3_u32 v17, v17, v182, v183
    v_cmp_ne_u32 vcc, v17, v186
    s_cbranch_vccnz gr_46
gae_47:
    ds_write_b32 v12, v12 offset:688
    s_add_u32 m0, s43, 102400
    buffer_load_dwordx4 v[220:223], v4, s[16:19], s41 offen offset:2048 sc1
    buffer_load_dwordx4 v4, s[16:19], s41 offen sc1 lds
    buffer_load_dwordx4 v4, s[16:19], s41 offen offset:1024 sc1 lds
    s_mov_b32 s57, 65536
ga_48:
    s_waitcnt vmcnt(6)
    ds_read_b128 v[188:191], v7 offset:0
    ds_read_b128 v[192:195], v7 offset:1024
    ds_write_b64 v5, v[196:197] offset:0
    v_add3_u32 v17, s28, v196, v197
    s_waitcnt lgkmcnt(2)
    v_add3_u32 v17, v17, v188, v189
    v_add3_u32 v17, v17, v190, v191
    s_waitcnt lgkmcnt(1)
    v_add3_u32 v17, v17, v192, v193
    v_add3_u32 v17, v17, v194, v195
    v_cmp_ne_u32 vcc, v17, v198
    s_cbranch_vccnz gr_49
gae_50:
    ds_write_b32 v12, v12 offset:704
    s_add_u32 m0, s43, 112640
    buffer_load_dwordx4 v[232:235], v4, s[16:19], s42 offen offset:2048 sc1
    buffer_load_dwordx4 v4, s[16:19], s42 offen sc1 lds
    buffer_load_dwordx4 v4, s[16:19], s42 offen offset:1024 sc1 lds
    v_mov_b32 v20, -1
    v_mov_b32 v21, -1
    v_mov_b32 v22, -1
    v_mov_b32_e64 v23, -1
    v_mul_u32_u24 v14, 1280, v3
    v_lshl_add_u32 v14, v2, 4, v14
    s_lshr_b32 s58, s6, 1
    s_mul_i32 s58, s58, 327680
    s_and_b32 s59, s6, 1
    s_mul_i32 s59, s59, 5120
    s_add_u32 s58, s58, s59
    s_mul_i32 s59, s3, 10240
    s_add_u32 s58, s58, s59
    s_lshl_b32 s59, s0, 8
    s_add_u32 s58, s58, s59
    s_add_u32 s58, s58, 6623232
    buffer_store_dwordx4 v[20:23], v14, s[16:19], s58 offen sc1
    s_mov_b32 s57, 65536
ga_51:
    s_waitcnt vmcnt(7)
    ds_read_b128 v[200:203], v7 offset:10240
    ds_read_b128 v[204:207], v7 offset:11264
    ds_write_b64 v5, v[208:209] offset:10240
    v_add3_u32 v17, s28, v208, v209
    s_waitcnt lgkmcnt(2)
    v_add3_u32 v17, v17, v200, v201
    v_add3_u32 v17, v17, v202, v203
    s_waitcnt lgkmcnt(1)
    v_add3_u32 v17, v17, v204, v205
    v_add3_u32 v17, v17, v206, v207
    v_cmp_ne_u32 vcc, v17, v210
    s_cbranch_vccnz gr_52
gae_53:
    ds_write_b32 v12, v12 offset:720
    s_mov_b32 s57, 65536
ga_54:
    s_waitcnt vmcnt(4)
    ds_read_b128 v[212:215], v7 offset:20480
    ds_read_b128 v[216:219], v7 offset:21504
    ds_write_b64 v5, v[220:221] offset:20480
    v_add3_u32 v17, s28, v220, v221
    s_waitcnt lgkmcnt(2)
    v_add3_u32 v17, v17, v212, v213
    v_add3_u32 v17, v17, v214, v215
    s_waitcnt lgkmcnt(1)
    v_add3_u32 v17, v17, v216, v217
    v_add3_u32 v17, v17, v218, v219
    v_cmp_ne_u32_e64 vcc, v17, v222
    s_cbranch_vccnz gr_55
gae_56:
    ds_write_b32 v12, v12 offset:736
    s_mov_b32 s57, 65536
ga_57:
    s_waitcnt vmcnt(1)
    ds_read_b128 v[224:227], v7 offset:30720
    ds_read_b128 v[228:231], v7 offset:31744
    ds_write_b64 v5, v[232:233] offset:30720
    v_add3_u32 v17, s28, v232, v233
    s_waitcnt lgkmcnt(2)
    v_add3_u32 v17, v17, v224, v225
    v_add3_u32 v17, v17, v226, v227
    s_waitcnt lgkmcnt(1)
    v_add3_u32 v17, v17, v228, v229
    v_add3_u32 v17, v17, v230, v231
    v_cmp_ne_u32 vcc, v17, v234
    s_cbranch_vccnz gr_58
gae_59:
    ds_write_b32 v12, v12 offset:752
    v_add_u32 v15, 143360, v4
    s_mul_i32 s73, s3, 5120
    s_add_u32 s73, s73, 6455296
    s_lshl_b32 s58, s0, 10
    s_add_u32 s58, s58, s73
    s_add_u32 s59, s73, 4096
    s_lshl_b32 s56, s3, 6
    s_sub_u32 s56, 2047, s56
    v_sub_u32 v60, s56, v1
    v_lshlrev_b32 v60, 3, v60
    v_lshlrev_b32 v61, 3, v1
    v_add_u32 v62, 160768, v4
    v_lshlrev_b32_e64 v63, 2, v1
    v_add_u32 v63, 161792, v63
    v_mov_b32 v65, s28
    s_lshl_b32 s68, s3, 7
    s_add_u32 s68, s68, 6619136
    s_mov_b32 s67, 0xffffc000
    v_lshlrev_b32 v14, 7, v1
    s_cmp_eq_u32 s6, 0
    s_cselect_b32 s56, s58, 0x7ff00000
    s_mov_b64 exec, 0xff
    buffer_load_dword v40, v14, s[16:19], s56 offen sc1
    s_mov_b64 exec, -1
    s_waitcnt vmcnt(0)
    s_barrier
    s_cmp_lg_u32 s6, 0
    s_cbranch_scc1 L_B_join
    ds_read_b96 v[24:26], v15 offset:0
    ds_read_b96 v[28:30], v15 offset:1024
    ds_read_b96 v[32:34], v15 offset:2048
    ds_read_b96 v[36:38], v15 offset:3072
    v_mov_b32_e64 v27, s28
    s_waitcnt lgkmcnt(2)
    v_pk_add_f32 v[24:25], v[24:25], v[28:29]
    v_add_f32 v26, v26, v30
    s_waitcnt lgkmcnt(0)
    v_pk_add_f32 v[32:33], v[32:33], v[36:37]
    v_add_f32_e64 v34, v34, v38
    v_pk_add_f32 v[24:25], v[24:25], v[32:33]
    v_add_f32 v26, v26, v34
    buffer_store_dwordx4 v[24:27], v4, s[16:19], s58 offen sc1
    buffer_load_dwordx4 v[40:43], v4, s[16:19], s73 offen offset:0 sc1
    buffer_load_dwordx4 v[44:47], v4, s[16:19], s73 offen offset:1024 sc1
    buffer_load_dwordx4 v[48:51], v4, s[16:19], s73 offen offset:2048 sc1
    buffer_load_dwordx4 v[52:55], v4, s[16:19], s73 offen offset:3072 sc1
    buffer_load_dwordx4 v[56:59], v4, s[16:19], s59 offen sc1
    s_mov_b32 s57, 65536
ga_60:
    s_waitcnt vmcnt(0)
    v_xor_b32_e64 v15, s28, v43
    v_bitop3_b32 v15, v15, v47, v65 bitop3:0xf6
    v_bitop3_b32 v15, v15, v51, v65 bitop3:0xf6
    v_bitop3_b32 v15, v15, v55, v65 bitop3:0xf6
    v_bitop3_b32 v15, v15, v59, v65 bitop3:0xf6
    v_cmp_ne_u32 vcc, 0, v15
    s_cbranch_vccnz gr_61
gae_62:
    v_pk_add_f32 v[40:41], v[40:41], v[44:45]
    v_pk_add_f32 v[48:49], v[48:49], v[52:53]
    v_pk_add_f32 v[40:41], v[40:41], v[56:57]
    v_pk_add_f32 v[40:41], v[40:41], v[48:49]
    v_add_f32 v42, v42, v46
    v_add_f32 v50, v50, v54
    v_add_f32 v42, v42, v58
    v_add_f32 v42, v42, v50
    v_mul_f32 v40, 0xbacccccd, v40
    v_mul_f32 v41, 0x3acccccd, v41
    v_fma_f32 v46, -v40, v40, v41
    v_max_f32_e64 v46, 0, v46
    v_cvt_pk_bf16_f32 v46, 0, v46
    v_add_f32 v46, 0x3727c5ac, v46
    v_cvt_pk_bf16_f32 v46, 0, v46
    v_sqrt_f32_e64 v46, v46
    v_cvt_pk_bf16_f32 v44, 0, v40
    v_cvt_pk_bf16_f32 v46, 0, v46
    v_rcp_f32 v45, v46
    v_fmac_f32 v42, v44, v125
    v_mul_f32 v42, v42, v45
    v_ashrrev_i32 v46, 31, v42
    v_or_b32 v46, 0x80000000, v46
    v_xor_b32_e64 v42, v42, v46
    v_and_or_b32 v46, v42, s67, v60
    v_mov_b32 v42, v46
    ds_write_b96 v62, v[44:46]
    s_nop 0
    v_mov_b32_dpp v43, v42 quad_perm:[1,0,3,2] row_mask:0xf bank_mask:0xf
    v_med3_u32 v42, v42, v43, v248
    s_nop 1
    v_mov_b32_dpp v43, v42 quad_perm:[3,2,1,0] row_mask:0xf bank_mask:0xf
    v_med3_u32 v42, v42, v43, v249
    s_nop 1
    v_mov_b32_dpp v43, v42 quad_perm:[1,0,3,2] row_mask:0xf bank_mask:0xf
    v_med3_u32 v42, v42, v43, v248
    s_nop 1
    v_mov_b32_dpp v43, v42 row_half_mirror row_mask:0xf bank_mask:0xf
    v_med3_u32 v42, v42, v43, v250
    s_nop 1
    v_mov_b32_dpp v43, v42 quad_perm:[2,3,0,1] row_mask:0xf bank_mask:0xf
    v_med3_u32 v42, v42, v43, v249
    s_nop 1
    v_mov_b32_dpp v43, v42 quad_perm:[1,0,3,2] row_mask:0xf bank_mask:0xf
    v_med3_u32 v42, v42, v43, v248
    s_nop 1
    v_max_u32_dpp v42, v42, v42 row_mirror row_mask:0xf bank_mask:0xf
    s_nop 1
    v_max_u32_dpp v43, v42, v42 row_shl:4 row_mask:0xf bank_mask:0x5
    s_nop 1
    v_min_u32_dpp v43, v42, v42 row_shr:4 row_mask:0xf bank_mask:0xa
    s_nop 1
    v_mov_b32_dpp v42, v43 quad_perm:[2,3,0,1] row_mask:0xf bank_mask:0xf
    v_med3_u32 v43, v43, v42, v249
    s_nop 1
    v_mov_b32_dpp v42, v43 quad_perm:[1,0,3,2] row_mask:0xf bank_mask:0xf
    v_med3_u32 v43, v43, v42, v248
    v_mov_b32 v42, v43
    s_nop 1
    v_permlane16_swap_b32 v43, v42
    s_nop 1
    v_max_u32_dpp v43, v42, v43 row_half_mirror row_mask:0xf bank_mask:0xf
    s_nop 1
    v_mov_b32_dpp v42, v43 row_ror:4 row_mask:0xf bank_mask:0xf
    v_med3_u32 v43, v43, v42, v250
    s_nop 1
    v_mov_b32_dpp v42, v43 quad_perm:[2,3,0,1] row_mask:0xf bank_mask:0xf
    v_med3_u32 v43, v43, v42, v249
    s_nop 1
    v_mov_b32_dpp v42, v43 quad_perm:[1,0,3,2] row_mask:0xf bank_mask:0xf
    v_med3_u32 v43, v43, v42, v248
    v_mov_b32_e64 v42, v43
    s_nop 1
    v_permlane32_swap_b32 v43, v42
    s_nop 1
    v_max_u32_dpp v43, v42, v43 row_half_mirror row_mask:0xf bank_mask:0xf
    s_nop 1
    v_mov_b32_dpp v42, v43 row_ror:4 row_mask:0xf bank_mask:0xf
    v_med3_u32 v43, v43, v42, v250
    s_nop 1
    v_mov_b32_dpp v42, v43 quad_perm:[2,3,0,1] row_mask:0xf bank_mask:0xf
    v_med3_u32 v43, v43, v42, v249
    s_nop 1
    v_mov_b32_dpp v42, v43 quad_perm:[1,0,3,2] row_mask:0xf bank_mask:0xf
    v_med3_u32 v43, v43, v42, v248
    v_or_b32 v64, v43, v1
    s_mov_b64 exec, 0xff
    s_cmp_lg_u32 s0, 2
    s_cbranch_scc1 L_nokey
    buffer_store_dwordx2 v[64:65], v61, s[16:19], s68 offen sc1
L_nokey:
    ds_write_b32 v63, v64
    s_mov_b64 exec, -1
    s_waitcnt lgkmcnt(0)
L_B_join:
    s_mov_b32 s24, s50
    s_and_b32 s25, s51, 0xffff
    s_mov_b32 s26, 2621440
    s_mov_b32 s27, 0x20000
    s_lshl_b32 s58, s5, 2
    s_add_u32 s58, s58, 161792
    v_mov_b32_e64 v16, s58
    v_mov_b32 v17, 161820
    s_lshl_b32 s58, s5, 3
    v_add_u32 v21, s58, v3
    v_add_u32 v22, 4, v21
    v_and_b32 v85, 7, v21
    v_xor_b32 v85, v85, v2
    v_lshlrev_b32 v85, 4, v85
    v_lshl_add_u32 v85, v21, 8, v85
    v_add_u32 v85, 81920, v85
    v_lshlrev_b32_e64 v89, 4, v21
    v_add_u32 v89, 160768, v89
    v_and_b32 v86, 7, v22
    v_xor_b32 v86, v86, v2
    v_lshlrev_b32_e64 v86, 4, v86
    v_lshl_add_u32 v86, v22, 8, v86
    v_add_u32 v86, 81920, v86
    v_lshlrev_b32_e64 v90, 4, v22
    v_add_u32 v90, 160768, v90
    s_lshl3_add_u32 s60, s3, s5
    s_mul_i32 s60, s60, 1280
    s_lshl_b32 s59, s0, 8
    s_add_u32 s60, s60, s59
    s_add_u32 s60, s60, 6623232
    s_add_u32 s61, s60, 327680
    s_mul_i32 s56, s3, 81920
    s_add_u32 s56, s56, s59
    v_lshlrev_b32 v18, 4, v2
    s_barrier
    ds_read_b32 v20, v16
    ds_read_b32 v19, v17
    s_waitcnt lgkmcnt(1)
    v_not_b32 v20, v20
    v_bfe_u32 v20, v20, 3, 6
    v_and_b32 v84, 7, v20
    v_xor_b32 v84, v84, v2
    v_lshlrev_b32_e64 v84, 4, v84
    v_lshl_add_u32 v84, v20, 8, v84
    v_add_u32 v84, 81920, v84
    v_lshlrev_b32_e64 v88, 4, v20
    v_add_u32 v88, 160768, v88
    ds_read_b128 v[24:27], v84
    ds_read_b96 v[28:30], v88
    ds_read_b128 v[32:35], v85
    ds_read_b96 v[36:38], v89
    ds_read_b128 v[40:43], v86
    ds_read_b96 v[44:46], v90
    v_mul_u32_u24 v80, 1280, v20
    v_add_u32 v80, v80, v18
    s_waitcnt lgkmcnt(4)
    v_lshlrev_b32 v48, 16, v24
    v_and_b32 v49, s31, v24
    v_lshlrev_b32 v50, 16, v25
    v_and_b32 v51, s31, v25
    v_lshlrev_b32 v52, 16, v26
    v_and_b32 v53, s31, v26
    v_lshlrev_b32 v54, 16, v27
    v_and_b32 v55, s31, v27
    v_pk_add_f32 v[56:57], v[48:49], v[28:29] op_sel_hi:[1,0]
    v_pk_add_f32 v[58:59], v[50:51], v[28:29] op_sel_hi:[1,0]
    v_pk_add_f32 v[60:61], v[52:53], v[28:29] op_sel_hi:[1,0]
    v_pk_add_f32 v[62:63], v[54:55], v[28:29] op_sel_hi:[1,0]
    v_cvt_pk_bf16_f32 v56, 0, v56
    v_cvt_pk_bf16_f32 v57, 0, v57
    v_cvt_pk_bf16_f32 v58, 0, v58
    v_cvt_pk_bf16_f32 v59, 0, v59
    v_cvt_pk_bf16_f32 v60, 0, v60
    v_cvt_pk_bf16_f32 v61, 0, v61
    v_cvt_pk_bf16_f32 v62, 0, v62
    v_cvt_pk_bf16_f32 v63, 0, v63
    v_pk_mul_f32 v[56:57], v[56:57], v[28:29] op_sel:[0,1] op_sel_hi:[1,1]
    v_pk_mul_f32 v[58:59], v[58:59], v[28:29] op_sel:[0,1] op_sel_hi:[1,1]
    v_pk_mul_f32 v[60:61], v[60:61], v[28:29] op_sel:[0,1] op_sel_hi:[1,1]
    v_pk_mul_f32 v[62:63], v[62:63], v[28:29] op_sel:[0,1] op_sel_hi:[1,1]
    v_cvt_pk_bf16_f32 v64, v56, v57
    v_cvt_pk_bf16_f32 v65, v58, v59
    v_cvt_pk_bf16_f32 v66, v60, v61
    v_cvt_pk_bf16_f32 v67, v62, v63
    s_mov_b64 exec, 0xffff
    buffer_store_dwordx4 v[64:67], v18, s[16:19], s60 offen sc1
    s_mov_b64 exec, -1
    s_nop 0
    v_cvt_pk_bf16_f32 v56, 0, v56
    v_cvt_pk_bf16_f32 v57, 0, v57
    v_cvt_pk_bf16_f32 v58, 0, v58
    v_cvt_pk_bf16_f32 v59, 0, v59
    v_cvt_pk_bf16_f32 v60, 0, v60
    v_cvt_pk_bf16_f32 v61, 0, v61
    v_cvt_pk_bf16_f32 v62, 0, v62
    v_cvt_pk_bf16_f32 v63, 0, v63
    v_pk_add_f32 v[56:57], v[56:57], v[48:49]
    v_pk_add_f32 v[58:59], v[58:59], v[50:51]
    v_pk_add_f32 v[60:61], v[60:61], v[52:53]
    v_pk_add_f32 v[62:63], v[62:63], v[54:55]
    v_cvt_pk_bf16_f32 v68, v56, v57
    v_cvt_pk_bf16_f32 v69, v58, v59
    v_cvt_pk_bf16_f32 v70, v60, v61
    v_cvt_pk_bf16_f32 v71, v62, v63
    s_mov_b64 exec, 0xffff
    buffer_store_dwordx4 v[68:71], v80, s[24:27], s56 offen sc1
    s_mov_b64 exec, -1
    v_mul_u32_u24 v81, 1280, v21
    v_add_u32 v81, v81, v18
    s_waitcnt lgkmcnt(2)
    v_lshlrev_b32 v48, 16, v32
    v_and_b32 v49, s31, v32
    v_lshlrev_b32 v50, 16, v33
    v_and_b32 v51, s31, v33
    v_lshlrev_b32 v52, 16, v34
    v_and_b32 v53, s31, v34
    v_lshlrev_b32 v54, 16, v35
    v_and_b32_e64 v55, s31, v35
    v_pk_add_f32 v[56:57], v[48:49], v[36:37] op_sel_hi:[1,0]
    v_pk_add_f32 v[58:59], v[50:51], v[36:37] op_sel_hi:[1,0]
    v_pk_add_f32 v[60:61], v[52:53], v[36:37] op_sel_hi:[1,0]
    v_pk_add_f32 v[62:63], v[54:55], v[36:37] op_sel_hi:[1,0]
    v_cvt_pk_bf16_f32 v56, 0, v56
    v_cvt_pk_bf16_f32 v57, 0, v57
    v_cvt_pk_bf16_f32 v58, 0, v58
    v_cvt_pk_bf16_f32 v59, 0, v59
    v_cvt_pk_bf16_f32 v60, 0, v60
    v_cvt_pk_bf16_f32 v61, 0, v61
    v_cvt_pk_bf16_f32 v62, 0, v62
    v_cvt_pk_bf16_f32 v63, 0, v63
    v_pk_mul_f32 v[56:57], v[56:57], v[36:37] op_sel:[0,1] op_sel_hi:[1,1]
    v_pk_mul_f32 v[58:59], v[58:59], v[36:37] op_sel:[0,1] op_sel_hi:[1,1]
    v_pk_mul_f32 v[60:61], v[60:61], v[36:37] op_sel:[0,1] op_sel_hi:[1,1]
    v_pk_mul_f32 v[62:63], v[62:63], v[36:37] op_sel:[0,1] op_sel_hi:[1,1]
    v_cvt_pk_bf16_f32 v56, 0, v56
    v_cvt_pk_bf16_f32 v57, 0, v57
    v_cvt_pk_bf16_f32 v58, 0, v58
    v_cvt_pk_bf16_f32 v59, 0, v59
    v_cvt_pk_bf16_f32 v60, 0, v60
    v_cvt_pk_bf16_f32 v61, 0, v61
    v_cvt_pk_bf16_f32 v62, 0, v62
    v_cvt_pk_bf16_f32 v63, 0, v63
    v_pk_add_f32 v[56:57], v[56:57], v[48:49]
    v_pk_add_f32 v[58:59], v[58:59], v[50:51]
    v_pk_add_f32 v[60:61], v[60:61], v[52:53]
    v_pk_add_f32 v[62:63], v[62:63], v[54:55]
    v_cvt_pk_bf16_f32 v72, v56, v57
    v_cvt_pk_bf16_f32 v73, v58, v59
    v_cvt_pk_bf16_f32 v74, v60, v61
    v_cvt_pk_bf16_f32 v75, v62, v63
    v_mul_u32_u24 v82, 1280, v22
    v_add_u32 v82, v82, v18
    s_waitcnt lgkmcnt(0)
    v_lshlrev_b32 v48, 16, v40
    v_and_b32 v49, s31, v40
    v_lshlrev_b32 v50, 16, v41
    v_and_b32 v51, s31, v41
    v_lshlrev_b32 v52, 16, v42
    v_and_b32 v53, s31, v42
    v_lshlrev_b32 v54, 16, v43
    v_and_b32 v55, s31, v43
    v_pk_add_f32 v[56:57], v[48:49], v[44:45] op_sel_hi:[1,0]
    v_pk_add_f32 v[58:59], v[50:51], v[44:45] op_sel_hi:[1,0]
    v_pk_add_f32 v[60:61], v[52:53], v[44:45] op_sel_hi:[1,0]
    v_pk_add_f32 v[62:63], v[54:55], v[44:45] op_sel_hi:[1,0]
    v_cvt_pk_bf16_f32 v56, 0, v56
    v_cvt_pk_bf16_f32 v57, 0, v57
    v_cvt_pk_bf16_f32 v58, 0, v58
    v_cvt_pk_bf16_f32 v59, 0, v59
    v_cvt_pk_bf16_f32 v60, 0, v60
    v_cvt_pk_bf16_f32 v61, 0, v61
    v_cvt_pk_bf16_f32 v62, 0, v62
    v_cvt_pk_bf16_f32 v63, 0, v63
    v_pk_mul_f32 v[56:57], v[56:57], v[44:45] op_sel:[0,1] op_sel_hi:[1,1]
    v_pk_mul_f32 v[58:59], v[58:59], v[44:45] op_sel:[0,1] op_sel_hi:[1,1]
    v_pk_mul_f32 v[60:61], v[60:61], v[44:45] op_sel:[0,1] op_sel_hi:[1,1]
    v_pk_mul_f32 v[62:63], v[62:63], v[44:45] op_sel:[0,1] op_sel_hi:[1,1]
    v_cvt_pk_bf16_f32 v56, 0, v56
    v_cvt_pk_bf16_f32 v57, 0, v57
    v_cvt_pk_bf16_f32 v58, 0, v58
    v_cvt_pk_bf16_f32 v59, 0, v59
    v_cvt_pk_bf16_f32 v60, 0, v60
    v_cvt_pk_bf16_f32 v61, 0, v61
    v_cvt_pk_bf16_f32 v62, 0, v62
    v_cvt_pk_bf16_f32 v63, 0, v63
    v_pk_add_f32 v[56:57], v[56:57], v[48:49]
    v_pk_add_f32 v[58:59], v[58:59], v[50:51]
    v_pk_add_f32 v[60:61], v[60:61], v[52:53]
    v_pk_add_f32 v[62:63], v[62:63], v[54:55]
    v_cvt_pk_bf16_f32 v76, v56, v57
    v_cvt_pk_bf16_f32 v77, v58, v59
    v_cvt_pk_bf16_f32 v78, v60, v61
    v_cvt_pk_bf16_f32 v79, v62, v63
    v_and_b32_e64 v19, -8, v19
    v_cmp_lt_u32 s[62:63], v38, v19
    v_cmp_lt_u32 s[64:65], v46, v19
    s_waitcnt vmcnt(0)
    s_mov_b64 exec, 0xffff
    buffer_store_dwordx4 v[24:27], v18, s[16:19], s61 offen sc1
    s_mov_b64 exec, s[62:63]
    buffer_store_dwordx4 v[72:75], v81, s[24:27], s56 offen sc1
    s_mov_b64 exec, s[64:65]
    buffer_store_dwordx4 v[76:79], v82, s[24:27], s56 offen sc1
    s_mov_b64 exec, -1
    s_endpgm
gr_40:
    s_sub_u32 s57, s57, 1
    s_cbranch_scc1 gae_41
    s_wqm_b64 exec, vcc
    s_add_u32 m0, s43, 51200
    buffer_load_dwordx4 v[160:163], v4, s[16:19], s36 offen offset:2048 sc1
    buffer_load_dwordx4 v4, s[16:19], s36 offen sc1 lds
    buffer_load_dwordx4 v4, s[16:19], s36 offen offset:1024 sc1 lds
    s_mov_b64 exec, -1
    s_waitcnt vmcnt(0)
    s_branch ga_39
gr_43:
    s_sub_u32 s57, s57, 1
    s_cbranch_scc1 gae_44
    s_wqm_b64 exec, vcc
    s_add_u32 m0, s43, 61440
    buffer_load_dwordx4 v[172:175], v4, s[16:19], s37 offen offset:2048 sc1
    buffer_load_dwordx4 v4, s[16:19], s37 offen sc1 lds
    buffer_load_dwordx4 v4, s[16:19], s37 offen offset:1024 sc1 lds
    s_mov_b64 exec, -1
    s_waitcnt vmcnt(0)
    s_branch ga_42
gr_46:
    s_sub_u32 s57, s57, 1
    s_cbranch_scc1 gae_47
    s_wqm_b64 exec, vcc
    s_add_u32 m0, s43, 71680
    buffer_load_dwordx4 v[184:187], v4, s[16:19], s38 offen offset:2048 sc1
    buffer_load_dwordx4 v4, s[16:19], s38 offen sc1 lds
    buffer_load_dwordx4 v4, s[16:19], s38 offen offset:1024 sc1 lds
    s_mov_b64 exec, -1
    s_waitcnt vmcnt(0)
    s_branch ga_45
gr_49:
    s_sub_u32 s57, s57, 1
    s_cbranch_scc1 gae_50
    s_wqm_b64 exec, vcc
    s_add_u32 m0, s43, 81920
    buffer_load_dwordx4 v[196:199], v4, s[16:19], s39 offen offset:2048 sc1
    buffer_load_dwordx4 v4, s[16:19], s39 offen sc1 lds
    buffer_load_dwordx4 v4, s[16:19], s39 offen offset:1024 sc1 lds
    s_mov_b64 exec, -1
    s_waitcnt vmcnt(0)
    s_branch ga_48
gr_52:
    s_sub_u32 s57, s57, 1
    s_cbranch_scc1 gae_53
    s_wqm_b64 exec, vcc
    s_add_u32 m0, s43, 92160
    buffer_load_dwordx4 v[208:211], v4, s[16:19], s40 offen offset:2048 sc1
    buffer_load_dwordx4 v4, s[16:19], s40 offen sc1 lds
    buffer_load_dwordx4 v4, s[16:19], s40 offen offset:1024 sc1 lds
    s_mov_b64 exec, -1
    s_waitcnt vmcnt(0)
    s_branch ga_51
gr_55:
    s_sub_u32 s57, s57, 1
    s_cbranch_scc1 gae_56
    s_wqm_b64 exec, vcc
    s_add_u32 m0, s43, 102400
    buffer_load_dwordx4 v[220:223], v4, s[16:19], s41 offen offset:2048 sc1
    buffer_load_dwordx4 v4, s[16:19], s41 offen sc1 lds
    buffer_load_dwordx4 v4, s[16:19], s41 offen offset:1024 sc1 lds
    s_mov_b64 exec, -1
    s_waitcnt vmcnt(0)
    s_branch ga_54
gr_58:
    s_sub_u32 s57, s57, 1
    s_cbranch_scc1 gae_59
    s_wqm_b64 exec, vcc
    s_add_u32 m0, s43, 112640
    buffer_load_dwordx4 v[232:235], v4, s[16:19], s42 offen offset:2048 sc1
    buffer_load_dwordx4 v4, s[16:19], s42 offen sc1 lds
    buffer_load_dwordx4 v4, s[16:19], s42 offen offset:1024 sc1 lds
    s_mov_b64 exec, -1
    s_waitcnt vmcnt(0)
    s_branch ga_57
gr_61:
    s_sub_u32 s57, s57, 1
    s_cbranch_scc1 gae_62
    v_cmp_ne_u32 vcc, s28, v43
    s_wqm_b64 exec, vcc
    buffer_load_dwordx4 v[40:43], v4, s[16:19], s73 offen offset:0 sc1
    s_mov_b64 exec, -1
    v_cmp_ne_u32 vcc, s28, v47
    s_wqm_b64 exec, vcc
    buffer_load_dwordx4 v[44:47], v4, s[16:19], s73 offen offset:1024 sc1
    s_mov_b64 exec, -1
    v_cmp_ne_u32 vcc, s28, v51
    s_wqm_b64 exec, vcc
    buffer_load_dwordx4 v[48:51], v4, s[16:19], s73 offen offset:2048 sc1
    s_mov_b64 exec, -1
    v_cmp_ne_u32 vcc, s28, v55
    s_wqm_b64 exec, vcc
    buffer_load_dwordx4 v[52:55], v4, s[16:19], s73 offen offset:3072 sc1
    s_mov_b64 exec, -1
    v_cmp_ne_u32 vcc, s28, v59
    s_wqm_b64 exec, vcc
    buffer_load_dwordx4 v[56:59], v4, s[16:19], s59 offen sc1
    s_mov_b64 exec, -1
    s_waitcnt vmcnt(0)
    s_branch ga_60
    .p2align 12
pg_63:
L_E1:
    s_setprio 2
    s_barrier
    s_add_u32 m0, s62, 0
    s_add_u32 s67, s40, 1280
    buffer_load_dwordx4 v4, s[12:15], s67 offen offset:0 lds
    buffer_load_dwordx4 v5, s[12:15], s67 offen offset:1024 lds
    buffer_load_dwordx4 v6, s[12:15], s67 offen offset:2048 lds
    buffer_load_dwordx4 v7, s[12:15], s67 offen offset:3072 lds
    s_add_u32 m0, s62, 4096
    s_nop 0
    buffer_load_dwordx4 v8, s[12:15], s67 offen lds
    s_mul_i32 s58, s4, 3200
    s_lshl_b32 s59, s6, 10
    s_add_u32 m0, s59, 155648
    s_nop 0
    buffer_load_dwordx4 v84, s[20:23], s58 offen lds
    s_lshl2_add_u32 s58, s74, s6
    s_lshl_b32 s58, s58, 6
    buffer_load_dwordx4 v[232:235], v85, s[24:27], s58 offen
    buffer_load_dwordx4 v[236:239], v85, s[24:27], s58 offen offset:16
    s_add_u32 m0, s62, 20480
    s_add_u32 s67, s41, 1280
    buffer_load_dwordx4 v4, s[12:15], s67 offen offset:0 lds
    buffer_load_dwordx4 v5, s[12:15], s67 offen offset:1024 lds
    s_mov_b32 s57, 524288
fw_64:
    ds_read_b32 v14, v13 offset:528
    s_waitcnt lgkmcnt(0)
    v_cmp_eq_u32 vcc, 0, v14
    s_cbranch_vccz fwe_65
    s_sub_u32 s57, s57, 1
    s_cbranch_scc0 fw_64
fwe_65:
    ds_read_b128 v[240:243], v10 offset:0
    ds_read_b128 v[244:247], v11 offset:0
    ds_read_b128 v[248:251], v10 offset:40960
    ds_read_b128 v[252:255], v11 offset:40960
    ds_write_b32 v12, v12 offset:544
    buffer_load_dwordx4 v6, s[12:15], s67 offen offset:2048 lds
    buffer_load_dwordx4 v7, s[12:15], s67 offen offset:3072 lds
    s_add_u32 m0, s62, 24576
    s_nop 0
    buffer_load_dwordx4 v8, s[12:15], s67 offen lds
    s_add_u32 m0, s62, 40960
    s_add_u32 s67, s32, 1280
    buffer_load_dwordx4 v4, s[12:15], s67 offen offset:0 lds
    buffer_load_dwordx4 v5, s[12:15], s67 offen offset:1024 lds
    s_waitcnt vmcnt(10)
    ds_write_b32 v12, v12 offset:0
    buffer_load_dwordx4 v6, s[12:15], s67 offen offset:2048 lds
    buffer_load_dwordx4 v7, s[12:15], s67 offen offset:3072 lds
    s_add_u32 m0, s62, 45056
    s_nop 0
    buffer_load_dwordx4 v8, s[12:15], s67 offen lds
    s_mul_i32 s28, s28, 0x9e3779b5
    s_add_u32 s28, s28, 0x7f4a7c15
    s_mov_b32 s57, 524288
fw_66:
    ds_read_b32 v14, v13 offset:544
    s_waitcnt lgkmcnt(0)
    v_cmp_eq_u32 vcc, 0, v14
    s_cbranch_vccz fwe_67
    s_sub_u32 s57, s57, 1
    s_cbranch_scc0 fw_66
fwe_67:
    s_add_u32 m0, s62, 61440
    s_add_u32 s67, s33, 1280
    buffer_load_dwordx4 v4, s[12:15], s67 offen offset:0 lds
    buffer_load_dwordx4 v5, s[12:15], s67 offen offset:1024 lds
    s_waitcnt vmcnt(7)
    ds_write_b32 v12, v12 offset:16
    buffer_load_dwordx4 v6, s[12:15], s67 offen offset:2048 lds
    buffer_load_dwordx4 v7, s[12:15], s67 offen offset:3072 lds
    s_add_u32 m0, s62, 65536
    s_nop 0
    buffer_load_dwordx4 v8, s[12:15], s67 offen lds
    s_add_u32 m0, s62, 81920
    s_add_u32 s67, s75, 1280
    buffer_load_dwordx4 v4, s[12:15], s67 offen offset:0 lds
    buffer_load_dwordx4 v5, s[12:15], s67 offen offset:1024 lds
    s_waitcnt vmcnt(7)
    ds_write_b32 v12, v12 offset:32
    buffer_load_dwordx4 v6, s[12:15], s67 offen offset:2048 lds
    buffer_load_dwordx4 v7, s[12:15], s67 offen offset:3072 lds
    s_add_u32 m0, s62, 86016
    s_nop 0
    buffer_load_dwordx4 v8, s[12:15], s67 offen lds
    s_mov_b32 s57, 524288
fw_68:
    ds_read_b32 v14, v13 offset:16
    s_waitcnt lgkmcnt(0)
    v_cmp_eq_u32 vcc, 0, v14
    s_cbranch_vccz fwe_69
    s_sub_u32 s57, s57, 1
    s_cbranch_scc0 fw_68
fwe_69:
    v_mov_b32 v74, 0
    v_mov_b32 v75, 0
    v_mov_b32 v166, 0
    v_mov_b32 v167, 0
    ds_read_b64_tr_b16 v[24:25], v86 offset:0
    ds_read_b64_tr_b16 v[26:27], v86 offset:160
    ds_read_b64_tr_b16 v[28:29], v86 offset:320
    ds_read_b64_tr_b16 v[30:31], v86 offset:480
    ds_read_b64_tr_b16 v[32:33], v86 offset:640
    ds_read_b64_tr_b16 v[34:35], v86 offset:8
    ds_read_b64_tr_b16 v[36:37], v86 offset:168
    ds_read_b64_tr_b16 v[38:39], v86 offset:328
    ds_read_b64_tr_b16 v[40:41], v86 offset:488
    ds_read_b64_tr_b16 v[42:43], v86 offset:648
    s_waitcnt lgkmcnt(5)
    ds_read_b64_tr_b16 v[44:45], v86 offset:16
    ds_read_b64_tr_b16 v[46:47], v86 offset:176
    ds_read_b64_tr_b16 v[48:49], v86 offset:336
    ds_read_b64_tr_b16 v[50:51], v86 offset:496
    ds_read_b64_tr_b16 v[52:53], v86 offset:656
    ds_read_b64_tr_b16 v[54:55], v86 offset:24
    ds_read_b64_tr_b16 v[56:57], v86 offset:184
    ds_read_b64_tr_b16 v[58:59], v86 offset:344
    ds_read_b64_tr_b16 v[60:61], v86 offset:504
    ds_read_b64_tr_b16 v[62:63], v86 offset:664
    s_waitcnt lgkmcnt(5)
    ds_read_b64_tr_b16 v[64:65], v86 offset:32
    ds_read_b64_tr_b16 v[66:67], v86 offset:192
    ds_read_b64_tr_b16 v[68:69], v86 offset:352
    ds_read_b64_tr_b16 v[70:71], v86 offset:512
    ds_read_b64_tr_b16 v[72:73], v86 offset:672
    s_add_u32 m0, s62, 102400
    s_add_u32 s67, s40, 2560
    buffer_load_dwordx4 v4, s[12:15], s67 offen offset:0 lds
    buffer_load_dwordx4 v5, s[12:15], s67 offen offset:1024 lds
    s_waitcnt vmcnt(7)
    ds_write_b32 v12, v12 offset:48
    buffer_load_dwordx4 v6, s[12:15], s67 offen offset:2048 lds
    buffer_load_dwordx4 v7, s[12:15], s67 offen offset:3072 lds
    s_add_u32 m0, s62, 106496
    s_nop 0
    buffer_load_dwordx4 v8, s[12:15], s67 offen lds
    s_add_u32 m0, s62, 122880
    s_add_u32 s67, s41, 2560
    buffer_load_dwordx4 v4, s[12:15], s67 offen offset:0 lds
    buffer_load_dwordx4 v5, s[12:15], s67 offen offset:1024 lds
    s_waitcnt vmcnt(7)
    ds_write_b32 v12, v12 offset:64
    buffer_load_dwordx4 v6, s[12:15], s67 offen offset:2048 lds
    buffer_load_dwordx4 v7, s[12:15], s67 offen offset:3072 lds
    s_add_u32 m0, s62, 126976
    s_nop 0
    buffer_load_dwordx4 v8, s[12:15], s67 offen lds
    v_bfe_u32 v14, v1, 2, 2
    v_xor_b32 v15, v14, v3
    v_lshlrev_b32 v15, 6, v15
    v_and_b32_e64 v16, 3, v1
    v_lshl_add_u32 v15, v16, 4, v15
    v_mul_u32_u24 v17, 1280, v3
    v_add_u32 v9, v15, v17
    s_mul_i32 s29, s6, 25600
    s_lshl_b32 s58, s0, 8
    s_add_u32 s29, s29, s58
    s_mov_b32 s24, s38
    s_and_b32 s25, s39, 0xffff
    s_mov_b32 s26, 819200
    s_mov_b32 s27, 0x20000
    v_mov_b32 v81, s28
    s_mov_b32 s8, 0x07060501
    s_mov_b32 s9, 0x07060502
    s_mov_b32 s10, 0x07060503
    s_mov_b32 s11, 0x07060500
    s_mov_b32 s68, 0xffffff
    s_mov_b32 s69, 0xffffff
    s_mov_b32 s57, 524288
fw_70:
    ds_read_b32 v14, v13 offset:256
    s_waitcnt lgkmcnt(0)
    v_cmp_eq_u32 vcc, 0, v14
    s_cbranch_vccz fwe_71
    s_sub_u32 s57, s57, 1
    s_cbranch_scc0 fw_70
fwe_71:
    s_add_u32 m0, s62, 0
    s_add_u32 s67, s32, 2560
    buffer_load_dwordx4 v4, s[12:15], s67 offen offset:0 lds
    buffer_load_dwordx4 v5, s[12:15], s67 offen offset:1024 lds
    s_waitcnt vmcnt(7)
    ds_write_b32 v12, v12 offset:80
    buffer_load_dwordx4 v6, s[12:15], s67 offen offset:2048 lds
    buffer_load_dwordx4 v7, s[12:15], s67 offen offset:3072 lds
    s_add_u32 m0, s62, 4096
    s_nop 0
    buffer_load_dwordx4 v8, s[12:15], s67 offen lds
    s_mov_b32 s57, 524288
fw_72:
    ds_read_b32 v14, v13 offset:272
    s_waitcnt lgkmcnt(0)
    v_cmp_eq_u32 vcc, 0, v14
    s_cbranch_vccz fwe_73
    s_sub_u32 s57, s57, 1
    s_cbranch_scc0 fw_72
fwe_73:
    s_add_u32 m0, s62, 20480
    s_add_u32 s67, s33, 2560
    buffer_load_dwordx4 v4, s[12:15], s67 offen offset:0 lds
    buffer_load_dwordx4 v5, s[12:15], s67 offen offset:1024 lds
    s_waitcnt vmcnt(7)
    ds_write_b32 v12, v12 offset:96
    buffer_load_dwordx4 v6, s[12:15], s67 offen offset:2048 lds
    buffer_load_dwordx4 v7, s[12:15], s67 offen offset:3072 lds
    s_add_u32 m0, s62, 24576
    s_nop 0
    buffer_load_dwordx4 v8, s[12:15], s67 offen lds
    ds_read_b32 v80, v13 offset:288
    s_waitcnt lgkmcnt(0)
    v_cmp_eq_u32 vcc, 0, v80
    s_cbranch_vccnz fs_74
fr_75:
    s_add_u32 m0, s62, 40960
    s_add_u32 s67, s75, 2560
    buffer_load_dwordx4 v4, s[12:15], s67 offen offset:0 lds
    buffer_load_dwordx4 v5, s[12:15], s67 offen offset:1024 lds
    s_waitcnt vmcnt(7)
    ds_write_b32 v12, v12 offset:112
    buffer_load_dwordx4 v6, s[12:15], s67 offen offset:2048 lds
    buffer_load_dwordx4 v7, s[12:15], s67 offen offset:3072 lds
    s_mov_b32 s57, 524288
fw_76:
    ds_read_b32 v14, v12 offset:560
    s_waitcnt lgkmcnt(0)
    v_cmp_eq_u32 vcc, 0, v14
    s_cbranch_vccz fwe_77
    s_sub_u32 s57, s57, 1
    s_cbranch_scc0 fw_76
fwe_77:
    ds_read_b128 v[156:159], v19
    ds_read_b128 v[160:163], v19 offset:1024
    ds_read_b64 v[164:165], v19 offset:2048
    s_add_u32 m0, s62, 45056
    s_nop 0
    buffer_load_dwordx4 v8, s[12:15], s67 offen lds
    s_waitcnt lgkmcnt(0)
    v_mfma_f32_16x16x32_bf16 v[168:171], v[24:27], v[156:159], 0
    v_mfma_f32_16x16x32_bf16 v[168:171], v[28:31], v[160:163], v[168:171]
    v_mfma_f32_16x16x32_bf16 v[168:171], v[32:35], v[164:167], v[168:171]
    v_mfma_f32_16x16x32_bf16 v[172:175], v[34:37], v[156:159], 0
    v_mfma_f32_16x16x32_bf16 v[172:175], v[38:41], v[160:163], v[172:175]
    v_mfma_f32_16x16x32_bf16 v[172:175], v[42:45], v[164:167], v[172:175]
    v_mfma_f32_16x16x32_bf16 v[176:179], v[44:47], v[156:159], 0
    ds_read_b32 v80, v13 offset:560
    v_mfma_f32_16x16x32_bf16 v[176:179], v[48:51], v[160:163], v[176:179]
    v_mfma_f32_16x16x32_bf16 v[176:179], v[52:55], v[164:167], v[176:179]
    v_mfma_f32_16x16x32_bf16 v[180:183], v[54:57], v[156:159], 0
    v_cvt_pk_bf16_f32 v168, 0, v168
    v_cvt_pk_bf16_f32 v169, 0, v169
    v_mfma_f32_16x16x32_bf16 v[180:183], v[58:61], v[160:163], v[180:183]
    v_cvt_pk_bf16_f32 v170, 0, v170
    v_cvt_pk_bf16_f32 v171, 0, v171
    v_mfma_f32_16x16x32_bf16 v[180:183], v[62:65], v[164:167], v[180:183]
    s_waitcnt lgkmcnt(0)
    v_cmp_eq_u32 vcc, 0, v80
    s_cbranch_vccnz fs_78
fr_79:
    s_add_u32 m0, s62, 81920
    s_nop 0
    buffer_load_dwordx4 v4, s[12:15], s40 offen offset:0 lds
    s_waitcnt vmcnt(6)
    ds_write_b32 v12, v12 offset:128
    v_cvt_pk_bf16_f32 v172, 0, v172
    v_cvt_pk_bf16_f32 v173, 0, v173
    v_mfma_f32_16x16x32_bf16 v[184:187], v[64:67], v[156:159], 0
    v_cvt_pk_bf16_f32 v174, 0, v174
    v_cvt_pk_bf16_f32 v175, 0, v175
    v_mfma_f32_16x16x32_bf16 v[184:187], v[68:71], v[160:163], v[184:187]
    v_cvt_pk_bf16_f32 v176, 0, v176
    v_cvt_pk_bf16_f32 v177, 0, v177
    v_mfma_f32_16x16x32_bf16 v[184:187], v[72:75], v[164:167], v[184:187]
    v_cvt_pk_bf16_f32 v178, 0, v178
    buffer_load_dwordx4 v5, s[12:15], s40 offen offset:1024 lds
    v_cvt_pk_bf16_f32 v179, 0, v179
    v_max3_f32 v14, v168, v169, v170
    v_min3_f32 v15, v168, v169, v170
    v_max3_f32 v14, v14, v171, v172
    v_min3_f32 v15, v15, v171, v172
    v_max3_f32 v14, v14, v173, v174
    v_min3_f32 v15, v15, v173, v174
    v_max3_f32 v14, v14, v175, v176
    v_min3_f32 v15, v15, v175, v176
    v_max3_f32 v14, v14, v177, v178
    v_min3_f32 v15, v15, v177, v178
    v_cvt_pk_bf16_f32 v180, 0, v180
    v_cvt_pk_bf16_f32 v181, 0, v181
    buffer_load_dwordx4 v6, s[12:15], s40 offen offset:2048 lds
    v_cvt_pk_bf16_f32 v182, 0, v182
    v_cvt_pk_bf16_f32 v183, 0, v183
    v_cvt_pk_bf16_f32 v184, 0, v184
    v_cvt_pk_bf16_f32 v185, 0, v185
    v_cvt_pk_bf16_f32 v186, 0, v186
    v_cvt_pk_bf16_f32 v187, 0, v187
    v_max3_f32 v14, v14, v179, v180
    v_min3_f32 v15, v15, v179, v180
    v_max3_f32 v14, v14, v181, v182
    v_min3_f32 v15, v15, v181, v182
    v_max3_f32 v14, v14, v183, v184
    v_min3_f32 v15, v15, v183, v184
    v_max3_f32 v14, v14, v185, v186
    buffer_load_dwordx4 v7, s[12:15], s40 offen offset:3072 lds
    v_min3_f32 v15, v15, v185, v186
    v_max_f32 v14, v14, v187
    v_min_f32 v15, v15, v187
    v_mul_f32 v14, s64, v14
    v_mul_f32 v16, s64, v15
    v_fma_f32 v104, v168, s64, -v14
    v_fma_f32 v105, v169, s64, -v14
    v_fma_f32 v106, v170, s64, -v14
    v_fma_f32 v107, v171, s64, -v14
    v_fma_f32 v108, v172, s64, -v14
    v_fma_f32 v109, v173, s64, -v14
    v_fma_f32 v110, v174, s64, -v14
    v_fma_f32 v111, v175, s64, -v14
    s_add_u32 m0, s62, 86016
    s_nop 0
    buffer_load_dwordx4 v8, s[12:15], s40 offen lds
    s_waitcnt vmcnt(5)
    ds_write_b32 v12, v12 offset:144
    v_fma_f32 v112, v176, s64, -v14
    v_fma_f32 v113, v177, s64, -v14
    v_fma_f32 v114, v178, s64, -v14
    v_fma_f32 v115, v179, s64, -v14
    v_fma_f32 v116, v180, s64, -v14
    v_fma_f32 v117, v181, s64, -v14
    v_fma_f32 v118, v182, s64, -v14
    v_fma_f32 v119, v183, s64, -v14
    v_fma_f32 v120, v184, s64, -v14
    v_fma_f32 v121, v185, s64, -v14
    v_fma_f32 v122, v186, s64, -v14
    v_fma_f32 v123, v187, s64, -v14
    v_fma_f32 v124, -v168, s64, v16
    ds_read_b32 v80, v13 offset:336
    v_fma_f32 v125, -v169, s64, v16
    v_fma_f32 v126, -v170, s64, v16
    v_fma_f32 v127, -v171, s64, v16
    v_fma_f32 v128, -v172, s64, v16
    v_fma_f32 v129, -v173, s64, v16
    v_fma_f32 v130, -v174, s64, v16
    v_fma_f32 v131, -v175, s64, v16
    v_fma_f32 v132, -v176, s64, v16
    v_fma_f32 v133, -v177, s64, v16
    v_fma_f32 v134, -v178, s64, v16
    v_fma_f32 v135, -v179, s64, v16
    v_fma_f32 v136, -v180, s64, v16
    v_fma_f32 v137, -v181, s64, v16
    s_waitcnt lgkmcnt(0)
    v_cmp_eq_u32 vcc, 0, v80
    s_cbranch_vccnz fs_80
fr_81:
    s_add_u32 m0, s62, 102400
    s_nop 0
    buffer_load_dwordx4 v4, s[12:15], s41 offen offset:0 lds
    v_fma_f32 v138, -v182, s64, v16
    v_fma_f32 v139, -v183, s64, v16
    v_fma_f32 v140, -v184, s64, v16
    v_fma_f32 v141, -v185, s64, v16
    v_fma_f32 v142, -v186, s64, v16
    v_fma_f32 v143, -v187, s64, v16
    v_exp_f32 v104, v104
    v_exp_f32 v105, v105
    v_exp_f32 v106, v106
    v_exp_f32 v107, v107
    buffer_load_dwordx4 v5, s[12:15], s41 offen offset:1024 lds
    v_exp_f32 v108, v108
    v_exp_f32 v109, v109
    v_exp_f32 v110, v110
    v_exp_f32 v111, v111
    v_exp_f32 v112, v112
    v_exp_f32 v113, v113
    v_exp_f32 v114, v114
    buffer_load_dwordx4 v6, s[12:15], s41 offen offset:2048 lds
    v_exp_f32 v115, v115
    v_exp_f32 v116, v116
    v_exp_f32 v117, v117
    v_exp_f32 v118, v118
    v_exp_f32 v119, v119
    v_exp_f32 v120, v120
    v_exp_f32 v121, v121
    buffer_load_dwordx4 v7, s[12:15], s41 offen offset:3072 lds
    v_exp_f32 v122, v122
    v_exp_f32 v123, v123
    v_add_f32 v14, v104, v105
    v_add_f32 v14, v14, v106
    v_add_f32 v14, v14, v107
    v_add_f32 v14, v14, v108
    v_add_f32 v14, v14, v109
    v_add_f32 v14, v14, v110
    v_add_f32 v14, v14, v111
    v_add_f32 v14, v14, v112
    v_add_f32 v14, v14, v113
    s_add_u32 m0, s62, 106496
    s_nop 0
    buffer_load_dwordx4 v8, s[12:15], s41 offen lds
    v_add_f32 v14, v14, v114
    v_add_f32 v14, v14, v115
    v_add_f32 v14, v14, v116
    v_add_f32 v14, v14, v117
    v_add_f32 v14, v14, v118
    v_add_f32 v14, v14, v119
    v_add_f32 v14, v14, v120
    v_add_f32 v14, v14, v121
    v_add_f32 v14, v14, v122
    v_add_f32 v14, v14, v123
    v_rcp_f32 v14, v14
    s_nop 0
    v_mul_f32 v104, v14, v104
    v_mul_f32 v105, v14, v105
    ds_read_b32 v80, v13 offset:352
    v_mul_f32 v106, v14, v106
    v_mul_f32 v107, v14, v107
    v_mul_f32 v108, v14, v108
    v_mul_f32 v109, v14, v109
    v_mul_f32 v110, v14, v110
    v_mul_f32 v111, v14, v111
    v_mul_f32 v112, v14, v112
    v_mul_f32 v113, v14, v113
    v_mul_f32 v114, v14, v114
    v_mul_f32 v115, v14, v115
    v_mul_f32 v116, v14, v116
    v_mul_f32 v117, v14, v117
    v_mul_f32 v118, v14, v118
    s_waitcnt lgkmcnt(0)
    v_cmp_eq_u32 vcc, 0, v80
    s_cbranch_vccnz fs_82
fr_83:
    s_add_u32 m0, s62, 122880
    s_nop 0
    buffer_load_dwordx4 v4, s[12:15], s32 offen offset:0 lds
    v_mul_f32 v119, v14, v119
    v_mul_f32 v120, v14, v120
    v_mul_f32 v121, v14, v121
    v_mul_f32 v122, v14, v122
    v_mul_f32 v123, v14, v123
    v_exp_f32 v124, v124
    v_exp_f32 v125, v125
    v_exp_f32 v126, v126
    v_exp_f32 v127, v127
    buffer_load_dwordx4 v5, s[12:15], s32 offen offset:1024 lds
    v_exp_f32 v128, v128
    v_exp_f32 v129, v129
    v_exp_f32 v130, v130
    v_exp_f32 v131, v131
    v_exp_f32 v132, v132
    v_exp_f32 v133, v133
    v_exp_f32 v134, v134
    buffer_load_dwordx4 v6, s[12:15], s32 offen offset:2048 lds
    v_exp_f32 v135, v135
    v_exp_f32 v136, v136
    v_exp_f32 v137, v137
    v_exp_f32 v138, v138
    v_exp_f32 v139, v139
    v_exp_f32 v140, v140
    v_exp_f32 v141, v141
    buffer_load_dwordx4 v7, s[12:15], s32 offen offset:3072 lds
    v_exp_f32 v142, v142
    v_exp_f32 v143, v143
    v_add_f32 v16, v124, v125
    v_add_f32 v16, v16, v126
    v_add_f32 v16, v16, v127
    v_add_f32 v16, v16, v128
    v_add_f32 v16, v16, v129
    v_add_f32 v16, v16, v130
    v_add_f32 v16, v16, v131
    v_add_f32 v16, v16, v132
    v_add_f32 v16, v16, v133
    s_add_u32 m0, s62, 126976
    s_nop 0
    buffer_load_dwordx4 v8, s[12:15], s32 offen lds
    v_add_f32 v16, v16, v134
    v_add_f32 v16, v16, v135
    v_add_f32 v16, v16, v136
    v_add_f32 v16, v16, v137
    v_add_f32 v16, v16, v138
    v_add_f32 v16, v16, v139
    v_add_f32 v16, v16, v140
    v_add_f32 v16, v16, v141
    v_add_f32 v16, v16, v142
    v_add_f32 v16, v16, v143
    v_rcp_f32 v16, v16
    s_nop 0
    v_mul_f32 v124, v16, v124
    v_mul_f32 v125, v16, v125
    v_mul_f32 v126, v16, v126
    v_mul_f32 v127, v16, v127
    v_mul_f32 v128, v16, v128
    v_mul_f32 v129, v16, v129
    v_mul_f32 v130, v16, v130
    v_mul_f32 v131, v16, v131
    v_mul_f32 v132, v16, v132
    v_mul_f32 v133, v16, v133
    v_mul_f32 v134, v16, v134
    v_mul_f32 v135, v16, v135
    v_mul_f32 v136, v16, v136
    v_mul_f32 v137, v16, v137
    v_mul_f32 v138, v16, v138
    v_mul_f32 v139, v16, v139
    v_mul_f32 v140, v16, v140
    v_mul_f32 v141, v16, v141
    v_mul_f32 v142, v16, v142
    v_mul_f32 v143, v16, v143
    v_cvt_pk_bf16_f32 v168, v104, v105
    v_cvt_pk_bf16_f32 v169, v106, v107
    v_cvt_pk_bf16_f32 v170, v108, v109
    v_cvt_pk_bf16_f32 v171, v110, v111
    ds_write_b128 v23, v[168:171] offset:0
    v_cvt_pk_bf16_f32 v172, v112, v113
    v_cvt_pk_bf16_f32 v173, v114, v115
    v_cvt_pk_bf16_f32 v174, v116, v117
    v_cvt_pk_bf16_f32 v175, v118, v119
    ds_write_b128 v23, v[172:175] offset:16
    v_cvt_pk_bf16_f32 v176, v120, v121
    v_cvt_pk_bf16_f32 v177, v122, v123
    v_cvt_pk_bf16_f32 v178, v124, v125
    v_cvt_pk_bf16_f32 v179, v126, v127
    ds_write_b128 v23, v[176:179] offset:32
    v_cvt_pk_bf16_f32 v180, v128, v129
    v_cvt_pk_bf16_f32 v181, v130, v131
    v_cvt_pk_bf16_f32 v182, v132, v133
    v_cvt_pk_bf16_f32 v183, v134, v135
    ds_write_b128 v23, v[180:183] offset:48
    v_cvt_pk_bf16_f32 v184, v136, v137
    v_cvt_pk_bf16_f32 v185, v138, v139
    v_cvt_pk_bf16_f32 v186, v140, v141
    v_cvt_pk_bf16_f32 v187, v142, v143
    ds_write_b128 v23, v[184:187] offset:64
    s_waitcnt vmcnt(5)
    s_waitcnt lgkmcnt(0)
    s_barrier
    ds_read_b64_tr_b16 v[200:201], v22 offset:0
    ds_read_b64_tr_b16 v[202:203], v22 offset:192
    ds_read_b64_tr_b16 v[104:105], v20 offset:0
    ds_read_b64_tr_b16 v[106:107], v20 offset:320
    ds_read_b64_tr_b16 v[108:109], v21 offset:0
    ds_read_b64_tr_b16 v[110:111], v21 offset:320
    ds_read_b64_tr_b16 v[204:205], v22 offset:768
    ds_read_b64_tr_b16 v[206:207], v22 offset:960
    ds_read_b64_tr_b16 v[112:113], v20 offset:1280
    ds_read_b64_tr_b16 v[114:115], v20 offset:1600
    ds_read_b64_tr_b16 v[116:117], v21 offset:1280
    ds_read_b64_tr_b16 v[118:119], v21 offset:1600
    s_waitcnt lgkmcnt(6)
    v_mfma_f32_32x32x16_bf16 v[40:55], v[108:111], v[200:203], 0
    v_mfma_f32_32x32x16_bf16 v[24:39], v[104:107], v[200:203], 0
    ds_read_b64_tr_b16 v[208:209], v22 offset:1536
    ds_read_b64_tr_b16 v[210:211], v22 offset:1728
    ds_read_b64_tr_b16 v[120:121], v20 offset:2560
    ds_read_b64_tr_b16 v[122:123], v20 offset:2880
    ds_read_b64_tr_b16 v[124:125], v21 offset:2560
    ds_read_b64_tr_b16 v[126:127], v21 offset:2880
    s_waitcnt lgkmcnt(6)
    v_mfma_f32_32x32x16_bf16 v[40:55], v[116:119], v[204:207], v[40:55]
    v_mfma_f32_32x32x16_bf16 v[24:39], v[112:115], v[204:207], v[24:39]
    ds_read_b64_tr_b16 v[212:213], v22 offset:2304
    ds_read_b64_tr_b16 v[214:215], v22 offset:2496
    ds_read_b64_tr_b16 v[128:129], v20 offset:3840
    ds_read_b64_tr_b16 v[130:131], v20 offset:4160
    ds_read_b64_tr_b16 v[132:133], v21 offset:3840
    ds_read_b64_tr_b16 v[134:135], v21 offset:4160
    s_waitcnt lgkmcnt(6)
    v_mfma_f32_32x32x16_bf16 v[40:55], v[124:127], v[208:211], v[40:55]
    v_mfma_f32_32x32x16_bf16 v[24:39], v[120:123], v[208:211], v[24:39]
    s_waitcnt lgkmcnt(0)
    v_mfma_f32_32x32x16_bf16 v[40:55], v[132:135], v[212:215], v[40:55]
    v_mfma_f32_32x32x16_bf16 v[24:39], v[128:131], v[212:215], v[24:39]
    ds_write_b32 v12, v12 offset:496
    s_mov_b64 exec, s[68:69]
    s_nop 8
    s_nop 0
    v_add_u32 v40, 0x80, v40
    v_add_u32 v41, 0x80, v41
    v_add_u32 v42, 0x80, v42
    v_add_u32 v43, 0x80, v43
    v_perm_b32 v24, v24, v40, s8
    v_perm_b32 v25, v25, v40, s9
    v_perm_b32 v26, v26, v40, s10
    v_perm_b32 v27, v27, v81, s11
    buffer_store_dwordx4 v[24:27], v18, s[16:19], s71 offen sc1
    s_add_u32 s71, s71, 24576
    v_perm_b32 v28, v28, v41, s8
    v_perm_b32 v29, v29, v41, s9
    v_perm_b32 v30, v30, v41, s10
    v_perm_b32 v31, v31, v81, s11
    buffer_store_dwordx4 v[28:31], v18, s[16:19], s71 offen sc1
    s_add_u32 s71, s71, 24576
    v_perm_b32 v32, v32, v42, s8
    v_perm_b32 v33, v33, v42, s9
    v_perm_b32 v34, v34, v42, s10
    v_perm_b32 v35, v35, v81, s11
    buffer_store_dwordx4 v[32:35], v18, s[16:19], s71 offen sc1
    s_add_u32 s71, s71, 24576
    v_perm_b32 v36, v36, v43, s8
    v_perm_b32 v37, v37, v43, s9
    v_perm_b32 v38, v38, v43, s10
    v_perm_b32 v39, v39, v81, s11
    buffer_store_dwordx4 v[36:39], v18, s[16:19], s71 offen sc1
    s_mov_b64 exec, -1
    s_waitcnt vmcnt(4)
    ds_write_b32 v12, v12 offset:192
    s_add_u32 m0, s62, 0
    s_nop 0
    buffer_load_dwordx4 v4, s[12:15], s33 offen offset:0 lds
    buffer_load_dwordx4 v5, s[12:15], s33 offen offset:1024 lds
    buffer_load_dwordx4 v6, s[12:15], s33 offen offset:2048 lds
    buffer_load_dwordx4 v7, s[12:15], s33 offen offset:3072 lds
    s_add_u32 m0, s62, 4096
    s_nop 0
    buffer_load_dwordx4 v8, s[12:15], s33 offen lds
    s_add_u32 m0, s62, 20480
    s_nop 0
    buffer_load_dwordx4 v4, s[12:15], s75 offen offset:0 lds
    buffer_load_dwordx4 v5, s[12:15], s75 offen offset:1024 lds
    buffer_load_dwordx4 v6, s[12:15], s75 offen offset:2048 lds
    buffer_load_dwordx4 v7, s[12:15], s75 offen offset:3072 lds
    s_add_u32 m0, s62, 24576
    s_nop 0
    buffer_load_dwordx4 v8, s[12:15], s75 offen lds
    s_cmp_ge_u32 s0, 5
    s_cbranch_scc1 L_E_aux
    s_branch L_E_B
    .p2align 12
pg_84:
L_E_aux:
    s_sub_u32 s58, s0, 5
    s_lshl2_add_u32 s58, s58, s6
    s_mul_i32 s59, s58, 11
    s_lshr_b32 s59, s59, 5
    s_mul_i32 s56, s59, 3
    s_sub_u32 s56, s58, s56
    s_lshl_b32 s56, s56, 8
    s_and_b32 s69, s59, 1
    s_lshl2_add_u32 s59, s3, s59
    s_mul_i32 s67, s59, 24576
    s_add_u32 s67, s67, s56
    s_add_u32 s67, s67, 65536
    s_mul_i32 s68, s59, 768
    s_add_u32 s68, s68, s56
    s_add_u32 s68, s68, 3211264
    v_mul_u32_u24 v14, 768, v3
    v_lshl_add_u32 v14, v2, 4, v14
    s_mov_b32 s8, 0x0c04000c
    s_mov_b32 s9, 0xffffff00
    v_mov_b32 v15, 0x80
    v_mov_b32 v64, s28
    v_mov_b32 v69, s28
    s_waitcnt vmcnt(10)
    s_add_u32 s58, s67, 0
    buffer_load_dwordx4 v[104:107], v14, s[16:19], s58 offen sc1
    s_add_u32 s58, s67, 3072
    buffer_load_dwordx4 v[108:111], v14, s[16:19], s58 offen sc1
    s_add_u32 s58, s67, 6144
    buffer_load_dwordx4 v[112:115], v14, s[16:19], s58 offen sc1
    s_add_u32 s58, s67, 9216
    buffer_load_dwordx4 v[116:119], v14, s[16:19], s58 offen sc1
    s_add_u32 s58, s67, 12288
    buffer_load_dwordx4 v[120:123], v14, s[16:19], s58 offen sc1
    s_add_u32 s58, s67, 15360
    buffer_load_dwordx4 v[124:127], v14, s[16:19], s58 offen sc1
    s_add_u32 s58, s67, 18432
    buffer_load_dwordx4 v[128:131], v14, s[16:19], s58 offen sc1
    s_add_u32 s58, s67, 21504
    buffer_load_dwordx4 v[132:135], v14, s[16:19], s58 offen sc1
    s_waitcnt vmcnt(8)
    ds_write_b32 v12, v12 offset:208
    ds_write_b32 v12, v12 offset:224
    s_mov_b32 s57, 65536
ga_85:
    s_waitcnt vmcnt(7)
    v_perm_b32 v17, v105, v104, s8
    v_lshl_or_b32 v60, v106, 24, v17
    v_xor_b32 v16, s28, v107
    v_and_or_b32 v56, v104, s9, v15
    v_and_or_b32 v57, v105, s9, v15
    v_and_or_b32 v58, v106, s9, v15
    v_and_or_b32 v59, v107, s9, v15
    s_waitcnt vmcnt(6)
    s_nop 0
    v_perm_b32 v17, v109, v108, s8
    v_lshl_or_b32 v17, v110, 24, v17
    v_bitop3_b32 v16, v16, v111, v64 bitop3:0xf6
    v_and_or_b32 v70, v108, s9, v15
    v_and_or_b32 v71, v109, s9, v15
    v_and_or_b32 v72, v110, s9, v15
    v_and_or_b32 v73, v111, s9, v15
    v_add_f32 v56, v56, v70
    v_add_f32 v57, v57, v71
    v_add_f32 v58, v58, v72
    v_add_f32 v59, v59, v73
    v_add_f32 v60, v60, v17
    s_waitcnt vmcnt(5)
    v_perm_b32 v17, v113, v112, s8
    v_lshl_or_b32 v17, v114, 24, v17
    v_bitop3_b32 v16, v16, v115, v64 bitop3:0xf6
    v_and_or_b32 v70, v112, s9, v15
    v_and_or_b32 v71, v113, s9, v15
    v_and_or_b32 v72, v114, s9, v15
    v_and_or_b32 v73, v115, s9, v15
    v_add_f32 v56, v56, v70
    v_add_f32 v57, v57, v71
    v_add_f32 v58, v58, v72
    v_add_f32 v59, v59, v73
    v_add_f32 v60, v60, v17
    s_waitcnt vmcnt(4)
    v_perm_b32 v17, v117, v116, s8
    v_lshl_or_b32 v17, v118, 24, v17
    v_bitop3_b32 v16, v16, v119, v64 bitop3:0xf6
    v_and_or_b32 v70, v116, s9, v15
    v_and_or_b32 v71, v117, s9, v15
    v_and_or_b32 v72, v118, s9, v15
    v_and_or_b32 v73, v119, s9, v15
    v_add_f32 v56, v56, v70
    v_add_f32 v57, v57, v71
    v_add_f32 v58, v58, v72
    v_add_f32 v59, v59, v73
    v_add_f32 v60, v60, v17
    s_waitcnt vmcnt(3)
    v_perm_b32 v17, v121, v120, s8
    v_lshl_or_b32 v17, v122, 24, v17
    v_bitop3_b32 v16, v16, v123, v64 bitop3:0xf6
    v_and_or_b32 v70, v120, s9, v15
    v_and_or_b32 v71, v121, s9, v15
    v_and_or_b32 v72, v122, s9, v15
    v_and_or_b32 v73, v123, s9, v15
    v_add_f32 v56, v56, v70
    v_add_f32 v57, v57, v71
    v_add_f32 v58, v58, v72
    v_add_f32 v59, v59, v73
    v_add_f32 v60, v60, v17
    s_waitcnt vmcnt(2)
    v_perm_b32 v17, v125, v124, s8
    v_lshl_or_b32 v17, v126, 24, v17
    v_bitop3_b32 v16, v16, v127, v64 bitop3:0xf6
    v_and_or_b32 v70, v124, s9, v15
    v_and_or_b32 v71, v125, s9, v15
    v_and_or_b32 v72, v126, s9, v15
    v_and_or_b32 v73, v127, s9, v15
    v_add_f32 v56, v56, v70
    v_add_f32 v57, v57, v71
    v_add_f32 v58, v58, v72
    v_add_f32 v59, v59, v73
    v_add_f32 v60, v60, v17
    s_waitcnt vmcnt(1)
    v_perm_b32 v17, v129, v128, s8
    v_lshl_or_b32 v17, v130, 24, v17
    v_bitop3_b32 v16, v16, v131, v64 bitop3:0xf6
    v_and_or_b32 v70, v128, s9, v15
    v_and_or_b32 v71, v129, s9, v15
    v_and_or_b32 v72, v130, s9, v15
    v_and_or_b32 v73, v131, s9, v15
    v_add_f32 v56, v56, v70
    v_add_f32 v57, v57, v71
    v_add_f32 v58, v58, v72
    v_add_f32 v59, v59, v73
    v_add_f32 v60, v60, v17
    s_waitcnt vmcnt(0)
    v_perm_b32 v17, v133, v132, s8
    v_lshl_or_b32 v17, v134, 24, v17
    v_bitop3_b32 v16, v16, v135, v64 bitop3:0xf6
    v_and_or_b32 v70, v132, s9, v15
    v_and_or_b32 v71, v133, s9, v15
    v_and_or_b32 v72, v134, s9, v15
    v_and_or_b32 v73, v135, s9, v15
    v_add_f32 v56, v56, v70
    v_add_f32 v57, v57, v71
    v_add_f32 v58, v58, v72
    v_add_f32 v59, v59, v73
    v_add_f32_e64 v60, v60, v17
    v_and_b32 v16, 0xff, v16
    v_cmp_ne_u32 vcc, 0, v16
    s_cbranch_vccnz gr_86
gae_87:
    v_mov_b32 v61, v60
    v_permlane32_swap_b32 v56, v57
    v_permlane32_swap_b32 v58, v59
    v_permlane32_swap_b32 v60, v61
    v_add_f32 v60, v60, v61
    v_add_f32 v56, v56, v57
    v_add_f32 v58, v58, v59
    v_mov_b32 v61, v60
    s_nop 0
    v_permlane16_swap_b32 v56, v58
    v_permlane16_swap_b32 v60, v61
    v_add_f32 v56, v56, v58
    v_add_f32_e64 v60, v60, v61
    v_cvt_pk_bf16_f32 v65, v60, 0
    v_permlane32_swap_b32 v56, v57
    v_mov_b32 v68, v65
    v_cvt_pk_bf16_f32 v66, v56, v57
    s_nop 1
    v_permlane16_swap_b32 v66, v67
    s_mov_b64 exec, 0xffff
    s_cmp_lg_u32 s69, 0
    s_cbranch_scc1 L_fodd
    buffer_store_dwordx4 v[64:67], v14, s[16:19], s68 offen sc1
    s_branch L_fdone
L_fodd:
    buffer_store_dwordx4 v[66:69], v14, s[16:19], s68 offen sc1
L_fdone:
    s_mov_b64 exec, -1
    s_branch L_aux
gr_86:
    s_sub_u32 s57, s57, 1
    s_cbranch_scc1 gae_87
    v_cmp_ne_u32_sdwa vcc, v107, v64 src0_sel:BYTE_0 src1_sel:BYTE_0
    s_wqm_b64 exec, vcc
    s_add_u32 s58, s67, 0
    buffer_load_dwordx4 v[104:107], v14, s[16:19], s58 offen sc1
    s_mov_b64 exec, -1
    v_cmp_ne_u32_sdwa vcc, v111, v64 src0_sel:BYTE_0 src1_sel:BYTE_0
    s_wqm_b64 exec, vcc
    s_add_u32 s58, s67, 3072
    buffer_load_dwordx4 v[108:111], v14, s[16:19], s58 offen sc1
    s_mov_b64 exec, -1
    v_cmp_ne_u32_sdwa vcc, v115, v64 src0_sel:BYTE_0 src1_sel:BYTE_0
    s_wqm_b64 exec, vcc
    s_add_u32 s58, s67, 6144
    buffer_load_dwordx4 v[112:115], v14, s[16:19], s58 offen sc1
    s_mov_b64 exec, -1
    v_cmp_ne_u32_sdwa vcc, v119, v64 src0_sel:BYTE_0 src1_sel:BYTE_0
    s_wqm_b64 exec, vcc
    s_add_u32 s58, s67, 9216
    buffer_load_dwordx4 v[116:119], v14, s[16:19], s58 offen sc1
    s_mov_b64 exec, -1
    v_cmp_ne_u32_sdwa vcc, v123, v64 src0_sel:BYTE_0 src1_sel:BYTE_0
    s_wqm_b64 exec, vcc
    s_add_u32 s58, s67, 12288
    buffer_load_dwordx4 v[120:123], v14, s[16:19], s58 offen sc1
    s_mov_b64 exec, -1
    v_cmp_ne_u32_sdwa vcc, v127, v64 src0_sel:BYTE_0 src1_sel:BYTE_0
    s_wqm_b64 exec, vcc
    s_add_u32 s58, s67, 15360
    buffer_load_dwordx4 v[124:127], v14, s[16:19], s58 offen sc1
    s_mov_b64 exec, -1
    v_cmp_ne_u32_sdwa vcc, v131, v64 src0_sel:BYTE_0 src1_sel:BYTE_0
    s_wqm_b64 exec, vcc
    s_add_u32 s58, s67, 18432
    buffer_load_dwordx4 v[128:131], v14, s[16:19], s58 offen sc1
    s_mov_b64 exec, -1
    v_cmp_ne_u32_sdwa vcc, v135, v64 src0_sel:BYTE_0 src1_sel:BYTE_0
    s_wqm_b64 exec, vcc
    s_add_u32 s58, s67, 21504
    buffer_load_dwordx4 v[132:135], v14, s[16:19], s58 offen sc1
    s_mov_b64 exec, -1
    s_waitcnt vmcnt(0)
    s_branch ga_85
fs_82:
    s_mov_b32 s57, 524288
fw_88:
    ds_read_b32 v80, v13 offset:352
    s_waitcnt lgkmcnt(0)
    v_cmp_eq_u32 vcc, 0, v80
    s_cbranch_vccz fwe_89
    s_sub_u32 s57, s57, 1
    s_cbranch_scc0 fw_88
fwe_89:
    s_branch fr_83
fs_80:
    s_mov_b32 s57, 524288
fw_90:
    ds_read_b32 v80, v13 offset:336
    s_waitcnt lgkmcnt(0)
    v_cmp_eq_u32 vcc, 0, v80
    s_cbranch_vccz fwe_91
    s_sub_u32 s57, s57, 1
    s_cbranch_scc0 fw_90
fwe_91:
    s_branch fr_81
fs_78:
    s_mov_b32 s57, 524288
fw_92:
    ds_read_b32 v80, v13 offset:560
    s_waitcnt lgkmcnt(0)
    v_cmp_eq_u32 vcc, 0, v80
    s_cbranch_vccz fwe_93
    s_sub_u32 s57, s57, 1
    s_cbranch_scc0 fw_92
fwe_93:
    s_branch fr_79
fs_74:
    s_mov_b32 s57, 524288
fw_94:
    ds_read_b32 v80, v13 offset:288
    s_waitcnt lgkmcnt(0)
    v_cmp_eq_u32 vcc, 0, v80
    s_cbranch_vccz fwe_95
    s_sub_u32 s57, s57, 1
    s_cbranch_scc0 fw_94
fwe_95:
    s_branch fr_75
fs_2:
    s_mov_b32 s57, 524288
fw_96:
    ds_read_b32 v14, v13 offset:16
    s_waitcnt lgkmcnt(0)
    v_cmp_eq_u32 vcc, 0, v14
    s_cbranch_vccz fwe_97
    s_sub_u32 s57, s57, 1
    s_cbranch_scc0 fw_96
fwe_97:
    s_branch fr_3
fs_4:
    s_mov_b32 s57, 524288
fw_98:
    ds_read_b32 v14, v13 offset:32
    s_waitcnt lgkmcnt(0)
    v_cmp_eq_u32 vcc, 0, v14
    s_cbranch_vccz fwe_99
    s_sub_u32 s57, s57, 1
    s_cbranch_scc0 fw_98
fwe_99:
    s_branch fr_5
fs_6:
    s_mov_b32 s57, 524288
fw_100:
    ds_read_b32 v14, v13 offset:48
    s_waitcnt lgkmcnt(0)
    v_cmp_eq_u32 vcc, 0, v14
    s_cbranch_vccz fwe_101
    s_sub_u32 s57, s57, 1
    s_cbranch_scc0 fw_100
fwe_101:
    s_branch fr_7
fs_8:
    s_mov_b32 s57, 524288
fw_102:
    ds_read_b32 v14, v13 offset:64
    s_waitcnt lgkmcnt(0)
    v_cmp_eq_u32 vcc, 0, v14
    s_cbranch_vccz fwe_103
    s_sub_u32 s57, s57, 1
    s_cbranch_scc0 fw_102
fwe_103:
    s_branch fr_9
fs_10:
    s_mov_b32 s57, 524288
fw_104:
    ds_read_b32 v14, v13 offset:80
    s_waitcnt lgkmcnt(0)
    v_cmp_eq_u32 vcc, 0, v14
    s_cbranch_vccz fwe_105
    s_sub_u32 s57, s57, 1
    s_cbranch_scc0 fw_104
fwe_105:
    s_branch fr_11
fs_12:
    s_mov_b32 s57, 524288
fw_106:
    ds_read_b32 v14, v13 offset:96
    s_waitcnt lgkmcnt(0)
    v_cmp_eq_u32 vcc, 0, v14
    s_cbranch_vccz fwe_107
    s_sub_u32 s57, s57, 1
    s_cbranch_scc0 fw_106
fwe_107:
    s_branch fr_13
fs_14:
    s_mov_b32 s57, 524288
fw_108:
    ds_read_b32 v14, v13 offset:112
    s_waitcnt lgkmcnt(0)
    v_cmp_eq_u32 vcc, 0, v14
    s_cbranch_vccz fwe_109
    s_sub_u32 s57, s57, 1
    s_cbranch_scc0 fw_108
fwe_109:
    s_branch fr_15
fs_16:
    s_mov_b32 s57, 524288
fw_110:
    ds_read_b32 v14, v13 offset:128
    s_waitcnt lgkmcnt(0)
    v_cmp_eq_u32 vcc, 0, v14
    s_cbranch_vccz fwe_111
    s_sub_u32 s57, s57, 1
    s_cbranch_scc0 fw_110
fwe_111:
    s_branch fr_17
fs_18:
    s_mov_b32 s57, 524288
fw_112:
    ds_read_b32 v14, v13 offset:144
    s_waitcnt lgkmcnt(0)
    v_cmp_eq_u32 vcc, 0, v14
    s_cbranch_vccz fwe_113
    s_sub_u32 s57, s57, 1
    s_cbranch_scc0 fw_112
fwe_113:
    s_branch fr_19
fs_20:
    s_mov_b32 s57, 524288
fw_114:
    ds_read_b32 v14, v13 offset:192
    s_waitcnt lgkmcnt(0)
    v_cmp_eq_u32 vcc, 0, v14
    s_cbranch_vccz fwe_115
    s_sub_u32 s57, s57, 1
    s_cbranch_scc0 fw_114
fwe_115:
    s_branch fr_21
fs_22:
    s_mov_b32 s57, 524288
fw_116:
    ds_read_b32 v14, v13 offset:208
    s_waitcnt lgkmcnt(0)
    v_cmp_eq_u32 vcc, 0, v14
    s_cbranch_vccz fwe_117
    s_sub_u32 s57, s57, 1
    s_cbranch_scc0 fw_116
fwe_117:
    s_branch fr_23
fs_25:
    s_mov_b32 s57, 524288
fw_118:
    ds_read_b32 v14, v13 offset:224
    s_waitcnt lgkmcnt(0)
    v_cmp_eq_u32 vcc, 0, v14
    s_cbranch_vccz fwe_119
    s_sub_u32 s57, s57, 1
    s_cbranch_scc0 fw_118
fwe_119:
    s_branch fr_26
fs_27:
    s_mov_b32 s57, 524288
fw_120:
    ds_read_b32 v20, v13 offset:448
    s_waitcnt lgkmcnt(0)
    v_cmp_eq_u32 vcc, 0, v20
    s_cbranch_vccz fwe_121
    s_sub_u32 s57, s57, 1
    s_cbranch_scc0 fw_120
fwe_121:
    s_branch fr_28
gr_32:
    s_sub_u32 s57, s57, 1
    s_cbranch_scc1 gae_33
    v_cmp_ne_u32 vcc, s28, v48
    s_wqm_b64 exec, vcc
    buffer_load_dwordx4 v[48:51], v251, s[16:19], s71 offen offset:0 sc1
    s_mov_b64 exec, -1
    v_cmp_ne_u32 vcc, s28, v55
    s_wqm_b64 exec, vcc
    buffer_load_dwordx4 v[52:55], v251, s[16:19], s71 offen offset:768 sc1
    s_mov_b64 exec, -1
    v_cmp_ne_u32 vcc, s28, v56
    s_wqm_b64 exec, vcc
    buffer_load_dwordx4 v[56:59], v251, s[16:19], s71 offen offset:1536 sc1
    s_mov_b64 exec, -1
    v_cmp_ne_u32 vcc, s28, v63
    s_wqm_b64 exec, vcc
    buffer_load_dwordx4 v[60:63], v251, s[16:19], s71 offen offset:2304 sc1
    s_mov_b64 exec, -1
    s_waitcnt vmcnt(0)
    s_branch ga_31
L_E_B:
    v_bfe_u32 v14, v1, 2, 2
    v_and_b32 v16, 3, v1
    v_and_b32 v15, 1, v3
    v_lshl_add_u32 v15, v15, 2, v16
    v_and_b32 v17, 1, v15
    v_lshrrev_b32 v15, 1, v15
    v_lshl_add_u32 v15, v17, 2, v15
    v_xor_b32 v17, s6, v14
    v_lshlrev_b32 v17, 6, v17
    v_lshl_add_u32 v15, v15, 3, v17
    v_lshl_add_u32 v15, v14, 8, v15
    v_lshrrev_b32_e64 v16, 5, v1
    v_lshl_add_u32 v5, v16, 11, v15
    v_add_u32 v6, 61440, v5
    v_mul_u32_u24 v16, 10240, v16
    v_add_u32_e64 v7, v15, v16
    v_add_u32 v8, 61440, v7
    v_add_u32 v18, 122880, v5
    v_add_u32 v19, 122880, v7
    s_mov_b32 s57, 524288
fw_122:
    ds_read_b32 v14, v13 offset:496
    s_waitcnt lgkmcnt(0)
    v_cmp_eq_u32 vcc, 0, v14
    s_cbranch_vccz fwe_123
    s_sub_u32 s57, s57, 1
    s_cbranch_scc0 fw_122
fwe_123:
    s_waitcnt vmcnt(10)
    s_waitcnt vmcnt(5)
    ds_write_b32 v12, v12 offset:208
    s_waitcnt vmcnt(0)
    ds_write_b32 v12, v12 offset:224
    s_add_u32 m0, s62, 61440
    s_and_b32 s30, s3, 7
    s_add_u32 s30, s30, 1
    s_cmp_ge_u32 s30, 8
    s_addc_u32 s30, s30, s4
    s_and_b32 s30, s30, 7
    s_mul_i32 s30, s30, 102400
    s_add_u32 s30, s30, s29
    buffer_load_dwordx4 v9, s[24:27], s30 offen lds
    s_add_u32 m0, s62, 62464
    s_add_u32 s30, s30, 5120
    buffer_load_dwordx4 v9, s[24:27], s30 offen lds
    s_add_u32 m0, s62, 63488
    s_add_u32 s30, s30, 5120
    buffer_load_dwordx4 v9, s[24:27], s30 offen lds
    s_add_u32 m0, s62, 64512
    s_add_u32 s30, s30, 5120
    buffer_load_dwordx4 v9, s[24:27], s30 offen lds
    s_add_u32 m0, s62, 65536
    s_add_u32 s30, s30, 5120
    buffer_load_dwordx4 v9, s[24:27], s30 offen lds
    s_add_u32 m0, s62, 40960
    s_mov_b32 s30, s4
    s_mul_i32 s30, s30, 102400
    s_add_u32 s30, s30, s29
    buffer_load_dwordx4 v9, s[24:27], s30 offen lds
    s_add_u32 m0, s62, 41984
    s_add_u32 s30, s30, 5120
    buffer_load_dwordx4 v9, s[24:27], s30 offen lds
    s_add_u32 m0, s62, 43008
    s_add_u32 s30, s30, 5120
    buffer_load_dwordx4 v9, s[24:27], s30 offen lds
    s_add_u32 m0, s62, 44032
    s_add_u32 s30, s30, 5120
    buffer_load_dwordx4 v9, s[24:27], s30 offen lds
    s_add_u32 m0, s62, 45056
    s_add_u32 s30, s30, 5120
    buffer_load_dwordx4 v9, s[24:27], s30 offen lds
    s_mov_b32 s57, 524288
fw_124:
    ds_read_b32 v14, v13 offset:432
    s_waitcnt lgkmcnt(0)
    v_cmp_eq_u32 vcc, 0, v14
    s_cbranch_vccz fwe_125
    s_sub_u32 s57, s57, 1
    s_cbranch_scc0 fw_124
fwe_125:
    s_add_u32 m0, s62, 81920
    s_and_b32 s30, s3, 7
    s_add_u32 s30, s30, 2
    s_cmp_ge_u32 s30, 8
    s_addc_u32 s30, s30, s4
    s_and_b32 s30, s30, 7
    s_mul_i32 s30, s30, 102400
    s_add_u32 s30, s30, s29
    buffer_load_dwordx4 v9, s[24:27], s30 offen lds
    s_add_u32 m0, s62, 82944
    s_add_u32 s30, s30, 5120
    buffer_load_dwordx4 v9, s[24:27], s30 offen lds
    s_add_u32 m0, s62, 83968
    s_add_u32 s30, s30, 5120
    buffer_load_dwordx4 v9, s[24:27], s30 offen lds
    s_add_u32 m0, s62, 84992
    s_add_u32 s30, s30, 5120
    buffer_load_dwordx4 v9, s[24:27], s30 offen lds
    s_add_u32 m0, s62, 86016
    s_add_u32 s30, s30, 5120
    buffer_load_dwordx4 v9, s[24:27], s30 offen lds
    s_add_u32 m0, s62, 102400
    s_and_b32 s30, s3, 7
    s_add_u32 s30, s30, 3
    s_cmp_ge_u32 s30, 8
    s_addc_u32 s30, s30, s4
    s_and_b32 s30, s30, 7
    s_mul_i32 s30, s30, 102400
    s_add_u32 s30, s30, s29
    buffer_load_dwordx4 v9, s[24:27], s30 offen lds
    s_add_u32 m0, s62, 103424
    s_add_u32 s30, s30, 5120
    buffer_load_dwordx4 v9, s[24:27], s30 offen lds
    s_add_u32 m0, s62, 104448
    s_add_u32 s30, s30, 5120
    buffer_load_dwordx4 v9, s[24:27], s30 offen lds
    s_add_u32 m0, s62, 105472
    s_add_u32 s30, s30, 5120
    buffer_load_dwordx4 v9, s[24:27], s30 offen lds
    s_add_u32 m0, s62, 106496
    s_add_u32 s30, s30, 5120
    buffer_load_dwordx4 v9, s[24:27], s30 offen lds
    s_mov_b32 s57, 524288
fw_126:
    ds_read_b32 v14, v13 offset:464
    s_waitcnt lgkmcnt(0)
    v_cmp_eq_u32 vcc, 0, v14
    s_cbranch_vccz fwe_127
    s_sub_u32 s57, s57, 1
    s_cbranch_scc0 fw_126
fwe_127:
    s_add_u32 m0, s62, 0
    s_and_b32 s30, s3, 7
    s_add_u32 s30, s30, 4
    s_cmp_ge_u32 s30, 8
    s_addc_u32 s30, s30, s4
    s_and_b32 s30, s30, 7
    s_mul_i32 s30, s30, 102400
    s_add_u32 s30, s30, s29
    buffer_load_dwordx4 v9, s[24:27], s30 offen lds
    s_add_u32 m0, s62, 1024
    s_add_u32 s30, s30, 5120
    buffer_load_dwordx4 v9, s[24:27], s30 offen lds
    s_add_u32 m0, s62, 2048
    s_add_u32 s30, s30, 5120
    buffer_load_dwordx4 v9, s[24:27], s30 offen lds
    s_add_u32 m0, s62, 3072
    s_add_u32 s30, s30, 5120
    buffer_load_dwordx4 v9, s[24:27], s30 offen lds
    s_add_u32 m0, s62, 4096
    s_add_u32 s30, s30, 5120
    buffer_load_dwordx4 v9, s[24:27], s30 offen lds
    v_lshlrev_b32 v10, 4, v1
    s_lshl_b32 s58, s6, 10
    s_add_u32 s58, s58, 143360
    v_add_u32 v4, s58, v10
    v_add_u32 v10, 40960, v10
    v_add_u32 v11, 40960, v10
    v_and_b32 v14, 31, v1
    v_lshrrev_b32 v15, 5, v1
    v_lshlrev_b32_e64 v14, 3, v14
    v_lshl_add_u32 v16, v15, 10, v14
    v_add_u32 v16, 40960, v16
    v_add_u32 v17, 40960, v16
    s_branch pg_128
    .p2align 12
pg_128:
    s_waitcnt vmcnt(0)
    ds_write_b32 v12, v12 offset:608
    s_mov_b32 s57, 524288
fw_129:
    ds_read_b32 v14, v13 offset:608
    s_waitcnt lgkmcnt(0)
    v_cmp_eq_u32 vcc, 0, v14
    s_cbranch_vccz fwe_130
    s_sub_u32 s57, s57, 1
    s_cbranch_scc0 fw_129
fwe_130:
    s_mov_b32 s57, 524288
fw_131:
    ds_read_b32 v14, v13 offset:576
    s_waitcnt lgkmcnt(0)
    v_cmp_eq_u32 vcc, 0, v14
    s_cbranch_vccz fwe_132
    s_sub_u32 s57, s57, 1
    s_cbranch_scc0 fw_131
fwe_132:
    ds_read_b64_tr_b16 v[44:45], v6 offset:0
    ds_read_b64_tr_b16 v[46:47], v6 offset:1024
    ds_read_b64_tr_b16 v[48:49], v6 offset:5120
    ds_read_b64_tr_b16 v[50:51], v6 offset:6144
    ds_read_b64_tr_b16 v[52:53], v6 offset:10240
    ds_read_b64_tr_b16 v[54:55], v6 offset:11264
    ds_read_b64_tr_b16 v[56:57], v6 offset:15360
    ds_read_b64_tr_b16 v[58:59], v6 offset:16384
    ds_read_b64_tr_b16 v[60:61], v8 offset:4096
    ds_read_b64_tr_b16 v[62:63], v8 offset:9216
    ds_read_b64_tr_b16 v[24:25], v5 offset:40960
    ds_read_b64_tr_b16 v[26:27], v5 offset:41984
    ds_read_b64_tr_b16 v[28:29], v5 offset:46080
    ds_read_b64_tr_b16 v[30:31], v5 offset:47104
    s_waitcnt lgkmcnt(13)
    ds_read_b64_tr_b16 v[32:33], v5 offset:51200
    ds_read_b64_tr_b16 v[34:35], v5 offset:52224
    s_waitcnt lgkmcnt(13)
    ds_read_b64_tr_b16 v[36:37], v5 offset:56320
    ds_read_b64_tr_b16 v[38:39], v5 offset:57344
    s_waitcnt lgkmcnt(13)
    ds_read_b64_tr_b16 v[40:41], v7 offset:45056
    ds_read_b64_tr_b16 v[42:43], v7 offset:50176
    s_waitcnt lgkmcnt(13)
    ds_read_b64_tr_b16 v[64:65], v6 offset:20480
    ds_read_b64_tr_b16 v[66:67], v6 offset:21504
    s_waitcnt lgkmcnt(13)
    ds_read_b64_tr_b16 v[68:69], v6 offset:25600
    ds_read_b64_tr_b16 v[70:71], v6 offset:26624
    s_waitcnt lgkmcnt(13)
    ds_read_b64_tr_b16 v[72:73], v6 offset:30720
    ds_read_b64_tr_b16 v[74:75], v6 offset:31744
    s_waitcnt lgkmcnt(13)
    ds_read_b64_tr_b16 v[76:77], v6 offset:35840
    ds_read_b64_tr_b16 v[78:79], v6 offset:36864
    s_waitcnt lgkmcnt(13)
    ds_read_b64_tr_b16 v[80:81], v8 offset:24576
    ds_read_b64_tr_b16 v[82:83], v8 offset:29696
    s_waitcnt lgkmcnt(13)
    ds_read_b64_tr_b16 v[84:85], v6 offset:40960
    ds_read_b64_tr_b16 v[86:87], v6 offset:41984
    s_waitcnt lgkmcnt(13)
    ds_read_b64_tr_b16 v[88:89], v6 offset:46080
    ds_read_b64_tr_b16 v[90:91], v6 offset:47104
    s_waitcnt lgkmcnt(13)
    ds_read_b64_tr_b16 v[92:93], v6 offset:51200
    ds_read_b64_tr_b16 v[94:95], v6 offset:52224
    s_waitcnt lgkmcnt(13)
    ds_read_b64_tr_b16 v[96:97], v6 offset:56320
    ds_read_b64_tr_b16 v[98:99], v6 offset:57344
    s_waitcnt lgkmcnt(13)
    ds_read_b64_tr_b16 v[100:101], v8 offset:45056
    ds_read_b64_tr_b16 v[102:103], v8 offset:50176
    s_waitcnt lgkmcnt(13)
    ds_read_b64_tr_b16 v[104:105], v5 offset:0
    ds_read_b64_tr_b16 v[106:107], v5 offset:1024
    s_waitcnt lgkmcnt(13)
    ds_read_b64_tr_b16 v[108:109], v5 offset:5120
    ds_read_b64_tr_b16 v[110:111], v5 offset:6144
    s_waitcnt lgkmcnt(13)
    ds_read_b64_tr_b16 v[112:113], v5 offset:10240
    ds_read_b64_tr_b16 v[114:115], v5 offset:11264
    s_waitcnt lgkmcnt(13)
    ds_read_b64_tr_b16 v[116:117], v5 offset:15360
    ds_read_b64_tr_b16 v[118:119], v5 offset:16384
    s_waitcnt lgkmcnt(13)
    ds_read_b64_tr_b16 v[120:121], v7 offset:4096
    ds_read_b64_tr_b16 v[122:123], v7 offset:9216
    s_waitcnt lgkmcnt(8)
    ds_write_b32 v12, v12 offset:592
    s_mov_b32 s57, 524288
fw_133:
    ds_read_b32 v14, v13 offset:640
    s_waitcnt lgkmcnt(0)
    v_cmp_eq_u32 vcc, 0, v14
    s_cbranch_vccz fwe_134
    s_sub_u32 s57, s57, 1
    s_cbranch_scc0 fw_133
fwe_134:
    ds_read_b128 v[216:219], v10 offset:0
    ds_read_b128 v[220:223], v10 offset:1024
    ds_read_b128 v[224:227], v10 offset:2048
    s_waitcnt lgkmcnt(2)
    v_mfma_f32_32x32x16_bf16 v[184:199], v[24:27], v[216:219], 0
    ds_read_b128 v[228:231], v10 offset:3072
    s_waitcnt lgkmcnt(2)
    v_mfma_f32_32x32x16_bf16 v[200:215], v[24:27], v[220:223], 0
    ds_read_b128 v[216:219], v10 offset:4096
    s_waitcnt lgkmcnt(2)
    v_mfma_f32_32x32x16_bf16 v[184:199], v[28:31], v[224:227], v[184:199]
    ds_read_b128 v[220:223], v10 offset:5120
    s_waitcnt lgkmcnt(2)
    v_mfma_f32_32x32x16_bf16 v[200:215], v[28:31], v[228:231], v[200:215]
    ds_read_b128 v[224:227], v10 offset:6144
    s_mov_b32 s57, 524288
fw_135:
    ds_read_b32 v15, v13 offset:768
    s_waitcnt lgkmcnt(0)
    v_cmp_eq_u32 vcc, 0, v15
    s_cbranch_vccz fwe_136
    s_sub_u32 s57, s57, 1
    s_cbranch_scc0 fw_135
fwe_136:
    ds_read_b64_tr_b16 v[124:125], v5 offset:0
    ds_read_b64_tr_b16 v[126:127], v5 offset:1024
    ds_read_b64_tr_b16 v[128:129], v5 offset:5120
    ds_read_b64_tr_b16 v[130:131], v5 offset:6144
    ds_read_b64_tr_b16 v[132:133], v5 offset:10240
    ds_read_b64_tr_b16 v[134:135], v5 offset:11264
    ds_read_b64_tr_b16 v[136:137], v5 offset:15360
    ds_read_b64_tr_b16 v[138:139], v5 offset:16384
    ds_read_b64_tr_b16 v[140:141], v7 offset:4096
    ds_read_b64_tr_b16 v[142:143], v7 offset:9216
    ds_read_b64_tr_b16 v[144:145], v5 offset:20480
    ds_read_b64_tr_b16 v[146:147], v5 offset:21504
    ds_read_b64_tr_b16 v[148:149], v5 offset:25600
    ds_read_b64_tr_b16 v[150:151], v5 offset:26624
    s_waitcnt lgkmcnt(13)
    ds_read_b64_tr_b16 v[152:153], v5 offset:30720
    ds_read_b64_tr_b16 v[154:155], v5 offset:31744
    s_waitcnt lgkmcnt(13)
    ds_read_b64_tr_b16 v[156:157], v5 offset:35840
    ds_read_b64_tr_b16 v[158:159], v5 offset:36864
    s_waitcnt lgkmcnt(13)
    ds_read_b64_tr_b16 v[160:161], v7 offset:24576
    ds_read_b64_tr_b16 v[162:163], v7 offset:29696
    s_waitcnt lgkmcnt(13)
    ds_read_b64_tr_b16 v[164:165], v18 offset:0
    ds_read_b64_tr_b16 v[166:167], v18 offset:1024
    s_waitcnt lgkmcnt(13)
    ds_read_b64_tr_b16 v[168:169], v18 offset:5120
    ds_read_b64_tr_b16 v[170:171], v18 offset:6144
    s_waitcnt lgkmcnt(13)
    ds_read_b64_tr_b16 v[172:173], v18 offset:10240
    ds_read_b64_tr_b16 v[174:175], v18 offset:11264
    s_waitcnt lgkmcnt(13)
    ds_read_b64_tr_b16 v[176:177], v18 offset:15360
    ds_read_b64_tr_b16 v[178:179], v18 offset:16384
    s_waitcnt lgkmcnt(13)
    ds_read_b64_tr_b16 v[180:181], v19 offset:4096
    ds_read_b64_tr_b16 v[182:183], v19 offset:9216
    v_mfma_f32_32x32x16_bf16 v[184:199], v[32:35], v[216:219], v[184:199]
    s_waitcnt lgkmcnt(14)
    ds_read_b32 v14, v13 offset:656
    s_waitcnt lgkmcnt(14)
    ds_read_b128 v[228:231], v10 offset:7168
    v_mfma_f32_32x32x16_bf16 v[200:215], v[32:35], v[220:223], v[200:215]
    s_waitcnt lgkmcnt(13)
    ds_read_b64 v[216:217], v16 offset:8192
    ds_read_b64 v[218:219], v16 offset:8704
    v_mfma_f32_32x32x16_bf16 v[184:199], v[36:39], v[224:227], v[184:199]
    s_waitcnt lgkmcnt(13)
    ds_read_b64 v[220:221], v16 offset:8448
    ds_read_b64 v[222:223], v16 offset:8960
    s_waitcnt lgkmcnt(4)
    v_cmp_eq_u32 vcc, 0, v14
    v_mfma_f32_32x32x16_bf16 v[200:215], v[36:39], v[228:231], v[200:215]
    s_cbranch_vccnz fs_137
fr_138:
    ds_read_b128 v[224:227], v10 offset:10240
    s_waitcnt lgkmcnt(3)
    v_mfma_f32_32x32x16_bf16 v[184:199], v[40:43], v[216:219], v[184:199]
    ds_read_b128 v[228:231], v10 offset:11264
    s_waitcnt lgkmcnt(2)
    v_mfma_f32_32x32x16_bf16 v[200:215], v[40:43], v[220:223], v[200:215]
    ds_read_b128 v[216:219], v10 offset:12288
    s_waitcnt lgkmcnt(2)
    v_mfma_f32_32x32x16_bf16 v[184:199], v[44:47], v[224:227], v[184:199]
    ds_read_b128 v[220:223], v10 offset:13312
    s_waitcnt lgkmcnt(2)
    v_mfma_f32_32x32x16_bf16 v[200:215], v[44:47], v[228:231], v[200:215]
    ds_read_b128 v[224:227], v10 offset:14336
    s_waitcnt lgkmcnt(2)
    v_mfma_f32_32x32x16_bf16 v[184:199], v[48:51], v[216:219], v[184:199]
    ds_read_b128 v[228:231], v10 offset:15360
    s_waitcnt lgkmcnt(2)
    v_mfma_f32_32x32x16_bf16 v[200:215], v[48:51], v[220:223], v[200:215]
    ds_read_b128 v[216:219], v10 offset:16384
    s_waitcnt lgkmcnt(2)
    v_mfma_f32_32x32x16_bf16 v[184:199], v[52:55], v[224:227], v[184:199]
    ds_read_b32 v14, v13 offset:672
    ds_read_b128 v[220:223], v10 offset:17408
    s_waitcnt lgkmcnt(3)
    v_mfma_f32_32x32x16_bf16 v[200:215], v[52:55], v[228:231], v[200:215]
    ds_read_b64 v[224:225], v16 offset:18432
    ds_read_b64 v[226:227], v16 offset:18944
    s_waitcnt lgkmcnt(4)
    v_mfma_f32_32x32x16_bf16 v[184:199], v[56:59], v[216:219], v[184:199]
    ds_read_b64 v[228:229], v16 offset:18688
    ds_read_b64 v[230:231], v16 offset:19200
    s_waitcnt lgkmcnt(4)
    v_cmp_eq_u32 vcc, 0, v14
    v_mfma_f32_32x32x16_bf16 v[200:215], v[56:59], v[220:223], v[200:215]
    s_cbranch_vccnz fs_139
fr_140:
    ds_read_b128 v[216:219], v10 offset:20480
    s_waitcnt lgkmcnt(3)
    v_mfma_f32_32x32x16_bf16 v[184:199], v[60:63], v[224:227], v[184:199]
    ds_read_b128 v[220:223], v10 offset:21504
    s_waitcnt lgkmcnt(2)
    v_mfma_f32_32x32x16_bf16 v[200:215], v[60:63], v[228:231], v[200:215]
    ds_read_b128 v[224:227], v10 offset:22528
    s_waitcnt lgkmcnt(2)
    v_mfma_f32_32x32x16_bf16 v[184:199], v[64:67], v[216:219], v[184:199]
    ds_read_b128 v[228:231], v10 offset:23552
    s_waitcnt lgkmcnt(2)
    v_mfma_f32_32x32x16_bf16 v[200:215], v[64:67], v[220:223], v[200:215]
    ds_read_b128 v[216:219], v10 offset:24576
    s_waitcnt lgkmcnt(2)
    v_mfma_f32_32x32x16_bf16 v[184:199], v[68:71], v[224:227], v[184:199]
    ds_read_b128 v[220:223], v10 offset:25600
    s_waitcnt lgkmcnt(2)
    v_mfma_f32_32x32x16_bf16 v[200:215], v[68:71], v[228:231], v[200:215]
    ds_read_b128 v[224:227], v10 offset:26624
    s_waitcnt lgkmcnt(2)
    v_mfma_f32_32x32x16_bf16 v[184:199], v[72:75], v[216:219], v[184:199]
    ds_read_b32 v14, v13 offset:688
    ds_read_b128 v[228:231], v10 offset:27648
    s_waitcnt lgkmcnt(3)
    v_mfma_f32_32x32x16_bf16 v[200:215], v[72:75], v[220:223], v[200:215]
    ds_read_b64 v[216:217], v16 offset:28672
    ds_read_b64 v[218:219], v16 offset:29184
    s_waitcnt lgkmcnt(4)
    v_mfma_f32_32x32x16_bf16 v[184:199], v[76:79], v[224:227], v[184:199]
    ds_read_b64 v[220:221], v16 offset:28928
    ds_read_b64 v[222:223], v16 offset:29440
    s_waitcnt lgkmcnt(4)
    v_cmp_eq_u32 vcc, 0, v14
    v_mfma_f32_32x32x16_bf16 v[200:215], v[76:79], v[228:231], v[200:215]
    s_cbranch_vccnz fs_141
fr_142:
    ds_read_b128 v[224:227], v10 offset:30720
    s_waitcnt lgkmcnt(3)
    v_mfma_f32_32x32x16_bf16 v[184:199], v[80:83], v[216:219], v[184:199]
    ds_read_b128 v[228:231], v10 offset:31744
    s_waitcnt lgkmcnt(2)
    v_mfma_f32_32x32x16_bf16 v[200:215], v[80:83], v[220:223], v[200:215]
    ds_read_b128 v[216:219], v10 offset:32768
    s_waitcnt lgkmcnt(2)
    v_mfma_f32_32x32x16_bf16 v[184:199], v[84:87], v[224:227], v[184:199]
    ds_read_b128 v[220:223], v10 offset:33792
    s_waitcnt lgkmcnt(2)
    v_mfma_f32_32x32x16_bf16 v[200:215], v[84:87], v[228:231], v[200:215]
    ds_read_b128 v[224:227], v10 offset:34816
    s_waitcnt lgkmcnt(2)
    v_mfma_f32_32x32x16_bf16 v[184:199], v[88:91], v[216:219], v[184:199]
    ds_read_b128 v[228:231], v10 offset:35840
    s_waitcnt lgkmcnt(2)
    v_mfma_f32_32x32x16_bf16 v[200:215], v[88:91], v[220:223], v[200:215]
    ds_read_b128 v[216:219], v10 offset:36864
    s_waitcnt lgkmcnt(2)
    v_mfma_f32_32x32x16_bf16 v[184:199], v[92:95], v[224:227], v[184:199]
    ds_read_b32 v14, v13 offset:704
    ds_read_b128 v[220:223], v10 offset:37888
    s_waitcnt lgkmcnt(3)
    v_mfma_f32_32x32x16_bf16 v[200:215], v[92:95], v[228:231], v[200:215]
    ds_read_b64 v[224:225], v16 offset:38912
    ds_read_b64 v[226:227], v16 offset:39424
    s_waitcnt lgkmcnt(4)
    v_mfma_f32_32x32x16_bf16 v[184:199], v[96:99], v[216:219], v[184:199]
    ds_read_b64 v[228:229], v16 offset:39168
    ds_read_b64 v[230:231], v16 offset:39680
    s_waitcnt lgkmcnt(4)
    v_cmp_eq_u32 vcc, 0, v14
    v_mfma_f32_32x32x16_bf16 v[200:215], v[96:99], v[220:223], v[200:215]
    s_cbranch_vccnz fs_143
fr_144:
    ds_read_b128 v[216:219], v11 offset:0
    s_waitcnt lgkmcnt(3)
    v_mfma_f32_32x32x16_bf16 v[184:199], v[100:103], v[224:227], v[184:199]
    ds_read_b128 v[220:223], v11 offset:1024
    s_waitcnt lgkmcnt(2)
    v_mfma_f32_32x32x16_bf16 v[200:215], v[100:103], v[228:231], v[200:215]
    ds_read_b128 v[224:227], v11 offset:2048
    s_waitcnt lgkmcnt(2)
    v_mfma_f32_32x32x16_bf16 v[184:199], v[104:107], v[216:219], v[184:199]
    ds_read_b128 v[228:231], v11 offset:3072
    s_waitcnt lgkmcnt(2)
    v_mfma_f32_32x32x16_bf16 v[200:215], v[104:107], v[220:223], v[200:215]
    ds_read_b128 v[216:219], v11 offset:4096
    s_waitcnt lgkmcnt(2)
    v_mfma_f32_32x32x16_bf16 v[184:199], v[108:111], v[224:227], v[184:199]
    ds_read_b128 v[220:223], v11 offset:5120
    v_lshlrev_b32 v56, 16, v240
    v_and_b32 v57, s31, v240
    s_waitcnt lgkmcnt(2)
    v_mfma_f32_32x32x16_bf16 v[200:215], v[108:111], v[228:231], v[200:215]
    ds_read_b128 v[224:227], v11 offset:6144
    v_lshlrev_b32 v58, 16, v241
    v_and_b32 v59, s31, v241
    s_waitcnt lgkmcnt(2)
    v_mfma_f32_32x32x16_bf16 v[184:199], v[112:115], v[216:219], v[184:199]
    ds_read_b32 v14, v13 offset:720
    ds_read_b128 v[228:231], v11 offset:7168
    v_lshlrev_b32 v60, 16, v242
    v_and_b32 v61, s31, v242
    s_waitcnt lgkmcnt(3)
    v_mfma_f32_32x32x16_bf16 v[200:215], v[112:115], v[220:223], v[200:215]
    ds_read_b64 v[216:217], v17 offset:8192
    ds_read_b64 v[218:219], v17 offset:8704
    v_lshlrev_b32 v62, 16, v243
    v_and_b32 v63, s31, v243
    s_waitcnt lgkmcnt(4)
    v_mfma_f32_32x32x16_bf16 v[184:199], v[116:119], v[224:227], v[184:199]
    ds_read_b64 v[220:221], v17 offset:8448
    ds_read_b64 v[222:223], v17 offset:8960
    v_lshlrev_b32 v64, 16, v244
    v_and_b32 v65, s31, v244
    s_waitcnt lgkmcnt(4)
    v_cmp_eq_u32 vcc, 0, v14
    v_mfma_f32_32x32x16_bf16 v[200:215], v[116:119], v[228:231], v[200:215]
    s_cbranch_vccnz fs_145
fr_146:
    ds_read_b128 v[224:227], v11 offset:10240
    v_lshlrev_b32 v66, 16, v245
    v_and_b32 v67, s31, v245
    s_waitcnt lgkmcnt(3)
    v_mfma_f32_32x32x16_bf16 v[184:199], v[120:123], v[216:219], v[184:199]
    ds_read_b128 v[228:231], v11 offset:11264
    v_lshlrev_b32 v68, 16, v246
    v_and_b32 v69, s31, v246
    s_waitcnt lgkmcnt(2)
    v_mfma_f32_32x32x16_bf16 v[200:215], v[120:123], v[220:223], v[200:215]
    ds_read_b128 v[216:219], v11 offset:12288
    v_lshlrev_b32 v70, 16, v247
    v_and_b32 v71, s31, v247
    s_waitcnt lgkmcnt(2)
    v_mfma_f32_32x32x16_bf16 v[184:199], v[124:127], v[224:227], v[184:199]
    ds_read_b128 v[220:223], v11 offset:13312
    v_lshlrev_b32 v72, 16, v248
    v_and_b32 v73, s31, v248
    s_waitcnt lgkmcnt(2)
    v_mfma_f32_32x32x16_bf16 v[200:215], v[124:127], v[228:231], v[200:215]
    ds_read_b128 v[224:227], v11 offset:14336
    v_lshlrev_b32 v74, 16, v249
    v_and_b32 v75, s31, v249
    s_waitcnt lgkmcnt(2)
    v_mfma_f32_32x32x16_bf16 v[184:199], v[128:131], v[216:219], v[184:199]
    ds_read_b128 v[228:231], v11 offset:15360
    v_lshlrev_b32 v76, 16, v250
    v_and_b32 v77, s31, v250
    s_waitcnt lgkmcnt(2)
    v_mfma_f32_32x32x16_bf16 v[200:215], v[128:131], v[220:223], v[200:215]
    ds_read_b128 v[216:219], v11 offset:16384
    v_lshlrev_b32 v78, 16, v251
    v_and_b32 v79, s31, v251
    s_waitcnt lgkmcnt(2)
    v_mfma_f32_32x32x16_bf16 v[184:199], v[132:135], v[224:227], v[184:199]
    ds_read_b32 v14, v13 offset:736
    ds_read_b128 v[220:223], v11 offset:17408
    v_lshlrev_b32 v80, 16, v252
    v_and_b32 v81, s31, v252
    s_waitcnt lgkmcnt(3)
    v_mfma_f32_32x32x16_bf16 v[200:215], v[132:135], v[228:231], v[200:215]
    ds_read_b64 v[224:225], v17 offset:18432
    ds_read_b64 v[226:227], v17 offset:18944
    v_lshlrev_b32 v82, 16, v253
    v_and_b32 v83, s31, v253
    s_waitcnt lgkmcnt(4)
    v_mfma_f32_32x32x16_bf16 v[184:199], v[136:139], v[216:219], v[184:199]
    ds_read_b64 v[228:229], v17 offset:18688
    ds_read_b64 v[230:231], v17 offset:19200
    v_lshlrev_b32 v84, 16, v254
    v_and_b32 v85, s31, v254
    s_waitcnt lgkmcnt(4)
    v_cmp_eq_u32 vcc, 0, v14
    v_mfma_f32_32x32x16_bf16 v[200:215], v[136:139], v[220:223], v[200:215]
    s_cbranch_vccnz fs_147
fr_148:
    ds_read_b128 v[216:219], v11 offset:20480
    v_lshlrev_b32 v86, 16, v255
    v_and_b32 v87, s31, v255
    s_waitcnt lgkmcnt(3)
    v_mfma_f32_32x32x16_bf16 v[184:199], v[140:143], v[224:227], v[184:199]
    ds_read_b128 v[220:223], v11 offset:21504
    v_mov_b32 v44, 0
    s_waitcnt lgkmcnt(2)
    v_mfma_f32_32x32x16_bf16 v[200:215], v[140:143], v[228:231], v[200:215]
    ds_read_b128 v[224:227], v11 offset:22528
    v_mov_b32 v45, 0
    s_waitcnt lgkmcnt(2)
    v_mfma_f32_32x32x16_bf16 v[184:199], v[144:147], v[216:219], v[184:199]
    ds_read_b128 v[228:231], v11 offset:23552
    v_mov_b32 v46, 0
    s_waitcnt lgkmcnt(2)
    v_mfma_f32_32x32x16_bf16 v[200:215], v[144:147], v[220:223], v[200:215]
    ds_read_b32 v14, v13 offset:752
    ds_read_b128 v[216:219], v11 offset:24576
    v_mov_b32 v47, 0
    s_waitcnt lgkmcnt(3)
    v_mfma_f32_32x32x16_bf16 v[184:199], v[148:151], v[224:227], v[184:199]
    ds_read_b128 v[220:223], v11 offset:26624
    v_mov_b32 v48, 0
    s_waitcnt lgkmcnt(3)
    v_mfma_f32_32x32x16_bf16 v[200:215], v[148:151], v[228:231], v[200:215]
    ds_read_b64 v[224:225], v17 offset:28672
    ds_read_b64 v[226:227], v17 offset:29184
    v_mov_b32 v49, 0
    s_waitcnt lgkmcnt(3)
    v_cmp_eq_u32 vcc, 0, v14
    v_mfma_f32_32x32x16_bf16 v[184:199], v[152:155], v[216:219], v[184:199]
    s_cbranch_vccnz fs_149
fr_150:
    ds_read_b128 v[228:231], v11 offset:30720
    s_waitcnt lgkmcnt(3)
    v_mfma_f32_32x32x16_bf16 v[184:199], v[156:159], v[220:223], v[184:199]
    ds_read_b128 v[216:219], v11 offset:32768
    s_waitcnt lgkmcnt(2)
    v_mfma_f32_32x32x16_bf16 v[184:199], v[160:163], v[224:227], v[184:199]
    ds_read_b128 v[220:223], v11 offset:34816
    s_waitcnt lgkmcnt(2)
    v_mfma_f32_32x32x16_bf16 v[184:199], v[164:167], v[228:231], v[184:199]
    ds_read_b128 v[224:227], v11 offset:36864
    s_waitcnt lgkmcnt(2)
    v_mfma_f32_32x32x16_bf16 v[184:199], v[168:171], v[216:219], v[184:199]
    ds_read_b64 v[228:229], v17 offset:38912
    ds_read_b64 v[230:231], v17 offset:39424
    s_waitcnt lgkmcnt(3)
    v_mfma_f32_32x32x16_bf16 v[184:199], v[172:175], v[220:223], v[184:199]
    ds_read_b128 v[216:219], v11 offset:25600
    s_waitcnt lgkmcnt(3)
    v_mfma_f32_32x32x16_bf16 v[184:199], v[176:179], v[224:227], v[184:199]
    ds_read_b128 v[220:223], v11 offset:27648
    s_waitcnt lgkmcnt(2)
    v_mfma_f32_32x32x16_bf16 v[184:199], v[180:183], v[228:231], v[184:199]
    ds_read_b64 v[224:225], v17 offset:28928
    ds_read_b64 v[226:227], v17 offset:29440
    s_waitcnt lgkmcnt(3)
    v_mfma_f32_32x32x16_bf16 v[200:215], v[152:155], v[216:219], v[200:215]
    ds_read_b128 v[228:231], v11 offset:31744
    s_waitcnt lgkmcnt(3)
    v_mfma_f32_32x32x16_bf16 v[200:215], v[156:159], v[220:223], v[200:215]
    ds_read_b128 v[216:219], v11 offset:33792
    s_nop 3
    v_cvt_pk_bf16_f32 v184, 0, v184
    v_cvt_pk_bf16_f32 v185, 0, v185
    v_cvt_pk_bf16_f32 v186, 0, v186
    v_cvt_pk_bf16_f32 v187, 0, v187
    v_cvt_pk_bf16_f32 v188, 0, v188
    v_cvt_pk_bf16_f32 v189, 0, v189
    s_waitcnt lgkmcnt(2)
    v_mfma_f32_32x32x16_bf16 v[200:215], v[160:163], v[224:227], v[200:215]
    ds_read_b128 v[220:223], v11 offset:35840
    s_nop 0
    v_cvt_pk_bf16_f32 v190, 0, v190
    v_cvt_pk_bf16_f32 v191, 0, v191
    v_cvt_pk_bf16_f32 v192, 0, v192
    v_cvt_pk_bf16_f32 v193, 0, v193
    v_cvt_pk_bf16_f32 v194, 0, v194
    v_cvt_pk_bf16_f32 v195, 0, v195
    s_waitcnt lgkmcnt(2)
    v_mfma_f32_32x32x16_bf16 v[200:215], v[164:167], v[228:231], v[200:215]
    ds_read_b128 v[224:227], v11 offset:37888
    v_cvt_pk_bf16_f32 v196, 0, v196
    v_cvt_pk_bf16_f32 v197, 0, v197
    v_cvt_pk_bf16_f32 v198, 0, v198
    v_cvt_pk_bf16_f32 v199, 0, v199
    v_add_f32 v184, v184, v56
    v_add_f32 v185, v185, v57
    s_waitcnt lgkmcnt(2)
    v_mfma_f32_32x32x16_bf16 v[200:215], v[168:171], v[216:219], v[200:215]
    ds_read_b64 v[228:229], v17 offset:39168
    ds_read_b64 v[230:231], v17 offset:39680
    v_add_f32 v186, v186, v58
    v_add_f32 v187, v187, v59
    v_add_f32 v188, v188, v60
    v_add_f32 v189, v189, v61
    v_add_f32 v190, v190, v62
    v_add_f32 v191, v191, v63
    s_waitcnt lgkmcnt(3)
    v_mfma_f32_32x32x16_bf16 v[200:215], v[172:175], v[220:223], v[200:215]
    v_add_f32 v192, v192, v64
    v_add_f32 v193, v193, v65
    v_add_f32 v194, v194, v66
    v_add_f32 v195, v195, v67
    v_add_f32 v196, v196, v68
    v_add_f32 v197, v197, v69
    s_waitcnt lgkmcnt(2)
    v_mfma_f32_32x32x16_bf16 v[200:215], v[176:179], v[224:227], v[200:215]
    v_add_f32 v198, v198, v70
    v_add_f32 v199, v199, v71
    v_cvt_pk_bf16_f32 v24, v184, v185
    v_cvt_pk_bf16_f32 v25, v186, v187
    v_cvt_pk_bf16_f32 v26, v188, v189
    v_cvt_pk_bf16_f32 v27, v190, v191
    s_waitcnt lgkmcnt(0)
    v_mfma_f32_32x32x16_bf16 v[200:215], v[180:183], v[228:231], v[200:215]
    v_cvt_pk_bf16_f32 v28, v192, v193
    v_cvt_pk_bf16_f32 v29, v194, v195
    v_cvt_pk_bf16_f32 v30, v196, v197
    v_cvt_pk_bf16_f32 v31, v198, v199
    v_dot2c_f32_bf16 v44, s66, v24
    v_dot2c_f32_bf16 v45, v24, v24
    v_dot2c_f32_bf16 v46, v232, v24
    v_dot2c_f32_bf16 v44, s66, v25
    v_dot2c_f32_bf16 v45, v25, v25
    v_dot2c_f32_bf16 v46, v233, v25
    v_dot2c_f32_bf16 v44, s66, v26
    v_dot2c_f32_bf16 v45, v26, v26
    v_dot2c_f32_bf16 v46, v234, v26
    v_dot2c_f32_bf16 v44, s66, v27
    v_dot2c_f32_bf16 v45, v27, v27
    v_dot2c_f32_bf16 v46, v235, v27
    v_dot2c_f32_bf16 v44, s66, v28
    v_dot2c_f32_bf16 v45, v28, v28
    v_dot2c_f32_bf16 v46, v236, v28
    v_dot2c_f32_bf16 v44, s66, v29
    v_dot2c_f32_bf16 v45, v29, v29
    v_dot2c_f32_bf16 v46, v237, v29
    v_dot2c_f32_bf16 v44, s66, v30
    v_dot2c_f32_bf16 v45, v30, v30
    v_dot2c_f32_bf16 v46, v238, v30
    v_dot2c_f32_bf16 v44, s66, v31
    v_dot2c_f32_bf16 v45, v31, v31
    v_dot2c_f32_bf16_e64 v46, v239, v31
    v_cvt_pk_bf16_f32 v200, 0, v200
    v_cvt_pk_bf16_f32 v201, 0, v201
    v_cvt_pk_bf16_f32 v202, 0, v202
    v_cvt_pk_bf16_f32 v203, 0, v203
    v_cvt_pk_bf16_f32 v204, 0, v204
    v_cvt_pk_bf16_f32 v205, 0, v205
    v_cvt_pk_bf16_f32 v206, 0, v206
    v_cvt_pk_bf16_f32 v207, 0, v207
    v_cvt_pk_bf16_f32 v208, 0, v208
    v_cvt_pk_bf16_f32 v209, 0, v209
    v_cvt_pk_bf16_f32 v210, 0, v210
    v_cvt_pk_bf16_f32 v211, 0, v211
    v_cvt_pk_bf16_f32 v212, 0, v212
    v_cvt_pk_bf16_f32 v213, 0, v213
    v_cvt_pk_bf16_f32 v214, 0, v214
    v_cvt_pk_bf16_f32 v215, 0, v215
    v_pk_add_f32 v[200:201], v[200:201], v[72:73]
    v_pk_add_f32 v[202:203], v[202:203], v[74:75]
    v_pk_add_f32 v[204:205], v[204:205], v[76:77]
    v_pk_add_f32 v[206:207], v[206:207], v[78:79]
    v_pk_add_f32 v[208:209], v[208:209], v[80:81]
    v_pk_add_f32 v[210:211], v[210:211], v[82:83]
    v_pk_add_f32 v[212:213], v[212:213], v[84:85]
    v_pk_add_f32 v[214:215], v[214:215], v[86:87]
    v_cvt_pk_bf16_f32 v32, v200, v201
    v_cvt_pk_bf16_f32 v33, v202, v203
    v_cvt_pk_bf16_f32 v34, v204, v205
    v_cvt_pk_bf16_f32 v35, v206, v207
    v_cvt_pk_bf16_f32 v36, v208, v209
    v_cvt_pk_bf16_f32 v37, v210, v211
    v_cvt_pk_bf16_f32 v38, v212, v213
    v_cvt_pk_bf16_f32 v39, v214, v215
    v_dot2c_f32_bf16 v47, s66, v32
    v_dot2c_f32_bf16 v48, v32, v32
    v_dot2c_f32_bf16 v49, v232, v32
    v_dot2c_f32_bf16 v47, s66, v33
    v_dot2c_f32_bf16 v48, v33, v33
    v_dot2c_f32_bf16 v49, v233, v33
    v_dot2c_f32_bf16 v47, s66, v34
    v_dot2c_f32_bf16 v48, v34, v34
    v_dot2c_f32_bf16 v49, v234, v34
    v_dot2c_f32_bf16 v47, s66, v35
    v_dot2c_f32_bf16 v48, v35, v35
    v_dot2c_f32_bf16 v49, v235, v35
    v_dot2c_f32_bf16 v47, s66, v36
    v_dot2c_f32_bf16 v48, v36, v36
    v_dot2c_f32_bf16 v49, v236, v36
    v_dot2c_f32_bf16 v47, s66, v37
    v_dot2c_f32_bf16 v48, v37, v37
    v_dot2c_f32_bf16 v49, v237, v37
    v_dot2c_f32_bf16 v47, s66, v38
    v_dot2c_f32_bf16 v48, v38, v38
    v_dot2c_f32_bf16 v49, v238, v38
    v_dot2c_f32_bf16 v47, s66, v39
    v_dot2c_f32_bf16 v48, v39, v39
    v_dot2c_f32_bf16 v49, v239, v39
    s_nop 0
    v_permlane32_swap_b32 v44, v47
    v_permlane32_swap_b32 v45, v48
    v_permlane32_swap_b32 v46, v49
    v_add_f32 v44, v44, v47
    v_add_f32 v45, v45, v48
    v_add_f32 v46, v46, v49
    ds_write_b96 v4, v[44:46]
    s_waitcnt lgkmcnt(0)
    s_setprio 0
    s_barrier
    v_and_b32 v14, 31, v1
    v_lshrrev_b32_e64 v15, 5, v1
    s_lshl_b32 s58, s6, 2
    v_lshl_add_u32 v15, v15, 1, s58
    v_and_b32 v16, 7, v1
    v_xor_b32 v15, v15, v16
    v_lshlrev_b32_e64 v15, 4, v15
    v_lshl_add_u32 v14, v14, 8, v15
    v_add_u32 v14, 81920, v14
    v_xor_b32 v15, 16, v14
    ds_write_b128 v14, v[24:27] offset:0
    ds_write_b128 v15, v[28:31] offset:0
    ds_write_b128 v14, v[32:35] offset:8192
    ds_write_b128 v15, v[36:39] offset:8192
    s_waitcnt lgkmcnt(0)
    s_branch L_B_join
fs_137:
    s_mov_b32 s57, 524288
fw_151:
    ds_read_b32 v14, v13 offset:656
    s_waitcnt lgkmcnt(0)
    v_cmp_eq_u32 vcc, 0, v14
    s_cbranch_vccz fwe_152
    s_sub_u32 s57, s57, 1
    s_cbranch_scc0 fw_151
fwe_152:
    s_branch fr_138
fs_139:
    s_mov_b32 s57, 524288
fw_153:
    ds_read_b32 v14, v13 offset:672
    s_waitcnt lgkmcnt(0)
    v_cmp_eq_u32 vcc, 0, v14
    s_cbranch_vccz fwe_154
    s_sub_u32 s57, s57, 1
    s_cbranch_scc0 fw_153
fwe_154:
    s_branch fr_140
fs_141:
    s_mov_b32 s57, 524288
fw_155:
    ds_read_b32 v14, v13 offset:688
    s_waitcnt lgkmcnt(0)
    v_cmp_eq_u32 vcc, 0, v14
    s_cbranch_vccz fwe_156
    s_sub_u32 s57, s57, 1
    s_cbranch_scc0 fw_155
fwe_156:
    s_branch fr_142
fs_143:
    s_mov_b32 s57, 524288
fw_157:
    ds_read_b32 v14, v13 offset:704
    s_waitcnt lgkmcnt(0)
    v_cmp_eq_u32 vcc, 0, v14
    s_cbranch_vccz fwe_158
    s_sub_u32 s57, s57, 1
    s_cbranch_scc0 fw_157
fwe_158:
    s_branch fr_144
fs_145:
    s_mov_b32 s57, 524288
fw_159:
    ds_read_b32 v14, v13 offset:720
    s_waitcnt lgkmcnt(0)
    v_cmp_eq_u32 vcc, 0, v14
    s_cbranch_vccz fwe_160
    s_sub_u32 s57, s57, 1
    s_cbranch_scc0 fw_159
fwe_160:
    s_branch fr_146
fs_147:
    s_mov_b32 s57, 524288
fw_161:
    ds_read_b32 v14, v13 offset:736
    s_waitcnt lgkmcnt(0)
    v_cmp_eq_u32 vcc, 0, v14
    s_cbranch_vccz fwe_162
    s_sub_u32 s57, s57, 1
    s_cbranch_scc0 fw_161
fwe_162:
    s_branch fr_148
fs_149:
    s_mov_b32 s57, 524288
fw_163:
    ds_read_b32 v14, v13 offset:752
    s_waitcnt lgkmcnt(0)
    v_cmp_eq_u32 vcc, 0, v14
    s_cbranch_vccz fwe_164
    s_sub_u32 s57, s57, 1
    s_cbranch_scc0 fw_163
fwe_164:
    s_branch fr_150
    .p2align 12
pg_165:
L_G_aux:
    v_mov_b32 v254, 0
    v_dot2c_f32_bf16 v254, v240, v240
    v_dot2c_f32_bf16 v254, v241, v241
    v_dot2c_f32_bf16 v254, v242, v242
    v_dot2c_f32_bf16 v254, v243, v243
    v_dot2c_f32_bf16_e64 v254, v244, v244
    s_nop 2
    v_add_f32_dpp v254, v254, v254 row_ror:1 row_mask:0xf bank_mask:0xf
    s_nop 1
    v_add_f32_dpp v254, v254, v254 row_ror:2 row_mask:0xf bank_mask:0xf
    s_nop 1
    v_add_f32_dpp v254, v254, v254 row_ror:4 row_mask:0xf bank_mask:0xf
    s_nop 1
    v_add_f32_dpp v254, v254, v254 row_ror:8 row_mask:0xf bank_mask:0xf
    v_mov_b32 v18, v254
    s_nop 1
    v_permlane16_swap_b32 v254, v18
    v_add_f32 v254, v254, v18
    v_mov_b32 v18, v254
    s_nop 1
    v_permlane32_swap_b32 v254, v18
    v_add_f32 v254, v254, v18
    v_sqrt_f32_e64 v254, v254
    s_nop 0
    v_mul_f32 v254, 0x3c800000, v254
L_aux:
    s_cmp_ge_u32 s70, 48
    s_cbranch_scc1 L_red
    s_mov_b32 s20, s44
    s_and_b32 s21, s45, 0xffff
    s_mov_b32 s22, 1966080
    s_mov_b32 s23, 0x20000
    s_mov_b32 s24, s46
    s_and_b32 s25, s47, 0xffff
    s_mov_b32 s26, 1966080
    s_mov_b32 s27, 0x20000
    s_mov_b32 s8, s48
    s_and_b32 s9, s49, 0xffff
    s_mov_b32 s10, 1966080
    s_mov_b32 s11, 0x20000
    v_lshrrev_b32 v14, 2, v1
    v_mul_u32_u24 v14, 3072, v14
    v_and_b32_e64 v15, 3, v1
    v_lshl_add_u32 v4, v15, 4, v14
    v_lshlrev_b32 v5, 4, v1
    s_lshl_b32 s67, s70, 6
    s_and_b32 s69, s70, 1
    s_lshl_b32 s69, s69, 4
    s_or_b32 s69, s69, s5
    s_mul_i32 s62, s5, 5120
    s_mul_i32 s68, s70, 40960
    s_add_u32 s68, s68, s62
    s_cmp_lt_u32 s5, 4
    s_cbranch_scc1 L_noyp
    v_mov_b32 v24, -1
    v_mov_b32 v25, -1
    v_mov_b32 v26, -1
    v_mov_b32 v27, -1
    s_mul_i32 s58, s6, 122880
    s_add_u32 s58, s58, s67
    s_add_u32 s58, s58, 7278592
    buffer_store_dwordx4 v[24:27], v4, s[16:19], s58 offen sc1
    s_add_u32 s58, s58, 49152
    buffer_store_dwordx4 v[24:27], v4, s[16:19], s58 offen sc1
    s_add_u32 s58, s58, 24576
    buffer_store_dwordx4 v[24:27], v4, s[16:19], s58 offen sc1
    s_add_u32 s58, s58, 0
L_noyp:
    v_lshrrev_b32 v16, 5, v1
    v_lshlrev_b32 v16, 5, v16
    v_xor_b32 v4, v4, v16
    s_barrier
    s_setprio 0
    s_xor_b32 s59, s69, 0
    s_mul_i32 s58, s59, 49152
    s_add_u32 s58, s58, s67
    s_lshl_b32 s59, s59, 10
    s_add_u32 m0, s59, 0
    s_nop 0
    buffer_load_dwordx4 v4, s[20:23], s58 offen lds
    s_add_u32 m0, s59, 40976
    s_nop 0
    buffer_load_dwordx4 v4, s[24:27], s58 offen lds
    s_xor_b32 s59, s69, 8
    s_mul_i32 s58, s59, 49152
    s_add_u32 s58, s58, s67
    s_lshl_b32 s59, s59, 10
    s_add_u32 m0, s59, 0
    s_nop 0
    buffer_load_dwordx4 v4, s[20:23], s58 offen lds
    s_add_u32 m0, s59, 40976
    s_nop 0
    buffer_load_dwordx4 v4, s[24:27], s58 offen lds
    s_xor_b32 s59, s69, 16
    s_mul_i32 s58, s59, 49152
    s_add_u32 s58, s58, s67
    s_lshl_b32 s59, s59, 10
    s_add_u32 m0, s59, 0
    s_nop 0
    buffer_load_dwordx4 v4, s[20:23], s58 offen lds
    s_add_u32 m0, s59, 40976
    s_nop 0
    buffer_load_dwordx4 v4, s[24:27], s58 offen lds
    s_xor_b32 s59, s69, 24
    s_mul_i32 s58, s59, 49152
    s_add_u32 s58, s58, s67
    s_lshl_b32 s59, s59, 10
    s_add_u32 m0, s59, 0
    s_nop 0
    buffer_load_dwordx4 v4, s[20:23], s58 offen lds
    s_add_u32 m0, s59, 40976
    s_nop 0
    buffer_load_dwordx4 v4, s[24:27], s58 offen lds
    s_add_u32 s59, s5, 32
    s_mul_i32 s58, s59, 49152
    s_add_u32 s58, s58, s67
    s_lshl_b32 s59, s59, 10
    s_add_u32 m0, s59, 0
    s_nop 0
    buffer_load_dwordx4 v4, s[20:23], s58 offen lds
    s_add_u32 m0, s59, 40976
    s_nop 0
    buffer_load_dwordx4 v4, s[24:27], s58 offen lds
    v_add_u32 v16, 0, v1
    v_mul_u32_u24 v17, 820, v16
    v_lshrrev_b32 v17, 16, v17
    v_lshlrev_b32 v17, 2, v17
    v_xor_b32 v16, v16, v17
    v_lshlrev_b32 v16, 4, v16
    s_add_u32 m0, s62, 81952
    s_nop 0
    buffer_load_dwordx4 v16, s[8:11], s68 offen lds
    v_add_u32 v16, 64, v1
    v_mul_u32_u24 v17, 820, v16
    v_lshrrev_b32 v17, 16, v17
    v_lshlrev_b32 v17, 2, v17
    v_xor_b32 v16, v16, v17
    v_lshlrev_b32_e64 v16, 4, v16
    s_add_u32 m0, s62, 82976
    s_nop 0
    buffer_load_dwordx4 v16, s[8:11], s68 offen lds
    v_add_u32 v16, 128, v1
    v_mul_u32_u24 v17, 820, v16
    v_lshrrev_b32 v17, 16, v17
    v_lshlrev_b32 v17, 2, v17
    v_xor_b32 v16, v16, v17
    v_lshlrev_b32_e64 v16, 4, v16
    s_add_u32 m0, s62, 84000
    s_nop 0
    buffer_load_dwordx4 v16, s[8:11], s68 offen lds
    v_add_u32 v16, 192, v1
    v_mul_u32_u24 v17, 820, v16
    v_lshrrev_b32 v17, 16, v17
    v_lshlrev_b32 v17, 2, v17
    v_xor_b32 v16, v16, v17
    v_lshlrev_b32_e64 v16, 4, v16
    s_add_u32 m0, s62, 85024
    s_nop 0
    buffer_load_dwordx4 v16, s[8:11], s68 offen lds
    v_add_u32 v16, 256, v1
    v_mul_u32_u24 v17, 820, v16
    v_lshrrev_b32 v17, 16, v17
    v_lshlrev_b32 v17, 2, v17
    v_xor_b32 v16, v16, v17
    v_lshlrev_b32_e64 v16, 4, v16
    s_add_u32 m0, s62, 86048
    s_nop 0
    buffer_load_dwordx4 v16, s[8:11], s68 offen lds
    s_waitcnt vmcnt(0)
    s_barrier
    s_cmp_ge_u32 s5, 4
    s_cbranch_scc1 L_ffn_end
    v_bfe_u32 v14, v1, 2, 2
    v_lshl_add_u32 v16, v3, 3, v14
    v_lshlrev_b32 v6, 6, v16
    v_and_b32 v17, 1, v15
    v_mul_u32_u24 v17, 40976, v17
    v_lshrrev_b32 v18, 1, v15
    v_lshlrev_b32 v18, 3, v18
    v_add3_u32 v6, v6, v17, v18
    v_and_b32 v17, 1, v3
    v_lshlrev_b32 v17, 1, v17
    v_xor_b32_e64 v17, s6, v17
    v_lshl_add_u32 v6, v17, 4, v6
    v_mul_u32_u24 v16, 1280, v16
    v_lshl_add_u32 v16, v15, 4, v16
    v_xor_b32_e64 v17, s6, v14
    v_lshl_add_u32 v16, v17, 6, v16
    v_add_u32 v7, 81952, v16
    ds_read_b64_tr_b16 v[120:121], v6 offset:0
    ds_read_b64_tr_b16 v[122:123], v6 offset:256
    ds_read_b64_tr_b16 v[124:125], v6 offset:2048
    ds_read_b64_tr_b16 v[126:127], v6 offset:2304
    ds_read_b64_tr_b16 v[128:129], v6 offset:4096
    ds_read_b64_tr_b16 v[130:131], v6 offset:4352
    ds_read_b64_tr_b16 v[132:133], v6 offset:6144
    ds_read_b64_tr_b16 v[134:135], v6 offset:6400
    ds_read_b64_tr_b16 v[136:137], v6 offset:8192
    ds_read_b64_tr_b16 v[138:139], v6 offset:8448
    ds_read_b64_tr_b16 v[140:141], v6 offset:10240
    ds_read_b64_tr_b16 v[142:143], v6 offset:10496
    ds_read_b64_tr_b16 v[144:145], v6 offset:12288
    ds_read_b64_tr_b16 v[146:147], v6 offset:12544
    s_waitcnt lgkmcnt(13)
    ds_read_b64_tr_b16 v[148:149], v6 offset:14336
    ds_read_b64_tr_b16 v[150:151], v6 offset:14592
    s_waitcnt lgkmcnt(13)
    ds_read_b64_tr_b16 v[152:153], v6 offset:16384
    ds_read_b64_tr_b16 v[154:155], v6 offset:16640
    s_waitcnt lgkmcnt(13)
    ds_read_b64_tr_b16 v[156:157], v6 offset:18432
    ds_read_b64_tr_b16 v[158:159], v6 offset:18688
    s_waitcnt lgkmcnt(13)
    ds_read_b64_tr_b16 v[160:161], v6 offset:20480
    ds_read_b64_tr_b16 v[162:163], v6 offset:20736
    s_waitcnt lgkmcnt(13)
    ds_read_b64_tr_b16 v[164:165], v6 offset:22528
    ds_read_b64_tr_b16 v[166:167], v6 offset:22784
    s_waitcnt lgkmcnt(13)
    ds_read_b64_tr_b16 v[168:169], v6 offset:24576
    ds_read_b64_tr_b16 v[170:171], v6 offset:24832
    s_waitcnt lgkmcnt(13)
    ds_read_b64_tr_b16 v[172:173], v6 offset:26624
    ds_read_b64_tr_b16 v[174:175], v6 offset:26880
    s_waitcnt lgkmcnt(13)
    ds_read_b64_tr_b16 v[176:177], v6 offset:28672
    ds_read_b64_tr_b16 v[178:179], v6 offset:28928
    s_waitcnt lgkmcnt(13)
    ds_read_b64_tr_b16 v[180:181], v6 offset:30720
    ds_read_b64_tr_b16 v[182:183], v6 offset:30976
    s_waitcnt lgkmcnt(13)
    ds_read_b64_tr_b16 v[184:185], v6 offset:32768
    ds_read_b64_tr_b16 v[186:187], v6 offset:33024
    s_waitcnt lgkmcnt(13)
    ds_read_b64_tr_b16 v[188:189], v6 offset:34816
    ds_read_b64_tr_b16 v[190:191], v6 offset:35072
    s_waitcnt lgkmcnt(13)
    ds_read_b64_tr_b16 v[192:193], v6 offset:36864
    ds_read_b64_tr_b16 v[194:195], v6 offset:37120
    s_waitcnt lgkmcnt(13)
    ds_read_b64_tr_b16 v[196:197], v6 offset:38912
    ds_read_b64_tr_b16 v[198:199], v6 offset:39168
    s_waitcnt lgkmcnt(13)
    ds_read_b64_tr_b16 v[200:201], v7 offset:0
    ds_read_b64_tr_b16 v[202:203], v7 offset:5120
    s_waitcnt lgkmcnt(13)
    ds_read_b64_tr_b16 v[204:205], v7 offset:8
    ds_read_b64_tr_b16 v[206:207], v7 offset:5128
    s_waitcnt lgkmcnt(13)
    ds_read_b64_tr_b16 v[208:209], v7 offset:256
    ds_read_b64_tr_b16 v[210:211], v7 offset:5376
    s_waitcnt lgkmcnt(13)
    ds_read_b64_tr_b16 v[212:213], v7 offset:264
    ds_read_b64_tr_b16 v[214:215], v7 offset:5384
    s_waitcnt lgkmcnt(13)
    ds_read_b64_tr_b16 v[216:217], v7 offset:512
    ds_read_b64_tr_b16 v[218:219], v7 offset:5632
    s_waitcnt lgkmcnt(13)
    ds_read_b64_tr_b16 v[220:221], v7 offset:520
    ds_read_b64_tr_b16 v[222:223], v7 offset:5640
    s_waitcnt lgkmcnt(13)
    ds_read_b64_tr_b16 v[224:225], v7 offset:768
    ds_read_b64_tr_b16 v[226:227], v7 offset:5888
    s_waitcnt lgkmcnt(13)
    ds_read_b64_tr_b16 v[228:229], v7 offset:776
    ds_read_b64_tr_b16 v[230:231], v7 offset:5896
    s_waitcnt lgkmcnt(13)
    ds_read_b64_tr_b16 v[232:233], v7 offset:1024
    ds_read_b64_tr_b16 v[234:235], v7 offset:6144
    s_waitcnt lgkmcnt(13)
    ds_read_b64_tr_b16 v[236:237], v7 offset:1032
    ds_read_b64_tr_b16 v[238:239], v7 offset:6152
    v_and_b32 v14, 7, v1
    v_mul_u32_u24 v15, 1312, v14
    v_lshl_add_u32 v15, v3, 4, v15
    v_add_u32 v8, 122944, v15
    v_lshrrev_b32 v15, 5, v1
    v_lshlrev_b32 v15, 3, v15
    v_lshl_add_u32 v15, v14, 4, v15
    s_lshl_b32 s58, s6, 7
    s_add_u32 s58, s58, 143360
    v_add_u32 v9, s58, v15
    v_lshlrev_b32_e64 v15, 7, v3
    v_lshl_add_u32 v15, v14, 4, v15
    v_add_u32 v10, 143360, v15
    v_bfe_u32 v15, v1, 2, 1
    v_lshl_add_u32 v15, v3, 1, v15
    v_mul_u32_u24 v15, 3072, v15
    v_and_b32_e64 v16, 3, v1
    v_lshl_add_u32 v11, v16, 4, v15
    s_mul_i32 s58, s6, 24576
    s_add_u32 s67, s67, s58
    s_add_u32 s67, s67, 7278592
    s_add_u32 s40, s67, 0
    s_add_u32 s41, s67, 98304
    s_add_u32 s42, s67, 196608
    s_add_u32 s43, s67, 294912
    s_add_u32 s44, s67, 393216
    s_mov_b32 s72, 0x00ff00ff
    s_mov_b32 s73, 0x00ff00ff
    s_mov_b32 s74, 0xff
    s_mov_b32 s75, 0xff
    s_mul_i32 s58, s6, 2624
    s_add_u32 s58, s58, 122944
    v_add_u32_e64 v20, s58, v5
    v_mul_u32_u24 v15, 1312, v3
    v_lshl_add_u32 v21, v2, 4, v15
    v_add_u32_e64 v21, s58, v21
    s_lshl_b32 s60, s6, 1
    s_add_u32 s61, s60, 1
    v_cmp_eq_u32 s[62:63], 0, v3
    v_lshlrev_b32_e64 v22, 4, v2
    v_mov_b32 v23, 6623232
    s_movk_i32 s71, 1280
    s_lshl_b32 s56, s70, 7
    s_add_u32 s56, s56, 7770124
    s_cmp_eq_u32 s6, 0
    s_cselect_b32 s56, s56, 0x7ff00000
    v_mov_b32 v18, s28
    s_waitcnt lgkmcnt(0)
    v_lshrrev_b32 v14, 3, v1
    v_lshlrev_b32_e64 v14, 6, v14
    v_lshl_add_u32 v14, v1, 3, v14
    s_mov_b32 s58, 6619136
    v_mov_b32 v16, s28
    s_mov_b32 s30, 0
    buffer_load_dwordx2 v[100:101], v14, s[16:19], s58 offen offset:0 sc1
    buffer_load_dwordx2 v[102:103], v14, s[16:19], s58 offen offset:1024 sc1
    buffer_load_dwordx2 v[104:105], v14, s[16:19], s58 offen offset:2048 sc1
    buffer_load_dwordx2 v[106:107], v14, s[16:19], s58 offen offset:3072 sc1
    s_mov_b32 s57, 65536
ga_166:
    s_waitcnt vmcnt(0)
    v_xor_b32 v15, s28, v101
    v_bitop3_b32 v15, v15, v103, v16 bitop3:0xf6
    v_bitop3_b32 v15, v15, v105, v16 bitop3:0xf6
    v_bitop3_b32 v15, v15, v107, v16 bitop3:0xf6
    v_cmp_ne_u32 vcc, 0, v15
    s_cbranch_vccnz gr_167
gae_168:
km_169:
    v_max_u32_dpp v92, v102, v100 row_half_mirror row_mask:0xf bank_mask:0xf
    v_max_u32_dpp v94, v106, v104 row_half_mirror row_mask:0xf bank_mask:0xf
    s_nop 0
    v_max_u32_dpp v93, v92, v92 row_shl:4 row_mask:0xf bank_mask:0x5
    v_max_u32_dpp v95, v94, v94 row_shl:4 row_mask:0xf bank_mask:0x5
    s_nop 0
    v_min_u32_dpp v93, v92, v92 row_shr:4 row_mask:0xf bank_mask:0xa
    v_min_u32_dpp v95, v94, v94 row_shr:4 row_mask:0xf bank_mask:0xa
    s_nop 0
    v_mov_b32_dpp v92, v93 quad_perm:[2,3,0,1] row_mask:0xf bank_mask:0xf
    v_mov_b32_dpp v94, v95 quad_perm:[2,3,0,1] row_mask:0xf bank_mask:0xf
    v_med3_u32 v93, v93, v92, v249
    v_med3_u32 v95, v95, v94, v249
    s_nop 0
    v_mov_b32_dpp v92, v93 quad_perm:[1,0,3,2] row_mask:0xf bank_mask:0xf
    v_mov_b32_dpp v94, v95 quad_perm:[1,0,3,2] row_mask:0xf bank_mask:0xf
    v_med3_u32 v93, v93, v92, v248
    v_med3_u32 v95, v95, v94, v248
    s_nop 1
    v_max_u32_dpp v93, v95, v93 row_half_mirror row_mask:0xf bank_mask:0xf
    s_nop 1
    v_max_u32_dpp v92, v93, v93 row_shl:4 row_mask:0xf bank_mask:0x5
    s_nop 1
    v_min_u32_dpp v92, v93, v93 row_shr:4 row_mask:0xf bank_mask:0xa
    s_nop 1
    v_mov_b32_dpp v93, v92 quad_perm:[2,3,0,1] row_mask:0xf bank_mask:0xf
    v_med3_u32 v92, v92, v93, v249
    s_nop 1
    v_mov_b32_dpp v93, v92 quad_perm:[1,0,3,2] row_mask:0xf bank_mask:0xf
    v_med3_u32 v92, v92, v93, v248
    s_nop 1
    v_max_u32_dpp v92, v92, v92 row_mirror row_mask:0xf bank_mask:0xf
    s_nop 1
    v_max_u32_dpp v93, v92, v92 row_shl:4 row_mask:0xf bank_mask:0x5
    s_nop 1
    v_min_u32_dpp v93, v92, v92 row_shr:4 row_mask:0xf bank_mask:0xa
    s_nop 1
    v_mov_b32_dpp v92, v93 quad_perm:[2,3,0,1] row_mask:0xf bank_mask:0xf
    v_med3_u32 v93, v93, v92, v249
    s_nop 1
    v_mov_b32_dpp v92, v93 quad_perm:[1,0,3,2] row_mask:0xf bank_mask:0xf
    v_med3_u32 v93, v93, v92, v248
    v_mov_b32 v92, v93
    s_nop 1
    v_permlane16_swap_b32 v93, v92
    s_nop 1
    v_max_u32_dpp v93, v92, v93 row_half_mirror row_mask:0xf bank_mask:0xf
    s_nop 1
    v_mov_b32_dpp v92, v93 row_ror:4 row_mask:0xf bank_mask:0xf
    v_med3_u32 v93, v93, v92, v250
    s_nop 1
    v_mov_b32_dpp v92, v93 quad_perm:[2,3,0,1] row_mask:0xf bank_mask:0xf
    v_med3_u32 v93, v93, v92, v249
    s_nop 1
    v_mov_b32_dpp v92, v93 quad_perm:[1,0,3,2] row_mask:0xf bank_mask:0xf
    v_med3_u32 v93, v93, v92, v248
    v_mov_b32_e64 v92, v93
    s_nop 1
    v_permlane32_swap_b32 v93, v92
    s_nop 1
    v_max_u32_dpp v93, v92, v93 row_half_mirror row_mask:0xf bank_mask:0xf
    v_not_b32_e64 v15, v93
    v_bfe_u32 v15, v15, 9, 5
    v_and_b32_e64 v16, 7, v93
    v_lshl_add_u32 v15, v15, 3, v16
    v_mad_u32_u24 v15, v15, s71, v23
    s_nop 0
    v_readlane_b32 s68, v15, s60
    v_readlane_b32 s69, v15, s61
    s_nop 1
    v_add_u32 v16, s69, v22
    v_add_u32 v17, s68, v22
    v_cndmask_b32 v16, v16, v17, s[62:63]
    buffer_load_dwordx4 v[108:111], v5, s[16:19], s68 offen sc1
    buffer_load_dwordx4 v[112:115], v5, s[16:19], s69 offen sc1
    buffer_load_dwordx4 v[116:119], v16, s[16:19], 0 offen offset:1024 sc1
    s_cmp_lg_u32 s30, 0
    s_cbranch_scc1 rfe_171
    v_min_u32_dpp v96, v93, v93 quad_perm:[1,0,3,2] row_mask:0xf bank_mask:0xf
    s_nop 1
    v_min_u32_dpp v96, v96, v96 quad_perm:[2,3,0,1] row_mask:0xf bank_mask:0xf
    s_nop 1
    v_min_u32_dpp v96, v96, v96 row_half_mirror row_mask:0xf bank_mask:0xf
    v_and_b32 v97, 0xffffc000, v96
    v_or_b32 v97, 0x2000, v97
    v_ashrrev_i32 v98, 31, v97
    v_not_b32 v98, v98
    v_or_b32 v98, 0x80000000, v98
    v_xor_b32_e64 v97, v97, v98
    v_and_b32 v98, 0x7f800000, v97
    v_fmamk_f32 v98, v98, 0xbcc00000, v254
    v_sub_f32 v96, v97, v98
    v_ashrrev_i32 v99, 31, v96
    v_or_b32 v99, 0x80000000, v99
    v_xor_b32_e64 v96, v96, v99
    v_cmp_ge_u32 s[8:9], v100, v96
    s_bcnt1_i32_b64 s12, s[8:9]
    v_cmp_ge_u32 s[10:11], v102, v96
    s_bcnt1_i32_b64 s13, s[10:11]
    v_cmp_ge_u32 s[8:9], v104, v96
    s_bcnt1_i32_b64 s14, s[8:9]
    v_cmp_ge_u32 s[10:11], v106, v96
    s_bcnt1_i32_b64 s15, s[10:11]
    s_add_u32 s12, s12, s13
    s_add_u32 s14, s14, s15
    s_add_u32 s12, s12, s14
    s_cmp_gt_u32 s12, 8
    s_cbranch_scc1 rf_170
rfe_171:
    s_mov_b32 s57, 65536
ga_172:
    s_waitcnt vmcnt(0)
    v_max3_u32 v17, v111, v115, v119
    v_cmp_eq_u32 vcc, -1, v17
    s_cbranch_vccnz gr_173
gae_174:
    s_mov_b64 exec, 1
    buffer_store_dword v18, v5, s[16:19], s56 offen sc1
    s_mov_b64 exec, -1
    ds_write_b128 v20, v[108:111]
    ds_write_b128 v20, v[112:115] offset:1312
    s_mov_b32 exec_hi, 0
    ds_write_b128 v21, v[116:119] offset:1024
    s_mov_b64 exec, -1
    s_waitcnt lgkmcnt(0)
    s_barrier
    ds_read_b128 v[24:27], v8 offset:0
    ds_read_b128 v[28:31], v8 offset:64
    ds_read_b128 v[32:35], v8 offset:128
    ds_read_b128 v[36:39], v8 offset:192
    ds_read_b128 v[40:43], v8 offset:256
    ds_read_b128 v[44:47], v8 offset:320
    ds_read_b128 v[48:51], v8 offset:384
    ds_read_b128 v[52:55], v8 offset:448
    s_waitcnt lgkmcnt(6)
    v_mfma_f32_16x16x32_bf16 v[104:107], v[120:123], v[24:27], 0
    ds_read_b128 v[56:59], v8 offset:512
    v_mfma_f32_16x16x32_bf16 v[104:107], v[124:127], v[28:31], v[104:107]
    ds_read_b128 v[60:63], v8 offset:576
    s_waitcnt lgkmcnt(6)
    v_mfma_f32_16x16x32_bf16 v[104:107], v[128:131], v[32:35], v[104:107]
    ds_read_b128 v[64:67], v8 offset:640
    v_mfma_f32_16x16x32_bf16 v[104:107], v[132:135], v[36:39], v[104:107]
    ds_read_b128 v[68:71], v8 offset:704
    s_waitcnt lgkmcnt(6)
    v_mfma_f32_16x16x32_bf16 v[104:107], v[136:139], v[40:43], v[104:107]
    ds_read_b128 v[72:75], v8 offset:768
    v_mfma_f32_16x16x32_bf16 v[104:107], v[140:143], v[44:47], v[104:107]
    ds_read_b128 v[76:79], v8 offset:832
    s_waitcnt lgkmcnt(6)
    v_mfma_f32_16x16x32_bf16 v[104:107], v[144:147], v[48:51], v[104:107]
    ds_read_b128 v[80:83], v8 offset:896
    v_mfma_f32_16x16x32_bf16 v[104:107], v[148:151], v[52:55], v[104:107]
    ds_read_b128 v[84:87], v8 offset:960
    s_waitcnt lgkmcnt(6)
    v_mfma_f32_16x16x32_bf16 v[104:107], v[152:155], v[56:59], v[104:107]
    ds_read_b128 v[88:91], v8 offset:1024
    v_mfma_f32_16x16x32_bf16 v[104:107], v[156:159], v[60:63], v[104:107]
    ds_read_b128 v[92:95], v8 offset:1088
    s_waitcnt lgkmcnt(6)
    v_mfma_f32_16x16x32_bf16 v[104:107], v[160:163], v[64:67], v[104:107]
    ds_read_b128 v[96:99], v8 offset:1152
    v_mfma_f32_16x16x32_bf16 v[104:107], v[164:167], v[68:71], v[104:107]
    ds_read_b128 v[100:103], v8 offset:1216
    s_waitcnt lgkmcnt(6)
    v_mfma_f32_16x16x32_bf16 v[104:107], v[168:171], v[72:75], v[104:107]
    v_mfma_f32_16x16x32_bf16 v[104:107], v[172:175], v[76:79], v[104:107]
    s_waitcnt lgkmcnt(4)
    v_mfma_f32_16x16x32_bf16 v[104:107], v[176:179], v[80:83], v[104:107]
    v_mfma_f32_16x16x32_bf16 v[104:107], v[180:183], v[84:87], v[104:107]
    s_waitcnt lgkmcnt(2)
    v_mfma_f32_16x16x32_bf16 v[104:107], v[184:187], v[88:91], v[104:107]
    v_mfma_f32_16x16x32_bf16 v[104:107], v[188:191], v[92:95], v[104:107]
    s_waitcnt lgkmcnt(0)
    v_mfma_f32_16x16x32_bf16 v[104:107], v[192:195], v[96:99], v[104:107]
    v_mfma_f32_16x16x32_bf16 v[104:107], v[196:199], v[100:103], v[104:107]
    s_nop 7
    v_mul_f32 v112, s64, v104
    v_mul_f32 v113, s64, v105
    v_mul_f32 v114, s64, v106
    v_mul_f32_e64 v115, s64, v107
    v_exp_f32_e64 v112, -v112
    v_exp_f32_e64 v113, -v113
    v_exp_f32_e64 v114, -v114
    v_exp_f32_e64 v115, -v115
    v_permlane16_swap_b32 v104, v108
    v_permlane16_swap_b32 v105, v109
    v_permlane16_swap_b32 v106, v110
    v_permlane16_swap_b32 v107, v111
    v_add_f32 v112, 1.0, v112
    v_add_f32 v113, 1.0, v113
    v_add_f32 v114, 1.0, v114
    v_add_f32 v115, 1.0, v115
    v_rcp_f32 v112, v112
    v_rcp_f32 v113, v113
    v_rcp_f32 v114, v114
    v_rcp_f32 v115, v115
    v_pk_mul_f32 v[104:105], v[104:105], v[108:109]
    v_pk_mul_f32 v[106:107], v[106:107], v[110:111]
    v_pk_mul_f32 v[104:105], v[104:105], v[112:113]
    v_pk_mul_f32 v[106:107], v[106:107], v[114:115]
    v_cvt_pk_bf16_f32 v108, v104, v105
    v_cvt_pk_bf16_f32 v109, v106, v107
    s_mov_b64 exec, s[74:75]
    ds_write_b64 v9, v[108:109]
    s_mov_b64 exec, -1
    s_waitcnt lgkmcnt(0)
    s_barrier
    ds_read_b128 v[100:103], v10
    s_waitcnt lgkmcnt(0)
    v_mfma_f32_16x16x32_bf16 v[24:27], v[200:203], v[100:103], 0
    v_mfma_f32_16x16x32_bf16 v[28:31], v[204:207], v[100:103], 0
    v_mfma_f32_16x16x32_bf16 v[32:35], v[208:211], v[100:103], 0
    v_mfma_f32_16x16x32_bf16 v[36:39], v[212:215], v[100:103], 0
    v_mfma_f32_16x16x32_bf16 v[40:43], v[216:219], v[100:103], 0
    v_mfma_f32_16x16x32_bf16 v[44:47], v[220:223], v[100:103], 0
    v_mfma_f32_16x16x32_bf16 v[48:51], v[224:227], v[100:103], 0
    v_mfma_f32_16x16x32_bf16 v[52:55], v[228:231], v[100:103], 0
    v_mfma_f32_16x16x32_bf16 v[56:59], v[232:235], v[100:103], 0
    v_mfma_f32_16x16x32_bf16 v[60:63], v[236:239], v[100:103], 0
    s_mov_b64 exec, s[72:73]
    v_cvt_pk_bf16_f32 v64, v24, v25
    v_cvt_pk_bf16_f32 v65, v26, v27
    v_cvt_pk_bf16_f32 v66, v28, v29
    v_cvt_pk_bf16_f32 v67, v30, v31
    buffer_store_dwordx4 v[64:67], v11, s[16:19], s40 offen sc1
    v_cvt_pk_bf16_f32 v68, v32, v33
    v_cvt_pk_bf16_f32 v69, v34, v35
    v_cvt_pk_bf16_f32 v70, v36, v37
    v_cvt_pk_bf16_f32 v71, v38, v39
    buffer_store_dwordx4 v[68:71], v11, s[16:19], s41 offen sc1
    v_cvt_pk_bf16_f32 v72, v40, v41
    v_cvt_pk_bf16_f32 v73, v42, v43
    v_cvt_pk_bf16_f32 v74, v44, v45
    v_cvt_pk_bf16_f32 v75, v46, v47
    buffer_store_dwordx4 v[72:75], v11, s[16:19], s42 offen sc1
    v_cvt_pk_bf16_f32 v76, v48, v49
    v_cvt_pk_bf16_f32 v77, v50, v51
    v_cvt_pk_bf16_f32 v78, v52, v53
    v_cvt_pk_bf16_f32 v79, v54, v55
    buffer_store_dwordx4 v[76:79], v11, s[16:19], s43 offen sc1
    v_cvt_pk_bf16_f32 v80, v56, v57
    v_cvt_pk_bf16_f32 v81, v58, v59
    v_cvt_pk_bf16_f32 v82, v60, v61
    v_cvt_pk_bf16_f32 v83, v62, v63
    buffer_store_dwordx4 v[80:83], v11, s[16:19], s44 offen sc1
L_ffn_end:
    s_mov_b64 exec, -1
    s_endpgm
gr_167:
    s_sub_u32 s57, s57, 1
    s_cbranch_scc1 gae_168
    v_cmp_ne_u32 vcc, s28, v101
    s_wqm_b64 exec, vcc
    buffer_load_dwordx2 v[100:101], v14, s[16:19], s58 offen offset:0 sc1
    s_mov_b64 exec, -1
    v_cmp_ne_u32 vcc, s28, v103
    s_wqm_b64 exec, vcc
    buffer_load_dwordx2 v[102:103], v14, s[16:19], s58 offen offset:1024 sc1
    s_mov_b64 exec, -1
    v_cmp_ne_u32 vcc, s28, v105
    s_wqm_b64 exec, vcc
    buffer_load_dwordx2 v[104:105], v14, s[16:19], s58 offen offset:2048 sc1
    s_mov_b64 exec, -1
    v_cmp_ne_u32 vcc, s28, v107
    s_wqm_b64 exec, vcc
    buffer_load_dwordx2 v[106:107], v14, s[16:19], s58 offen offset:3072 sc1
    s_mov_b64 exec, -1
    s_waitcnt vmcnt(0)
    s_branch ga_166
gr_173:
    s_sub_u32 s57, s57, 1
    s_cbranch_scc1 gae_174
    v_cmp_eq_u32 vcc, -1, v111
    s_wqm_b64 exec, vcc
    buffer_load_dwordx4 v[108:111], v5, s[16:19], s68 offen sc1
    s_mov_b64 exec, -1
    v_cmp_eq_u32 vcc, -1, v115
    s_wqm_b64 exec, vcc
    buffer_load_dwordx4 v[112:115], v5, s[16:19], s69 offen sc1
    s_mov_b64 exec, -1
    v_cmp_eq_u32 vcc, -1, v119
    s_wqm_b64 exec, vcc
    buffer_load_dwordx4 v[116:119], v16, s[16:19], 0 offen offset:1024 sc1
    s_mov_b64 exec, -1
    s_waitcnt vmcnt(0)
    s_branch ga_172
    .p2align 12
pg_175:
L_red:
    s_cmp_ge_u32 s5, 4
    s_cbranch_scc1 L_red_end
    s_sub_u32 s56, s1, 6
    s_lshl2_add_u32 s56, s56, s6
    s_and_b32 s57, s2, 7
    s_getpc_b64 s[20:21]
L_pc2:
    s_sub_u32 s20, s20, L_pc2-sequential_preLN__linear_kernel_hedgehog__moe_arch_mod__prompt_kernel
    s_subb_u32 s21, s21, 0
    s_and_b32 s21, s21, 0xffff
    s_mov_b32 s22, L_codeend-sequential_preLN__linear_kernel_hedgehog__moe_arch_mod__prompt_kernel
    s_mov_b32 s23, 0x20000
    s_mul_i32 s58, s56, 2304
    v_lshlrev_b32 v14, 7, v1
    s_mov_b64 exec, 0x3ffff
    buffer_load_dword v229, v14, s[20:23], s58 offen
    s_mov_b64 exec, -1
    s_mov_b32 s20, s44
    s_and_b32 s21, s45, 0xffff
    s_mov_b32 s22, 1966080
    s_mov_b32 s23, 0x20000
    s_mov_b32 s24, s46
    s_and_b32 s25, s47, 0xffff
    s_mov_b32 s26, 1966080
    s_mov_b32 s27, 0x20000
    s_mov_b32 s8, s48
    s_and_b32 s9, s49, 0xffff
    s_mov_b32 s10, 1966080
    s_mov_b32 s11, 0x20000
    s_waitcnt vmcnt(0)
    v_mul_u32_u24 v14, 21846, v1
    v_lshrrev_b32 v14, 16, v14
    v_mul_u32_u24 v15, 2688, v14
    v_lshlrev_b32 v14, 7, v1
    v_add_u32 v15, v15, v14
    s_mul_i32 s58, s56, 21504
    s_mul_i32 s59, s57, 384
    s_add_u32 s58, s58, s59
    s_add_u32 s58, s58, 1449984
    s_mov_b64 exec, 0x1fffff
    buffer_load_dword v230, v15, s[20:23], s58 offen
    buffer_load_dword v231, v15, s[24:27], s58 offen
    s_mov_b64 exec, -1
    s_mul_i32 s58, s56, 10240
    s_mul_i32 s59, s57, 245760
    s_add_u32 s58, s58, s59
    buffer_load_dword v232, v14, s[8:11], s58 offen
    s_add_u32 s58, s58, 8192
    s_mov_b64 exec, 0xffff
    buffer_load_dword v233, v14, s[8:11], s58 offen
    s_mov_b64 exec, -1
    s_cmp_ge_u32 s70, 88
    s_cbranch_scc1 L_red_end
    s_sub_u32 s70, s70, 48
    s_mov_b32 s24, s50
    s_and_b32 s25, s51, 0xffff
    s_mov_b32 s26, 2621440
    s_mov_b32 s27, 0x20000
    v_and_b32 v14, 1, v1
    v_lshlrev_b32_e64 v14, 4, v14
    v_mov_b32 v15, 0x3f80
    v_lshlrev_b32_e64 v15, v14, v15
    v_bfe_u32 v14, v1, 1, 2
    v_cmp_eq_u32 vcc, 0, v14
    s_nop 1
    v_cndmask_b32 v20, 0, v15, vcc
    v_cmp_eq_u32 vcc, 1, v14
    s_nop 1
    v_cndmask_b32 v21, 0, v15, vcc
    v_cmp_eq_u32 vcc, 2, v14
    s_nop 1
    v_cndmask_b32 v22, 0, v15, vcc
    v_cmp_eq_u32 vcc, 3, v14
    s_nop 1
    v_cndmask_b32 v23, 0, v15, vcc
    v_and_b32 v16, 1, v3
    v_lshlrev_b32 v4, 3, v16
    v_lshlrev_b32 v5, 4, v1
    v_lshlrev_b32 v8, 7, v1
    s_lshr_b32 s58, s6, 1
    s_lshl1_add_u32 s67, s70, s58
    s_lshl_b32 s67, s67, 4
    s_add_u32 s68, s67, 6623232
    s_add_u32 s69, s67, 6950912
    s_lshl2_add_u32 s72, s70, s6
    s_mul_i32 s72, s72, 3072
    s_add_u32 s72, s72, 7278592
    s_mov_b32 s73, 7770124
    s_and_b32 s58, s6, 1
    s_lshl_b32 s58, s58, 2
    s_lshl_b32 s36, 0x000f000f, s58
    s_mov_b32 s37, 0
    s_mov_b32 s38, -1
    s_mov_b32 s39, 0xffff
    v_lshrrev_b32 v14, 3, v1
    v_lshlrev_b32 v14, 6, v14
    v_lshl_add_u32 v14, v1, 3, v14
    s_mov_b32 s58, 6619136
    v_mov_b32 v16, s28
    s_mov_b32 s30, 0
    buffer_load_dwordx2 v[100:101], v14, s[16:19], s58 offen offset:0 sc1
    buffer_load_dwordx2 v[102:103], v14, s[16:19], s58 offen offset:1024 sc1
    buffer_load_dwordx2 v[104:105], v14, s[16:19], s58 offen offset:2048 sc1
    buffer_load_dwordx2 v[106:107], v14, s[16:19], s58 offen offset:3072 sc1
    s_mov_b32 s57, 65536
ga_176:
    s_waitcnt vmcnt(0)
    v_xor_b32 v15, s28, v101
    v_bitop3_b32 v15, v15, v103, v16 bitop3:0xf6
    v_bitop3_b32 v15, v15, v105, v16 bitop3:0xf6
    v_bitop3_b32 v15, v15, v107, v16 bitop3:0xf6
    v_cmp_ne_u32 vcc, 0, v15
    s_cbranch_vccnz gr_177
gae_178:
km_179:
    v_max_u32_dpp v92, v102, v100 row_half_mirror row_mask:0xf bank_mask:0xf
    v_max_u32_dpp v94, v106, v104 row_half_mirror row_mask:0xf bank_mask:0xf
    s_nop 0
    v_max_u32_dpp v93, v92, v92 row_shl:4 row_mask:0xf bank_mask:0x5
    v_max_u32_dpp v95, v94, v94 row_shl:4 row_mask:0xf bank_mask:0x5
    s_nop 0
    v_min_u32_dpp v93, v92, v92 row_shr:4 row_mask:0xf bank_mask:0xa
    v_min_u32_dpp v95, v94, v94 row_shr:4 row_mask:0xf bank_mask:0xa
    s_nop 0
    v_mov_b32_dpp v92, v93 quad_perm:[2,3,0,1] row_mask:0xf bank_mask:0xf
    v_mov_b32_dpp v94, v95 quad_perm:[2,3,0,1] row_mask:0xf bank_mask:0xf
    v_med3_u32 v93, v93, v92, v249
    v_med3_u32 v95, v95, v94, v249
    s_nop 0
    v_mov_b32_dpp v92, v93 quad_perm:[1,0,3,2] row_mask:0xf bank_mask:0xf
    v_mov_b32_dpp v94, v95 quad_perm:[1,0,3,2] row_mask:0xf bank_mask:0xf
    v_med3_u32 v93, v93, v92, v248
    v_med3_u32 v95, v95, v94, v248
    s_nop 1
    v_max_u32_dpp v93, v95, v93 row_half_mirror row_mask:0xf bank_mask:0xf
    s_nop 1
    v_max_u32_dpp v92, v93, v93 row_shl:4 row_mask:0xf bank_mask:0x5
    s_nop 1
    v_min_u32_dpp v92, v93, v93 row_shr:4 row_mask:0xf bank_mask:0xa
    s_nop 1
    v_mov_b32_dpp v93, v92 quad_perm:[2,3,0,1] row_mask:0xf bank_mask:0xf
    v_med3_u32 v92, v92, v93, v249
    s_nop 1
    v_mov_b32_dpp v93, v92 quad_perm:[1,0,3,2] row_mask:0xf bank_mask:0xf
    v_med3_u32 v92, v92, v93, v248
    s_nop 1
    v_max_u32_dpp v92, v92, v92 row_mirror row_mask:0xf bank_mask:0xf
    s_nop 1
    v_max_u32_dpp v93, v92, v92 row_shl:4 row_mask:0xf bank_mask:0x5
    s_nop 1
    v_min_u32_dpp v93, v92, v92 row_shr:4 row_mask:0xf bank_mask:0xa
    s_nop 1
    v_mov_b32_dpp v92, v93 quad_perm:[2,3,0,1] row_mask:0xf bank_mask:0xf
    v_med3_u32 v93, v93, v92, v249
    s_nop 1
    v_mov_b32_dpp v92, v93 quad_perm:[1,0,3,2] row_mask:0xf bank_mask:0xf
    v_med3_u32 v93, v93, v92, v248
    v_mov_b32 v92, v93
    s_nop 1
    v_permlane16_swap_b32 v93, v92
    s_nop 1
    v_max_u32_dpp v93, v92, v93 row_half_mirror row_mask:0xf bank_mask:0xf
    s_nop 1
    v_mov_b32_dpp v92, v93 row_ror:4 row_mask:0xf bank_mask:0xf
    v_med3_u32 v93, v93, v92, v250
    s_nop 1
    v_mov_b32_dpp v92, v93 quad_perm:[2,3,0,1] row_mask:0xf bank_mask:0xf
    v_med3_u32 v93, v93, v92, v249
    s_nop 1
    v_mov_b32_dpp v92, v93 quad_perm:[1,0,3,2] row_mask:0xf bank_mask:0xf
    v_med3_u32 v93, v93, v92, v248
    v_mov_b32_e64 v92, v93
    s_nop 1
    v_permlane32_swap_b32 v93, v92
    s_nop 1
    v_max_u32_dpp v93, v92, v93 row_half_mirror row_mask:0xf bank_mask:0xf
    s_cmp_lg_u32 s30, 0
    s_cbranch_scc1 rfe_181
    v_min_u32_dpp v96, v93, v93 quad_perm:[1,0,3,2] row_mask:0xf bank_mask:0xf
    s_nop 1
    v_min_u32_dpp v96, v96, v96 quad_perm:[2,3,0,1] row_mask:0xf bank_mask:0xf
    s_nop 1
    v_min_u32_dpp v96, v96, v96 row_half_mirror row_mask:0xf bank_mask:0xf
    v_and_b32 v97, 0xffffc000, v96
    v_or_b32 v97, 0x2000, v97
    v_ashrrev_i32 v98, 31, v97
    v_not_b32 v98, v98
    v_or_b32 v98, 0x80000000, v98
    v_xor_b32_e64 v97, v97, v98
    v_and_b32 v98, 0x7f800000, v97
    v_fmamk_f32 v98, v98, 0xbcc00000, v254
    v_sub_f32 v96, v97, v98
    v_ashrrev_i32 v99, 31, v96
    v_or_b32 v99, 0x80000000, v99
    v_xor_b32_e64 v96, v96, v99
    v_cmp_ge_u32 s[8:9], v100, v96
    s_bcnt1_i32_b64 s12, s[8:9]
    v_cmp_ge_u32 s[10:11], v102, v96
    s_bcnt1_i32_b64 s13, s[10:11]
    v_cmp_ge_u32 s[8:9], v104, v96
    s_bcnt1_i32_b64 s14, s[8:9]
    v_cmp_ge_u32 s[10:11], v106, v96
    s_bcnt1_i32_b64 s15, s[10:11]
    s_add_u32 s12, s12, s13
    s_add_u32 s14, s14, s15
    s_add_u32 s12, s12, s14
    s_cmp_gt_u32 s12, 8
    s_cbranch_scc1 rf_180
rfe_181:
    v_not_b32 v15, v93
    v_bfe_u32 v15, v15, 3, 11
    v_mul_u32_u24 v6, 1280, v15
    v_add_u32 v6, v6, v4
    v_lshrrev_b32 v15, 6, v15
    v_and_b32_e64 v16, 7, v93
    v_lshl_add_u32 v15, v15, 3, v16
    v_mul_u32_u24 v15, 1280, v15
    v_add_u32_e64 v7, v15, v4
    v_and_b32 v15, 0xffffc000, v93
    v_or_b32 v15, 0x2000, v15
    v_ashrrev_i32 v16, 31, v15
    v_not_b32 v16, v16
    v_or_b32 v16, 0x80000000, v16
    v_xor_b32_e64 v15, v15, v16
    v_cvt_pk_bf16_f32 v15, 0, v15
    v_mul_f32_e64 v15, s64, v15
    v_exp_f32_e64 v15, -v15
    s_nop 0
    v_add_f32 v15, 1.0, v15
    v_rcp_f32 v15, v15
    s_nop 0
    v_cvt_pk_bf16_f32 v10, 0, v15
    s_mov_b64 exec, s[36:37]
    buffer_load_dwordx2 v[80:81], v7, s[16:19], s68 offen sc1
    buffer_load_dwordx2 v[82:83], v7, s[16:19], s69 offen sc1
    s_mov_b32 s57, 65536
ga_182:
    s_waitcnt vmcnt(0)
    v_max_u32 v17, v81, v83
    v_cmp_eq_u32 vcc, -1, v17
    s_cbranch_vccnz gr_183
gae_184:
    v_lshlrev_b32 v86, 16, v80
    v_and_b32 v87, s31, v80
    v_lshlrev_b32 v90, 16, v82
    v_and_b32 v91, s31, v82
    v_lshlrev_b32 v88, 16, v81
    v_and_b32 v89, s31, v81
    v_lshlrev_b32 v92, 16, v83
    v_and_b32 v93, s31, v83
    s_mov_b64 exec, s[38:39]
    buffer_load_dword v17, v8, s[16:19], s73 offen sc1
    s_mov_b32 s57, 65536
ga_185:
    s_waitcnt vmcnt(0)
    v_cmp_ne_u32 vcc, s28, v17
    s_cbranch_vccnz gr_186
gae_187:
    s_mov_b64 exec, -1
    buffer_load_dwordx4 v[24:27], v5, s[16:19], s72 offen offset:0 sc1
    buffer_load_dwordx4 v[28:31], v5, s[16:19], s72 offen offset:1024 sc1
    buffer_load_dwordx4 v[32:35], v5, s[16:19], s72 offen offset:2048 sc1
    s_mov_b32 s57, 65536
ga_188:
    s_waitcnt vmcnt(2)
    v_mfma_f32_16x16x32_bf16 v[72:75], v[20:23], v[24:27], 0
    s_waitcnt vmcnt(1)
    v_mfma_f32_16x16x32_bf16 v[72:75], v[20:23], v[28:31], v[72:75]
    s_waitcnt vmcnt(0)
    v_mfma_f32_16x16x32_bf16 v[72:75], v[20:23], v[32:35], v[72:75]
    v_max3_u32 v17, v27, v31, v35
    v_cmp_eq_u32 vcc, -1, v17
    s_cbranch_vccnz gr_189
gae_190:
    s_nop 4
    v_add_f32_dpp v72, v72, v72 row_ror:4 row_mask:0xf bank_mask:0xf
    v_add_f32_dpp v73, v73, v73 row_ror:4 row_mask:0xf bank_mask:0xf
    v_add_f32_dpp v74, v74, v74 row_ror:4 row_mask:0xf bank_mask:0xf
    v_add_f32_dpp v75, v75, v75 row_ror:4 row_mask:0xf bank_mask:0xf
    v_add_f32_dpp v72, v72, v72 row_ror:8 row_mask:0xf bank_mask:0xf
    v_add_f32_dpp v73, v73, v73 row_ror:8 row_mask:0xf bank_mask:0xf
    v_add_f32_dpp v74, v74, v74 row_ror:8 row_mask:0xf bank_mask:0xf
    v_add_f32_dpp v75, v75, v75 row_ror:8 row_mask:0xf bank_mask:0xf
    v_pk_fma_f32 v[72:73], v[72:73], v[10:11], v[86:87] op_sel_hi:[1,0,1]
    v_pk_fma_f32 v[74:75], v[74:75], v[10:11], v[88:89] op_sel_hi:[1,0,1]
    v_cvt_pk_bf16_f32 v72, 0, v72
    v_cvt_pk_bf16_f32 v73, 0, v73
    v_cvt_pk_bf16_f32 v74, 0, v74
    v_cvt_pk_bf16_f32 v75, 0, v75
    v_pk_add_f32 v[72:73], v[72:73], v[90:91]
    v_pk_add_f32 v[74:75], v[74:75], v[92:93]
    v_cvt_pk_bf16_f32 v76, v72, v73
    v_cvt_pk_bf16_f32 v77, v74, v75
    s_mov_b64 exec, s[36:37]
    buffer_store_dwordx2 v[76:77], v6, s[24:27], s67 offen sc1
    s_or_b32 s70, s70, s6
    s_cbranch_scc1 L_red_end
    s_mov_b64 exec, 1
    v_mov_b32 v17, s28
    buffer_store_dword v17, v5, s[16:19], 0 offen offset:12 sc1
L_red_end:
    s_mov_b64 exec, -1
    s_endpgm
gr_177:
    s_sub_u32 s57, s57, 1
    s_cbranch_scc1 gae_178
    v_cmp_ne_u32 vcc, s28, v101
    s_wqm_b64 exec, vcc
    buffer_load_dwordx2 v[100:101], v14, s[16:19], s58 offen offset:0 sc1
    s_mov_b64 exec, -1
    v_cmp_ne_u32 vcc, s28, v103
    s_wqm_b64 exec, vcc
    buffer_load_dwordx2 v[102:103], v14, s[16:19], s58 offen offset:1024 sc1
    s_mov_b64 exec, -1
    v_cmp_ne_u32 vcc, s28, v105
    s_wqm_b64 exec, vcc
    buffer_load_dwordx2 v[104:105], v14, s[16:19], s58 offen offset:2048 sc1
    s_mov_b64 exec, -1
    v_cmp_ne_u32 vcc, s28, v107
    s_wqm_b64 exec, vcc
    buffer_load_dwordx2 v[106:107], v14, s[16:19], s58 offen offset:3072 sc1
    s_mov_b64 exec, -1
    s_waitcnt vmcnt(0)
    s_branch ga_176
gr_183:
    s_sub_u32 s57, s57, 1
    s_cbranch_scc1 gae_184
    s_wqm_b64 exec, vcc
    buffer_load_dwordx2 v[80:81], v7, s[16:19], s68 offen sc1
    buffer_load_dwordx2 v[82:83], v7, s[16:19], s69 offen sc1
    s_mov_b64 exec, s[36:37]
    s_waitcnt vmcnt(0)
    s_branch ga_182
gr_186:
    s_sub_u32 s57, s57, 1
    s_cbranch_scc1 gae_187
    s_wqm_b64 exec, vcc
    buffer_load_dword v17, v8, s[16:19], s73 offen sc1
    s_mov_b64 exec, s[38:39]
    s_waitcnt vmcnt(0)
    s_branch ga_185
gr_189:
    s_sub_u32 s57, s57, 1
    s_cbranch_scc1 gae_190
    v_cmp_eq_u32 vcc, -1, v27
    s_wqm_b64 exec, vcc
    buffer_load_dwordx4 v[24:27], v5, s[16:19], s72 offen offset:0 sc1
    s_mov_b64 exec, -1
    v_cmp_eq_u32 vcc, -1, v31
    s_wqm_b64 exec, vcc
    buffer_load_dwordx4 v[28:31], v5, s[16:19], s72 offen offset:1024 sc1
    s_mov_b64 exec, -1
    v_cmp_eq_u32 vcc, -1, v35
    s_wqm_b64 exec, vcc
    buffer_load_dwordx4 v[32:35], v5, s[16:19], s72 offen offset:2048 sc1
    s_mov_b64 exec, -1
    s_waitcnt vmcnt(0)
    s_branch ga_188
rf_180:
    s_waitcnt vmcnt(0)
    s_mov_b32 s30, 1
    v_add_f32 v97, v97, v98
    v_mul_u32_u24 v91, 20, v1
    v_ashrrev_i32_e64 v99, 31, v97
    v_or_b32 v99, 0x80000000, v99
    v_xor_b32_e64 v97, v97, v99
    v_cmp_ge_u32 s[8:9], v100, v96
    v_cmp_le_u32 vcc, v100, v97
    s_and_b64 s[8:9], s[8:9], vcc
ra_191:
    s_cmp_eq_u64 s[8:9], 0
    s_cbranch_scc1 rb_192
    s_ff1_i32_b64 s10, s[8:9]
    s_bitset0_b64 s[8:9], s10
    v_readlane_b32 s11, v100, s10
    s_not_b32 s12, s11
    s_bfe_u32 s12, s12, 0x50009
    s_lshl_b32 s12, s12, 3
    s_and_b32 s13, s11, 7
    s_add_u32 s12, s12, s13
    s_mul_i32 s12, s12, 1280
    s_add_u32 s12, s12, 6623232
    s_mov_b32 s57, 65536
rp_193:
    buffer_load_dwordx4 v[84:87], v91, s[16:19], s12 offen sc1
    buffer_load_dword v88, v91, s[16:19], s12 offen offset:16 sc1
    s_waitcnt vmcnt(0)
    v_max3_u32 v89, v84, v85, v86
    v_max3_u32 v89, v89, v87, v88
    v_cmp_eq_u32 vcc, -1, v89
    s_cbranch_vccz rq_194
    s_sub_u32 s57, s57, 1
    s_cbranch_scc0 rp_193
rq_194:
    v_mov_b32 v89, 0
    v_dot2c_f32_bf16 v89, v240, v84
    v_dot2c_f32_bf16 v89, v241, v85
    v_dot2c_f32_bf16 v89, v242, v86
    v_dot2c_f32_bf16 v89, v243, v87
    v_dot2c_f32_bf16 v89, v244, v88
    s_nop 2
    v_add_f32_dpp v89, v89, v89 row_ror:1 row_mask:0xf bank_mask:0xf
    s_nop 1
    v_add_f32_dpp v89, v89, v89 row_ror:2 row_mask:0xf bank_mask:0xf
    s_nop 1
    v_add_f32_dpp v89, v89, v89 row_ror:4 row_mask:0xf bank_mask:0xf
    s_nop 1
    v_add_f32_dpp v89, v89, v89 row_ror:8 row_mask:0xf bank_mask:0xf
    v_mov_b32 v90, v89
    s_nop 1
    v_permlane16_swap_b32 v89, v90
    v_add_f32 v89, v89, v90
    v_mov_b32 v90, v89
    s_nop 1
    v_permlane32_swap_b32 v89, v90
    v_add_f32 v89, v89, v90
    v_ashrrev_i32 v90, 31, v89
    v_or_b32 v90, 0x80000000, v90
    v_xor_b32_e64 v89, v89, v90
    s_and_b32 s11, s11, 0x3fff
    v_and_b32 v89, 0xffffc000, v89
    v_or_b32 v89, s11, v89
    s_lshl_b64 s[14:15], 1, s10
    s_mov_b64 exec, s[14:15]
    v_mov_b32 v100, v89
    s_mov_b64 exec, -1
    s_branch ra_191
rb_192:
    v_cmp_ge_u32 s[8:9], v102, v96
    v_cmp_le_u32 vcc, v102, v97
    s_and_b64 s[8:9], s[8:9], vcc
ra_195:
    s_cmp_eq_u64 s[8:9], 0
    s_cbranch_scc1 rb_196
    s_ff1_i32_b64 s10, s[8:9]
    s_bitset0_b64 s[8:9], s10
    v_readlane_b32 s11, v102, s10
    s_not_b32 s12, s11
    s_bfe_u32 s12, s12, 0x50009
    s_lshl_b32 s12, s12, 3
    s_and_b32 s13, s11, 7
    s_add_u32 s12, s12, s13
    s_mul_i32 s12, s12, 1280
    s_add_u32 s12, s12, 6623232
    s_mov_b32 s57, 65536
rp_197:
    buffer_load_dwordx4 v[84:87], v91, s[16:19], s12 offen sc1
    buffer_load_dword v88, v91, s[16:19], s12 offen offset:16 sc1
    s_waitcnt vmcnt(0)
    v_max3_u32 v89, v84, v85, v86
    v_max3_u32 v89, v89, v87, v88
    v_cmp_eq_u32 vcc, -1, v89
    s_cbranch_vccz rq_198
    s_sub_u32 s57, s57, 1
    s_cbranch_scc0 rp_197
rq_198:
    v_mov_b32 v89, 0
    v_dot2c_f32_bf16 v89, v240, v84
    v_dot2c_f32_bf16 v89, v241, v85
    v_dot2c_f32_bf16 v89, v242, v86
    v_dot2c_f32_bf16 v89, v243, v87
    v_dot2c_f32_bf16 v89, v244, v88
    s_nop 2
    v_add_f32_dpp v89, v89, v89 row_ror:1 row_mask:0xf bank_mask:0xf
    s_nop 1
    v_add_f32_dpp v89, v89, v89 row_ror:2 row_mask:0xf bank_mask:0xf
    s_nop 1
    v_add_f32_dpp v89, v89, v89 row_ror:4 row_mask:0xf bank_mask:0xf
    s_nop 1
    v_add_f32_dpp v89, v89, v89 row_ror:8 row_mask:0xf bank_mask:0xf
    v_mov_b32 v90, v89
    s_nop 1
    v_permlane16_swap_b32 v89, v90
    v_add_f32 v89, v89, v90
    v_mov_b32 v90, v89
    s_nop 1
    v_permlane32_swap_b32 v89, v90
    v_add_f32 v89, v89, v90
    v_ashrrev_i32 v90, 31, v89
    v_or_b32 v90, 0x80000000, v90
    v_xor_b32_e64 v89, v89, v90
    s_and_b32 s11, s11, 0x3fff
    v_and_b32 v89, 0xffffc000, v89
    v_or_b32 v89, s11, v89
    s_lshl_b64 s[14:15], 1, s10
    s_mov_b64 exec, s[14:15]
    v_mov_b32 v102, v89
    s_mov_b64 exec, -1
    s_branch ra_195
rb_196:
    v_cmp_ge_u32 s[8:9], v104, v96
    v_cmp_le_u32 vcc, v104, v97
    s_and_b64 s[8:9], s[8:9], vcc
ra_199:
    s_cmp_eq_u64 s[8:9], 0
    s_cbranch_scc1 rb_200
    s_ff1_i32_b64 s10, s[8:9]
    s_bitset0_b64 s[8:9], s10
    v_readlane_b32 s11, v104, s10
    s_not_b32 s12, s11
    s_bfe_u32 s12, s12, 0x50009
    s_lshl_b32 s12, s12, 3
    s_and_b32 s13, s11, 7
    s_add_u32 s12, s12, s13
    s_mul_i32 s12, s12, 1280
    s_add_u32 s12, s12, 6623232
    s_mov_b32 s57, 65536
rp_201:
    buffer_load_dwordx4 v[84:87], v91, s[16:19], s12 offen sc1
    buffer_load_dword v88, v91, s[16:19], s12 offen offset:16 sc1
    s_waitcnt vmcnt(0)
    v_max3_u32 v89, v84, v85, v86
    v_max3_u32 v89, v89, v87, v88
    v_cmp_eq_u32 vcc, -1, v89
    s_cbranch_vccz rq_202
    s_sub_u32 s57, s57, 1
    s_cbranch_scc0 rp_201
rq_202:
    v_mov_b32 v89, 0
    v_dot2c_f32_bf16 v89, v240, v84
    v_dot2c_f32_bf16 v89, v241, v85
    v_dot2c_f32_bf16 v89, v242, v86
    v_dot2c_f32_bf16 v89, v243, v87
    v_dot2c_f32_bf16 v89, v244, v88
    s_nop 2
    v_add_f32_dpp v89, v89, v89 row_ror:1 row_mask:0xf bank_mask:0xf
    s_nop 1
    v_add_f32_dpp v89, v89, v89 row_ror:2 row_mask:0xf bank_mask:0xf
    s_nop 1
    v_add_f32_dpp v89, v89, v89 row_ror:4 row_mask:0xf bank_mask:0xf
    s_nop 1
    v_add_f32_dpp v89, v89, v89 row_ror:8 row_mask:0xf bank_mask:0xf
    v_mov_b32 v90, v89
    s_nop 1
    v_permlane16_swap_b32 v89, v90
    v_add_f32 v89, v89, v90
    v_mov_b32 v90, v89
    s_nop 1
    v_permlane32_swap_b32 v89, v90
    v_add_f32 v89, v89, v90
    v_ashrrev_i32 v90, 31, v89
    v_or_b32 v90, 0x80000000, v90
    v_xor_b32_e64 v89, v89, v90
    s_and_b32 s11, s11, 0x3fff
    v_and_b32 v89, 0xffffc000, v89
    v_or_b32 v89, s11, v89
    s_lshl_b64 s[14:15], 1, s10
    s_mov_b64 exec, s[14:15]
    v_mov_b32 v104, v89
    s_mov_b64 exec, -1
    s_branch ra_199
rb_200:
    v_cmp_ge_u32 s[8:9], v106, v96
    v_cmp_le_u32 vcc, v106, v97
    s_and_b64 s[8:9], s[8:9], vcc
ra_203:
    s_cmp_eq_u64 s[8:9], 0
    s_cbranch_scc1 rb_204
    s_ff1_i32_b64 s10, s[8:9]
    s_bitset0_b64 s[8:9], s10
    v_readlane_b32 s11, v106, s10
    s_not_b32 s12, s11
    s_bfe_u32 s12, s12, 0x50009
    s_lshl_b32 s12, s12, 3
    s_and_b32 s13, s11, 7
    s_add_u32 s12, s12, s13
    s_mul_i32 s12, s12, 1280
    s_add_u32 s12, s12, 6623232
    s_mov_b32 s57, 65536
rp_205:
    buffer_load_dwordx4 v[84:87], v91, s[16:19], s12 offen sc1
    buffer_load_dword v88, v91, s[16:19], s12 offen offset:16 sc1
    s_waitcnt vmcnt(0)
    v_max3_u32 v89, v84, v85, v86
    v_max3_u32 v89, v89, v87, v88
    v_cmp_eq_u32 vcc, -1, v89
    s_cbranch_vccz rq_206
    s_sub_u32 s57, s57, 1
    s_cbranch_scc0 rp_205
rq_206:
    v_mov_b32 v89, 0
    v_dot2c_f32_bf16 v89, v240, v84
    v_dot2c_f32_bf16 v89, v241, v85
    v_dot2c_f32_bf16 v89, v242, v86
    v_dot2c_f32_bf16 v89, v243, v87
    v_dot2c_f32_bf16 v89, v244, v88
    s_nop 2
    v_add_f32_dpp v89, v89, v89 row_ror:1 row_mask:0xf bank_mask:0xf
    s_nop 1
    v_add_f32_dpp v89, v89, v89 row_ror:2 row_mask:0xf bank_mask:0xf
    s_nop 1
    v_add_f32_dpp v89, v89, v89 row_ror:4 row_mask:0xf bank_mask:0xf
    s_nop 1
    v_add_f32_dpp v89, v89, v89 row_ror:8 row_mask:0xf bank_mask:0xf
    v_mov_b32 v90, v89
    s_nop 1
    v_permlane16_swap_b32 v89, v90
    v_add_f32 v89, v89, v90
    v_mov_b32 v90, v89
    s_nop 1
    v_permlane32_swap_b32 v89, v90
    v_add_f32 v89, v89, v90
    v_ashrrev_i32 v90, 31, v89
    v_or_b32 v90, 0x80000000, v90
    v_xor_b32_e64 v89, v89, v90
    s_and_b32 s11, s11, 0x3fff
    v_and_b32 v89, 0xffffc000, v89
    v_or_b32 v89, s11, v89
    s_lshl_b64 s[14:15], 1, s10
    s_mov_b64 exec, s[14:15]
    v_mov_b32 v106, v89
    s_mov_b64 exec, -1
    s_branch ra_203
rb_204:
    v_mov_b32_dpp v101, v100 quad_perm:[1,0,3,2] row_mask:0xf bank_mask:0xf
    v_mov_b32_dpp v103, v102 quad_perm:[1,0,3,2] row_mask:0xf bank_mask:0xf
    v_mov_b32_dpp v105, v104 quad_perm:[1,0,3,2] row_mask:0xf bank_mask:0xf
    v_mov_b32_dpp v107, v106 quad_perm:[1,0,3,2] row_mask:0xf bank_mask:0xf
    v_med3_u32 v100, v100, v101, v248
    v_med3_u32 v102, v102, v103, v248
    v_med3_u32 v104, v104, v105, v248
    v_med3_u32 v106, v106, v107, v248
    v_mov_b32_dpp v101, v100 quad_perm:[3,2,1,0] row_mask:0xf bank_mask:0xf
    v_mov_b32_dpp v103, v102 quad_perm:[3,2,1,0] row_mask:0xf bank_mask:0xf
    v_mov_b32_dpp v105, v104 quad_perm:[3,2,1,0] row_mask:0xf bank_mask:0xf
    v_mov_b32_dpp v107, v106 quad_perm:[3,2,1,0] row_mask:0xf bank_mask:0xf
    v_med3_u32 v100, v100, v101, v249
    v_med3_u32 v102, v102, v103, v249
    v_med3_u32 v104, v104, v105, v249
    v_med3_u32 v106, v106, v107, v249
    v_mov_b32_dpp v101, v100 quad_perm:[1,0,3,2] row_mask:0xf bank_mask:0xf
    v_mov_b32_dpp v103, v102 quad_perm:[1,0,3,2] row_mask:0xf bank_mask:0xf
    v_mov_b32_dpp v105, v104 quad_perm:[1,0,3,2] row_mask:0xf bank_mask:0xf
    v_mov_b32_dpp v107, v106 quad_perm:[1,0,3,2] row_mask:0xf bank_mask:0xf
    v_med3_u32 v100, v100, v101, v248
    v_med3_u32 v102, v102, v103, v248
    v_med3_u32 v104, v104, v105, v248
    v_med3_u32 v106, v106, v107, v248
    v_mov_b32_dpp v101, v100 row_half_mirror row_mask:0xf bank_mask:0xf
    v_mov_b32_dpp v103, v102 row_half_mirror row_mask:0xf bank_mask:0xf
    v_mov_b32_dpp v105, v104 row_half_mirror row_mask:0xf bank_mask:0xf
    v_mov_b32_dpp v107, v106 row_half_mirror row_mask:0xf bank_mask:0xf
    v_med3_u32 v100, v100, v101, v250
    v_med3_u32 v102, v102, v103, v250
    v_med3_u32 v104, v104, v105, v250
    v_med3_u32 v106, v106, v107, v250
    v_mov_b32_dpp v101, v100 quad_perm:[2,3,0,1] row_mask:0xf bank_mask:0xf
    v_mov_b32_dpp v103, v102 quad_perm:[2,3,0,1] row_mask:0xf bank_mask:0xf
    v_mov_b32_dpp v105, v104 quad_perm:[2,3,0,1] row_mask:0xf bank_mask:0xf
    v_mov_b32_dpp v107, v106 quad_perm:[2,3,0,1] row_mask:0xf bank_mask:0xf
    v_med3_u32 v100, v100, v101, v249
    v_med3_u32 v102, v102, v103, v249
    v_med3_u32 v104, v104, v105, v249
    v_med3_u32 v106, v106, v107, v249
    v_mov_b32_dpp v101, v100 quad_perm:[1,0,3,2] row_mask:0xf bank_mask:0xf
    v_mov_b32_dpp v103, v102 quad_perm:[1,0,3,2] row_mask:0xf bank_mask:0xf
    v_mov_b32_dpp v105, v104 quad_perm:[1,0,3,2] row_mask:0xf bank_mask:0xf
    v_mov_b32_dpp v107, v106 quad_perm:[1,0,3,2] row_mask:0xf bank_mask:0xf
    v_med3_u32 v100, v100, v101, v248
    v_med3_u32 v102, v102, v103, v248
    v_med3_u32 v104, v104, v105, v248
    v_med3_u32 v106, v106, v107, v248
    s_branch km_179
rf_170:
    s_waitcnt vmcnt(0)
    s_mov_b32 s30, 1
    v_add_f32 v97, v97, v98
    v_mul_u32_u24 v91, 20, v1
    v_ashrrev_i32 v99, 31, v97
    v_or_b32 v99, 0x80000000, v99
    v_xor_b32_e64 v97, v97, v99
    v_cmp_ge_u32 s[8:9], v100, v96
    v_cmp_le_u32 vcc, v100, v97
    s_and_b64 s[8:9], s[8:9], vcc
ra_207:
    s_cmp_eq_u64 s[8:9], 0
    s_cbranch_scc1 rb_208
    s_ff1_i32_b64 s10, s[8:9]
    s_bitset0_b64 s[8:9], s10
    v_readlane_b32 s11, v100, s10
    s_not_b32 s12, s11
    s_bfe_u32 s12, s12, 0x50009
    s_lshl_b32 s12, s12, 3
    s_and_b32 s13, s11, 7
    s_add_u32 s12, s12, s13
    s_mul_i32 s12, s12, 1280
    s_add_u32 s12, s12, 6623232
    s_mov_b32 s57, 65536
rp_209:
    buffer_load_dwordx4 v[84:87], v91, s[16:19], s12 offen sc1
    buffer_load_dword v88, v91, s[16:19], s12 offen offset:16 sc1
    s_waitcnt vmcnt(0)
    v_max3_u32 v89, v84, v85, v86
    v_max3_u32 v89, v89, v87, v88
    v_cmp_eq_u32 vcc, -1, v89
    s_cbranch_vccz rq_210
    s_sub_u32 s57, s57, 1
    s_cbranch_scc0 rp_209
rq_210:
    v_mov_b32 v89, 0
    v_dot2c_f32_bf16 v89, v240, v84
    v_dot2c_f32_bf16 v89, v241, v85
    v_dot2c_f32_bf16 v89, v242, v86
    v_dot2c_f32_bf16 v89, v243, v87
    v_dot2c_f32_bf16 v89, v244, v88
    s_nop 2
    v_add_f32_dpp v89, v89, v89 row_ror:1 row_mask:0xf bank_mask:0xf
    s_nop 1
    v_add_f32_dpp v89, v89, v89 row_ror:2 row_mask:0xf bank_mask:0xf
    s_nop 1
    v_add_f32_dpp v89, v89, v89 row_ror:4 row_mask:0xf bank_mask:0xf
    s_nop 1
    v_add_f32_dpp v89, v89, v89 row_ror:8 row_mask:0xf bank_mask:0xf
    v_mov_b32 v90, v89
    s_nop 1
    v_permlane16_swap_b32 v89, v90
    v_add_f32 v89, v89, v90
    v_mov_b32 v90, v89
    s_nop 1
    v_permlane32_swap_b32 v89, v90
    v_add_f32 v89, v89, v90
    v_ashrrev_i32 v90, 31, v89
    v_or_b32 v90, 0x80000000, v90
    v_xor_b32_e64 v89, v89, v90
    s_and_b32 s11, s11, 0x3fff
    v_and_b32 v89, 0xffffc000, v89
    v_or_b32 v89, s11, v89
    s_lshl_b64 s[14:15], 1, s10
    s_mov_b64 exec, s[14:15]
    v_mov_b32 v100, v89
    s_mov_b64 exec, -1
    s_branch ra_207
rb_208:
    v_cmp_ge_u32 s[8:9], v102, v96
    v_cmp_le_u32 vcc, v102, v97
    s_and_b64 s[8:9], s[8:9], vcc
ra_211:
    s_cmp_eq_u64 s[8:9], 0
    s_cbranch_scc1 rb_212
    s_ff1_i32_b64 s10, s[8:9]
    s_bitset0_b64 s[8:9], s10
    v_readlane_b32 s11, v102, s10
    s_not_b32 s12, s11
    s_bfe_u32 s12, s12, 0x50009
    s_lshl_b32 s12, s12, 3
    s_and_b32 s13, s11, 7
    s_add_u32 s12, s12, s13
    s_mul_i32 s12, s12, 1280
    s_add_u32 s12, s12, 6623232
    s_mov_b32 s57, 65536
rp_213:
    buffer_load_dwordx4 v[84:87], v91, s[16:19], s12 offen sc1
    buffer_load_dword v88, v91, s[16:19], s12 offen offset:16 sc1
    s_waitcnt vmcnt(0)
    v_max3_u32 v89, v84, v85, v86
    v_max3_u32 v89, v89, v87, v88
    v_cmp_eq_u32 vcc, -1, v89
    s_cbranch_vccz rq_214
    s_sub_u32 s57, s57, 1
    s_cbranch_scc0 rp_213
rq_214:
    v_mov_b32 v89, 0
    v_dot2c_f32_bf16 v89, v240, v84
    v_dot2c_f32_bf16 v89, v241, v85
    v_dot2c_f32_bf16 v89, v242, v86
    v_dot2c_f32_bf16 v89, v243, v87
    v_dot2c_f32_bf16 v89, v244, v88
    s_nop 2
    v_add_f32_dpp v89, v89, v89 row_ror:1 row_mask:0xf bank_mask:0xf
    s_nop 1
    v_add_f32_dpp v89, v89, v89 row_ror:2 row_mask:0xf bank_mask:0xf
    s_nop 1
    v_add_f32_dpp v89, v89, v89 row_ror:4 row_mask:0xf bank_mask:0xf
    s_nop 1
    v_add_f32_dpp v89, v89, v89 row_ror:8 row_mask:0xf bank_mask:0xf
    v_mov_b32 v90, v89
    s_nop 1
    v_permlane16_swap_b32 v89, v90
    v_add_f32 v89, v89, v90
    v_mov_b32 v90, v89
    s_nop 1
    v_permlane32_swap_b32 v89, v90
    v_add_f32 v89, v89, v90
    v_ashrrev_i32 v90, 31, v89
    v_or_b32 v90, 0x80000000, v90
    v_xor_b32_e64 v89, v89, v90
    s_and_b32 s11, s11, 0x3fff
    v_and_b32 v89, 0xffffc000, v89
    v_or_b32 v89, s11, v89
    s_lshl_b64 s[14:15], 1, s10
    s_mov_b64 exec, s[14:15]
    v_mov_b32 v102, v89
    s_mov_b64 exec, -1
    s_branch ra_211
rb_212:
    v_cmp_ge_u32 s[8:9], v104, v96
    v_cmp_le_u32 vcc, v104, v97
    s_and_b64 s[8:9], s[8:9], vcc
ra_215:
    s_cmp_eq_u64 s[8:9], 0
    s_cbranch_scc1 rb_216
    s_ff1_i32_b64 s10, s[8:9]
    s_bitset0_b64 s[8:9], s10
    v_readlane_b32 s11, v104, s10
    s_not_b32 s12, s11
    s_bfe_u32 s12, s12, 0x50009
    s_lshl_b32 s12, s12, 3
    s_and_b32 s13, s11, 7
    s_add_u32 s12, s12, s13
    s_mul_i32 s12, s12, 1280
    s_add_u32 s12, s12, 6623232
    s_mov_b32 s57, 65536
rp_217:
    buffer_load_dwordx4 v[84:87], v91, s[16:19], s12 offen sc1
    buffer_load_dword v88, v91, s[16:19], s12 offen offset:16 sc1
    s_waitcnt vmcnt(0)
    v_max3_u32 v89, v84, v85, v86
    v_max3_u32 v89, v89, v87, v88
    v_cmp_eq_u32 vcc, -1, v89
    s_cbranch_vccz rq_218
    s_sub_u32 s57, s57, 1
    s_cbranch_scc0 rp_217
rq_218:
    v_mov_b32 v89, 0
    v_dot2c_f32_bf16 v89, v240, v84
    v_dot2c_f32_bf16 v89, v241, v85
    v_dot2c_f32_bf16 v89, v242, v86
    v_dot2c_f32_bf16 v89, v243, v87
    v_dot2c_f32_bf16 v89, v244, v88
    s_nop 2
    v_add_f32_dpp v89, v89, v89 row_ror:1 row_mask:0xf bank_mask:0xf
    s_nop 1
    v_add_f32_dpp v89, v89, v89 row_ror:2 row_mask:0xf bank_mask:0xf
    s_nop 1
    v_add_f32_dpp v89, v89, v89 row_ror:4 row_mask:0xf bank_mask:0xf
    s_nop 1
    v_add_f32_dpp v89, v89, v89 row_ror:8 row_mask:0xf bank_mask:0xf
    v_mov_b32 v90, v89
    s_nop 1
    v_permlane16_swap_b32 v89, v90
    v_add_f32 v89, v89, v90
    v_mov_b32 v90, v89
    s_nop 1
    v_permlane32_swap_b32 v89, v90
    v_add_f32 v89, v89, v90
    v_ashrrev_i32 v90, 31, v89
    v_or_b32 v90, 0x80000000, v90
    v_xor_b32_e64 v89, v89, v90
    s_and_b32 s11, s11, 0x3fff
    v_and_b32 v89, 0xffffc000, v89
    v_or_b32 v89, s11, v89
    s_lshl_b64 s[14:15], 1, s10
    s_mov_b64 exec, s[14:15]
    v_mov_b32 v104, v89
    s_mov_b64 exec, -1
    s_branch ra_215
rb_216:
    v_cmp_ge_u32 s[8:9], v106, v96
    v_cmp_le_u32 vcc, v106, v97
    s_and_b64 s[8:9], s[8:9], vcc
ra_219:
    s_cmp_eq_u64 s[8:9], 0
    s_cbranch_scc1 rb_220
    s_ff1_i32_b64 s10, s[8:9]
    s_bitset0_b64 s[8:9], s10
    v_readlane_b32 s11, v106, s10
    s_not_b32 s12, s11
    s_bfe_u32 s12, s12, 0x50009
    s_lshl_b32 s12, s12, 3
    s_and_b32 s13, s11, 7
    s_add_u32 s12, s12, s13
    s_mul_i32 s12, s12, 1280
    s_add_u32 s12, s12, 6623232
    s_mov_b32 s57, 65536
rp_221:
    buffer_load_dwordx4 v[84:87], v91, s[16:19], s12 offen sc1
    buffer_load_dword v88, v91, s[16:19], s12 offen offset:16 sc1
    s_waitcnt vmcnt(0)
    v_max3_u32 v89, v84, v85, v86
    v_max3_u32 v89, v89, v87, v88
    v_cmp_eq_u32 vcc, -1, v89
    s_cbranch_vccz rq_222
    s_sub_u32 s57, s57, 1
    s_cbranch_scc0 rp_221
rq_222:
    v_mov_b32 v89, 0
    v_dot2c_f32_bf16 v89, v240, v84
    v_dot2c_f32_bf16 v89, v241, v85
    v_dot2c_f32_bf16 v89, v242, v86
    v_dot2c_f32_bf16 v89, v243, v87
    v_dot2c_f32_bf16 v89, v244, v88
    s_nop 2
    v_add_f32_dpp v89, v89, v89 row_ror:1 row_mask:0xf bank_mask:0xf
    s_nop 1
    v_add_f32_dpp v89, v89, v89 row_ror:2 row_mask:0xf bank_mask:0xf
    s_nop 1
    v_add_f32_dpp v89, v89, v89 row_ror:4 row_mask:0xf bank_mask:0xf
    s_nop 1
    v_add_f32_dpp v89, v89, v89 row_ror:8 row_mask:0xf bank_mask:0xf
    v_mov_b32 v90, v89
    s_nop 1
    v_permlane16_swap_b32 v89, v90
    v_add_f32 v89, v89, v90
    v_mov_b32 v90, v89
    s_nop 1
    v_permlane32_swap_b32 v89, v90
    v_add_f32 v89, v89, v90
    v_ashrrev_i32 v90, 31, v89
    v_or_b32 v90, 0x80000000, v90
    v_xor_b32_e64 v89, v89, v90
    s_and_b32 s11, s11, 0x3fff
    v_and_b32 v89, 0xffffc000, v89
    v_or_b32 v89, s11, v89
    s_lshl_b64 s[14:15], 1, s10
    s_mov_b64 exec, s[14:15]
    v_mov_b32 v106, v89
    s_mov_b64 exec, -1
    s_branch ra_219
rb_220:
    v_mov_b32_dpp v101, v100 quad_perm:[1,0,3,2] row_mask:0xf bank_mask:0xf
    v_mov_b32_dpp v103, v102 quad_perm:[1,0,3,2] row_mask:0xf bank_mask:0xf
    v_mov_b32_dpp v105, v104 quad_perm:[1,0,3,2] row_mask:0xf bank_mask:0xf
    v_mov_b32_dpp v107, v106 quad_perm:[1,0,3,2] row_mask:0xf bank_mask:0xf
    v_med3_u32 v100, v100, v101, v248
    v_med3_u32 v102, v102, v103, v248
    v_med3_u32 v104, v104, v105, v248
    v_med3_u32 v106, v106, v107, v248
    v_mov_b32_dpp v101, v100 quad_perm:[3,2,1,0] row_mask:0xf bank_mask:0xf
    v_mov_b32_dpp v103, v102 quad_perm:[3,2,1,0] row_mask:0xf bank_mask:0xf
    v_mov_b32_dpp v105, v104 quad_perm:[3,2,1,0] row_mask:0xf bank_mask:0xf
    v_mov_b32_dpp v107, v106 quad_perm:[3,2,1,0] row_mask:0xf bank_mask:0xf
    v_med3_u32 v100, v100, v101, v249
    v_med3_u32 v102, v102, v103, v249
    v_med3_u32 v104, v104, v105, v249
    v_med3_u32 v106, v106, v107, v249
    v_mov_b32_dpp v101, v100 quad_perm:[1,0,3,2] row_mask:0xf bank_mask:0xf
    v_mov_b32_dpp v103, v102 quad_perm:[1,0,3,2] row_mask:0xf bank_mask:0xf
    v_mov_b32_dpp v105, v104 quad_perm:[1,0,3,2] row_mask:0xf bank_mask:0xf
    v_mov_b32_dpp v107, v106 quad_perm:[1,0,3,2] row_mask:0xf bank_mask:0xf
    v_med3_u32 v100, v100, v101, v248
    v_med3_u32 v102, v102, v103, v248
    v_med3_u32 v104, v104, v105, v248
    v_med3_u32 v106, v106, v107, v248
    v_mov_b32_dpp v101, v100 row_half_mirror row_mask:0xf bank_mask:0xf
    v_mov_b32_dpp v103, v102 row_half_mirror row_mask:0xf bank_mask:0xf
    v_mov_b32_dpp v105, v104 row_half_mirror row_mask:0xf bank_mask:0xf
    v_mov_b32_dpp v107, v106 row_half_mirror row_mask:0xf bank_mask:0xf
    v_med3_u32 v100, v100, v101, v250
    v_med3_u32 v102, v102, v103, v250
    v_med3_u32 v104, v104, v105, v250
    v_med3_u32 v106, v106, v107, v250
    v_mov_b32_dpp v101, v100 quad_perm:[2,3,0,1] row_mask:0xf bank_mask:0xf
    v_mov_b32_dpp v103, v102 quad_perm:[2,3,0,1] row_mask:0xf bank_mask:0xf
    v_mov_b32_dpp v105, v104 quad_perm:[2,3,0,1] row_mask:0xf bank_mask:0xf
    v_mov_b32_dpp v107, v106 quad_perm:[2,3,0,1] row_mask:0xf bank_mask:0xf
    v_med3_u32 v100, v100, v101, v249
    v_med3_u32 v102, v102, v103, v249
    v_med3_u32 v104, v104, v105, v249
    v_med3_u32 v106, v106, v107, v249
    v_mov_b32_dpp v101, v100 quad_perm:[1,0,3,2] row_mask:0xf bank_mask:0xf
    v_mov_b32_dpp v103, v102 quad_perm:[1,0,3,2] row_mask:0xf bank_mask:0xf
    v_mov_b32_dpp v105, v104 quad_perm:[1,0,3,2] row_mask:0xf bank_mask:0xf
    v_mov_b32_dpp v107, v106 quad_perm:[1,0,3,2] row_mask:0xf bank_mask:0xf
    v_med3_u32 v100, v100, v101, v248
    v_med3_u32 v102, v102, v103, v248
    v_med3_u32 v104, v104, v105, v248
    v_med3_u32 v106, v106, v107, v248
    s_branch km_169
L_codeend:
.section .rodata,"a"
.p2align 6
.amdhsa_kernel sequential_preLN__linear_kernel_hedgehog__moe_arch_mod__prompt_kernel
  .amdhsa_next_free_vgpr 256
  .amdhsa_next_free_sgpr 102
  .amdhsa_accum_offset 256
  .amdhsa_group_segment_fixed_size 0
  .amdhsa_kernarg_size 96
  .amdhsa_user_sgpr_count 2
  .amdhsa_user_sgpr_kernarg_segment_ptr 1
  .amdhsa_system_sgpr_workgroup_id_x 1
.end_amdhsa_kernel
```
